```python
import torch

def _softmax(x, axis=-1):
    return torch.softmax(x, dim=axis)
def _gelu(x):
    return torch.nn.functional.gelu(x, approximate="tanh")
def _silu(x):
    return torch.nn.functional.silu(x)
def _sigmoid(x):
    return torch.sigmoid(x)
def _layernorm(x, axis=-1, eps=1e-5):
    m = x.mean(dim=axis, keepdim=True)
    v = x.var(dim=axis, keepdim=True, unbiased=False)
    return (x - m) / torch.sqrt(v + eps)
def _scatter_add(tgt, idx, src, axis=0):
    return tgt.clone().index_add_(axis, idx, src)
def _segment_sum(src, seg, n):
    out = torch.zeros((n,) + src.shape[1:], dtype=src.dtype)
    return out.index_add_(0, seg, src)
def _pad(x, pw):
    flat = tuple(v for pair in reversed(pw) for v in pair)
    return torch.nn.functional.pad(x, flat)

kernel_name = 'concat_heads__gqa_block_cached__gqa_block_cached__near_ridge'

def setup_inputs():

    _w = (lambda a: (lambda t: t.to(torch.bfloat16) if t.is_floating_point() else t)(torch.as_tensor(a)))
    def _A_setup():
        B, Sq, D = 16, 112, 576
        Hq, Hkv, Sk, Dh = 32, 16, 512, 128
        assert Hq % Hkv == 0, (Hq, Hkv)
        return {
            "x": _w((lambda *s: torch.randn(*s, dtype=torch.bfloat16) * 0.8)(B, Sq, D)),
            "k_cache": _w((lambda *s: torch.randn(*s, dtype=torch.bfloat16) * 0.8)(B, Hkv, Sk, Dh)),
            "v_cache": _w((lambda *s: torch.randn(*s, dtype=torch.bfloat16) * 0.05)(B, Hkv, Sk, Dh)),
            "wq": _w((lambda *s: torch.randn(*s, dtype=torch.bfloat16) * 0.8)(D, Hq * Dh) * (D ** -0.5)),
            "wo": _w((lambda *s: torch.randn(*s, dtype=torch.bfloat16) * 0.05)(Hq * Dh, D) * ((Hq * Dh) ** -0.5)),
        }
    _A_in = _A_setup()

    def _B_setup():
        B, Sq, D = 16, 112, 576
        Hq, Hkv, Sk, Dh = 32, 16, 512, 128
        assert Hq % Hkv == 0, (Hq, Hkv)
        return {
            "x": _w((lambda *s: torch.randn(*s, dtype=torch.bfloat16) * 0.8)(B, Sq, D)),
            "k_cache": _w((lambda *s: torch.randn(*s, dtype=torch.bfloat16) * 0.8)(B, Hkv, Sk, Dh)),
            "v_cache": _w((lambda *s: torch.randn(*s, dtype=torch.bfloat16) * 0.05)(B, Hkv, Sk, Dh)),
            "wq": _w((lambda *s: torch.randn(*s, dtype=torch.bfloat16) * 0.8)(D, Hq * Dh) * (D ** -0.5)),
            "wo": _w((lambda *s: torch.randn(*s, dtype=torch.bfloat16) * 0.05)(Hq * Dh, D) * ((Hq * Dh) ** -0.5)),
        }
    _B_in = _B_setup()

    return {
        "A_x": _A_in["x"],
        "A_k_cache": _A_in["k_cache"],
        "A_v_cache": _A_in["v_cache"],
        "A_wq": _A_in["wq"],
        "A_wo": _A_in["wo"],
        "B_x": _B_in["x"],
        "B_k_cache": _B_in["k_cache"],
        "B_v_cache": _B_in["v_cache"],
        "B_wq": _B_in["wq"],
        "B_wo": _B_in["wo"],
    }

def reference(A_x, A_k_cache, A_v_cache, A_wq, A_wo, B_x, B_k_cache, B_v_cache, B_wq, B_wo):
    def _A_ref(x, k_cache, v_cache, wq, wo):
        B, Sq, D = x.shape
        Hq, Dh = 32, 128
        Hkv = k_cache.shape[1]
        rep = Hq // Hkv
        q = (lambda x, *d: x.permute(*d))((x @ wq).reshape(B, Sq, Hq, Dh), 0, 2, 1, 3)
        k = (lambda x, n, axis: torch.repeat_interleave(x, n, dim=axis))(k_cache, rep, axis=1)
        v = (lambda x, n, axis: torch.repeat_interleave(x, n, dim=axis))(v_cache, rep, axis=1)
        scores = torch.einsum("bhqd,bhkd->bhqk", q, k) * (Dh ** -0.5)
        p = _softmax(scores, axis=-1)
        o = torch.einsum("bhqk,bhkd->bhqd", p, v)
        return (lambda x, *d: x.permute(*d))(o, 0, 2, 1, 3).reshape(B, Sq, Hq * Dh) @ wo

    def _B_ref(x, k_cache, v_cache, wq, wo):
        B, Sq, D = x.shape
        Hq, Dh = 32, 128
        Hkv = k_cache.shape[1]
        rep = Hq // Hkv
        q = (lambda x, *d: x.permute(*d))((x @ wq).reshape(B, Sq, Hq, Dh), 0, 2, 1, 3)
        k = (lambda x, n, axis: torch.repeat_interleave(x, n, dim=axis))(k_cache, rep, axis=1)
        v = (lambda x, n, axis: torch.repeat_interleave(x, n, dim=axis))(v_cache, rep, axis=1)
        scores = torch.einsum("bhqd,bhkd->bhqk", q, k) * (Dh ** -0.5)
        p = _softmax(scores, axis=-1)
        o = torch.einsum("bhqk,bhkd->bhqd", p, v)
        return (lambda x, *d: x.permute(*d))(o, 0, 2, 1, 3).reshape(B, Sq, Hq * Dh) @ wo

    a = _A_ref(A_x, A_k_cache, A_v_cache, A_wq, A_wo)
    b = _B_ref(B_x, B_k_cache, B_v_cache, B_wq, B_wo)
    return torch.concatenate([a, b], axis=-1)
```

```asm
; @launch kernel=attn_kernel grid=(256,1,1) block=(256,1,1) lds=163840
; @launch kernel=oproj_kernel grid=(256,1,1) block=(256,1,1) lds=131072
.amdgcn_target "amdgcn-amd-amdhsa--gfx950"
.text
.globl attn_kernel
.p2align 8
.type attn_kernel,@function
attn_kernel:
  s_cmp_ge_u32 s2, 256
  s_cbranch_scc1 attn_kernel_done
  s_load_dwordx8 s[4:11], s[0:1], 0
  s_load_dwordx8 s[12:19], s[0:1], 40
  s_load_dwordx2 s[20:21], s[0:1], 96
  s_load_dwordx2 s[22:23], s[0:1], 32
  s_load_dwordx2 s[76:77], s[0:1], 72
  v_lshrrev_b32 v10, 6, v0
  v_and_b32 v1, 63, v0
  s_and_b32 s52, s2, 7
  v_readfirstlane_b32 s40, v10
  s_lshr_b32 s53, s2, 3
  s_lshr_b32 s41, s52, 2
  s_and_b32 s52, s52, 3
  s_lshl_b32 s42, s52, 2
  s_and_b32 s54, s53, 3
  s_add_u32 s42, s42, s54
  s_lshr_b32 s43, s53, 2
  s_lshr_b32 s44, s40, 1
  s_and_b32 s45, s40, 1
  s_getpc_b64 s[96:97]
attn_kernel_pc:
  s_sub_u32 s96, s96, attn_kernel_pc-attn_kernel
  s_subb_u32 s97, s97, 0
  s_lshr_b32 s52, s2, 3
  s_lshl_b32 s52, s52, 2
  s_add_u32 s52, s52, s40
  s_lshl_b32 s52, s52, 9
  v_lshl_add_u32 v13, v1, 3, s52
  s_mov_b32 s52, code_end-attn_kernel-4
  v_min_u32 v13, s52, v13
  v_lshrrev_b32 v10, 5, v1
  v_and_b32 v11, 31, v1
  s_lshl_b32 s52, s45, 3
  v_lshlrev_b32 v12, 1, v10
  v_or_b32 v12, s52, v12
  v_xor_b32 v12, v12, v11
  v_lshlrev_b32 v18, 13, v10
  v_lshl_add_u32 v14, v12, 4, v18
  v_add_u32 v16, 30720, v14
  v_xor_b32 v12, 4, v12
  v_lshl_add_u32 v15, v12, 4, v18
  v_add_u32 v15, 15360, v15
  v_add_u32 v17, 30720, v15
  v_lshrrev_b32 v10, 3, v1
  v_mul_u32_u24 v10, 1152, v10
  v_lshrrev_b32 v11, 4, v1
  v_and_b32 v12, 7, v1
  v_xor_b32 v11, v11, v12
  s_lshl_b32 s52, s45, 2
  v_xor_b32 v11, s52, v11
  v_lshl_add_u32 v30, v11, 4, v10
  v_xor_b32 v11, 4, v11
  v_lshl_add_u32 v31, v11, 4, v10
  s_lshl_b32 s46, s40, 16
  s_lshl_b32 s52, s42, 9
  s_add_u32 s46, s46, s52
  s_mul_i32 s47, s40, 64512
  s_lshl_b32 s49, s40, 12
  s_add_u32 s49, s49, 131072
  s_mul_i32 s50, s40, 7168
  s_add_u32 s52, s50, 34816
  s_add_u32 s50, s50, 69632
  s_xor_b32 s57, s50, s52
  s_mul_i32 s51, s40, 8704
  s_add_u32 s72, s46, 4718592
  s_add_u32 s73, s47, 1152
  s_mov_b32 s48, 0
  s_mov_b32 s66, 16384
  s_mov_b32 s67, 4294918144
  s_mov_b32 s68, 34816
  s_mov_b32 s69, 4294862848
  s_mov_b32 s65, 2
  s_mov_b32 s64, 0
  s_waitcnt lgkmcnt(0)
  s_cmp_eq_u32 s41, 0
  s_cselect_b64 s[4:5], s[4:5], s[12:13]
  s_cselect_b64 s[6:7], s[6:7], s[14:15]
  s_cselect_b64 s[8:9], s[8:9], s[16:17]
  s_cselect_b64 s[10:11], s[10:11], s[18:19]
  s_cselect_b64 s[22:23], s[22:23], s[76:77]
  s_mul_i32 s52, s43, 258048
  s_add_u32 s24, s4, s52
  s_addc_u32 s25, s5, 0
  s_mov_b32 s26, 258048
  s_mov_b32 s27, 0x00020000
  s_mov_b32 s28, s10
  s_mov_b32 s29, s11
  s_mov_b32 s30, 4718592
  s_mov_b32 s31, 0x00020000
  s_mov_b32 m0, s49
  s_add_u32 s65, s65, 1
  buffer_load_dwordx4 v14, s[28:31], s46 offen offset:0 lds
  buffer_load_dwordx4 v15, s[28:31], s46 offen offset:1024 lds
  buffer_load_dwordx4 v16, s[28:31], s46 offen offset:2048 lds
  buffer_load_dwordx4 v17, s[28:31], s46 offen offset:3072 lds
  s_add_u32 s46, s46, 262144
  s_and_b32 s65, s65, 3
  s_cselect_b32 s52, s66, s67
  s_add_u32 s49, s49, s52
  s_add_u32 m0, s50, 0
  s_add_u32 s53, s47, 0
  buffer_load_dwordx4 v30, s[24:27], s53 offen offset:0 lds
  s_add_u32 s53, s47, 8192
  buffer_load_dwordx4 v31, s[24:27], s53 offen offset:1024 lds
  s_add_u32 s53, s47, 16384
  buffer_load_dwordx4 v30, s[24:27], s53 offen offset:2048 lds
  s_add_u32 s53, s47, 24576
  buffer_load_dwordx4 v31, s[24:27], s53 offen offset:3072 lds
  s_add_u32 m0, s50, 4096
  s_add_u32 s53, s47, 36864
  buffer_load_dwordx4 v30, s[24:27], s53 offen offset:0 lds
  s_add_u32 s53, s47, 45056
  buffer_load_dwordx4 v31, s[24:27], s53 offen offset:1024 lds
  s_add_u32 s53, s47, 53248
  buffer_load_dwordx4 v30, s[24:27], s53 offen offset:2048 lds
  s_add_u32 s47, s47, 128
  s_xor_b32 s50, s50, s57
  s_mov_b32 m0, s49
  s_add_u32 s65, s65, 1
  buffer_load_dwordx4 v14, s[28:31], s46 offen offset:0 lds
  buffer_load_dwordx4 v15, s[28:31], s46 offen offset:1024 lds
  buffer_load_dwordx4 v16, s[28:31], s46 offen offset:2048 lds
  buffer_load_dwordx4 v17, s[28:31], s46 offen offset:3072 lds
  s_add_u32 s46, s46, 262144
  s_and_b32 s65, s65, 3
  s_cselect_b32 s52, s66, s67
  s_add_u32 s49, s49, s52
  global_load_dword v0, v13, s[96:97]
  s_cmp_eq_u32 s45, 0
  s_cselect_b64 s[6:7], s[6:7], s[8:9]
  s_lshl_b32 s52, s43, 1
  s_add_u32 s52, s52, s44
  s_lshl_b32 s53, s52, 4
  s_add_u32 s53, s53, s42
  s_lshl_b32 s53, s53, 17
  s_add_u32 s32, s6, s53
  s_addc_u32 s33, s7, 0
  s_sub_u32 s32, s32, 192
  s_subb_u32 s33, s33, 0
  s_mov_b32 s34, 131264
  s_mov_b32 s35, 0x00020000
  s_lshl_b32 s53, s41, 4
  s_add_u32 s52, s52, s53
  s_mul_i32 s52, s52, 917504
  s_lshl_b32 s53, s42, 1
  s_add_u32 s53, s53, s45
  s_lshl_b32 s53, s53, 12
  s_add_u32 s52, s52, s53
  s_add_u32 s36, s20, s52
  s_addc_u32 s37, s21, 0
  s_mov_b32 s38, 790528
  s_mov_b32 s39, 0x00020000
  v_lshrrev_b32 v10, 4, v1
  v_and_b32 v11, 1, v10
  v_lshlrev_b32 v11, 1, v11
  v_lshrrev_b32 v12, 1, v10
  v_lshl_or_b32 v11, v12, 3, v11
  s_cmp_eq_u32 s45, 0
  s_cselect_b64 vcc, -1, 0
  v_cndmask_b32 v11, v11, v10, vcc
  v_and_b32 v12, 15, v1
  v_xor_b32 v11, v11, v12
  v_lshlrev_b32 v11, 4, v11
  v_lshl_add_u32 v11, v10, 8, v11
  v_add_u32 v2, 192, v11
  v_add_u32 v3, 128, v11
  v_add_u32 v4, 64, v11
  v_mov_b32 v5, v11
  s_lshl_b32 s52, s42, 3
  s_add_u32 s52, s52, s43
  s_lshl_b32 s52, s52, 2
  s_add_u32 s52, s52, s40
  s_mul_i32 s52, s52, 9216
  s_add_u32 s12, s22, s52
  s_addc_u32 s13, s23, 0
  s_sub_u32 s12, s12, 192
  s_subb_u32 s13, s13, 0
  s_mov_b32 s16, 0x70000000
  s_mov_b32 s14, 9408
  s_mov_b32 s15, 0x00020000
  s_mov_b32 s17, s51
  s_mov_b32 s19, 0
  s_add_u32 s51, s51, 34816
  s_mov_b32 s48, 8192
  s_mov_b32 s64, 1
  v_lshrrev_b32 v32, 4, v1
  v_bfe_u32 v33, v1, 2, 2
  v_lshl_add_u32 v34, v32, 3, v33
  v_lshlrev_b32 v34, 9, v34
  v_and_b32 v35, 1, v32
  v_lshl_or_b32 v35, v35, 2, v33
  v_lshl_add_u32 v34, v35, 5, v34
  v_and_b32 v35, 3, v1
  v_lshl_add_u32 v34, v35, 3, v34
  s_lshl_b32 s52, s45, 8
  s_add_u32 s52, s52, 131072
  v_add_u32 v20, s52, v34
  v_xor_b32 v21, 32, v20
  v_xor_b32 v22, 64, v20
  v_xor_b32 v23, 96, v20
  v_xor_b32 v24, 128, v20
  v_xor_b32 v25, 160, v20
  v_xor_b32 v26, 192, v20
  v_xor_b32 v27, 224, v20
  v_and_b32 v33, 15, v1
  v_lshrrev_b32 v34, 1, v33
  v_xor_b32 v34, v34, v32
  v_lshlrev_b32 v34, 4, v34
  v_lshl_add_u32 v34, v33, 7, v34
  s_mul_i32 s52, s44, 14336
  s_add_u32 s52, s52, 69632
  v_add_u32 v28, s52, v34
  v_xor_b32 v29, 64, v28
  s_mov_b32 s60, 1040356334
  s_mov_b32 s61, 1040356334
  s_mov_b32 s75, 3187839982
  s_mov_b32 s58, 1090519040
  s_mov_b32 s55, 0
  v_and_b32 v36, 15, v1
  v_lshrrev_b32 v37, 4, v1
  v_lshrrev_b32 v38, 2, v36
  v_and_b32 v39, 3, v36
  v_mul_u32_u24 v40, 1088, v38
  v_lshl_add_u32 v40, v39, 8, v40
  v_xor_b32 v41, v37, v39
  v_lshl_add_u32 v40, v41, 4, v40
  s_mul_i32 s52, s44, 17408
  v_add_u32 v6, s52, v40
  v_mul_u32_u24 v40, 1088, v37
  v_lshl_add_u32 v40, v38, 8, v40
  v_lshl_add_u32 v40, v39, 3, v40
  s_add_u32 s52, s52, 8704
  v_add_u32 v40, s52, v40
  v_and_b32 v41, 1, v38
  v_lshrrev_b32 v36, 1, v38
  v_lshl_or_b32 v41, v36, 2, v41
  v_xor_b32 v36, 0, v41
  v_lshl_add_u32 v7, v36, 5, v40
  v_xor_b32 v36, 1, v41
  v_lshl_add_u32 v8, v36, 5, v40
  v_xor_b32 v36, 4, v41
  v_lshl_add_u32 v9, v36, 5, v40
  v_xor_b32 v36, 5, v41
  v_lshl_add_u32 v10, v36, 5, v40
  s_mov_b32 s62, 0
  s_mov_b32 s63, 0
  v_mov_b32 v36, 0x3f803f80
  v_mov_b32 v37, 0
  v_accvgpr_write_b32 a252, v36
  v_accvgpr_write_b32 a253, v36
  v_accvgpr_write_b32 a254, v36
  v_accvgpr_write_b32 a255, v36
  v_accvgpr_write_b32 a192, v37
  v_accvgpr_write_b32 a193, v37
  v_accvgpr_write_b32 a194, v37
  v_accvgpr_write_b32 a195, v37
  v_accvgpr_write_b32 a196, v37
  v_accvgpr_write_b32 a197, v37
  v_accvgpr_write_b32 a198, v37
  v_accvgpr_write_b32 a199, v37
  v_accvgpr_write_b32 a200, v37
  v_accvgpr_write_b32 a201, v37
  v_accvgpr_write_b32 a202, v37
  v_accvgpr_write_b32 a203, v37
  v_accvgpr_write_b32 a204, v37
  v_accvgpr_write_b32 a205, v37
  v_accvgpr_write_b32 a206, v37
  v_accvgpr_write_b32 a207, v37
  v_accvgpr_write_b32 a208, v37
  v_accvgpr_write_b32 a209, v37
  v_accvgpr_write_b32 a210, v37
  v_accvgpr_write_b32 a211, v37
  v_accvgpr_write_b32 a212, v37
  v_accvgpr_write_b32 a213, v37
  v_accvgpr_write_b32 a214, v37
  v_accvgpr_write_b32 a215, v37
  v_accvgpr_write_b32 a216, v37
  v_accvgpr_write_b32 a217, v37
  v_accvgpr_write_b32 a218, v37
  v_accvgpr_write_b32 a219, v37
  v_accvgpr_write_b32 a220, v37
  v_accvgpr_write_b32 a221, v37
  v_accvgpr_write_b32 a222, v37
  v_accvgpr_write_b32 a223, v37
  v_accvgpr_write_b32 a248, v37
  v_accvgpr_write_b32 a249, v37
  v_accvgpr_write_b32 a250, v37
  v_accvgpr_write_b32 a251, v37
  s_waitcnt vmcnt(5)
  s_barrier
  ds_read_b64_tr_b16 a[0:1], v20 offset:0
  ds_read_b64_tr_b16 a[2:3], v20 offset:2048
  ds_read_b128 a[16:19], v28 offset:0
  ds_read_b128 a[20:23], v28 offset:2048
  ds_read_b128 a[24:27], v28 offset:4096
  ds_read_b128 a[28:31], v28 offset:6144
  ds_read_b128 a[32:35], v28 offset:8192
  ds_read_b128 a[36:39], v28 offset:10240
  ds_read_b128 a[40:43], v28 offset:12288
  ds_read_b64_tr_b16 a[4:5], v21 offset:0
  ds_read_b64_tr_b16 a[6:7], v21 offset:2048
  s_mov_b32 s59, 4294932480
  s_mov_b32 s56, 4294934528
  s_waitcnt lgkmcnt(8)
  v_mfma_f32_16x16x32_bf16 v[32:35], a[0:3], a[16:19], 0
  s_waitcnt lgkmcnt(7)
  ds_read_b64_tr_b16 a[8:9], v22 offset:0
  v_mfma_f32_16x16x32_bf16 v[40:43], a[0:3], a[20:23], 0
  s_waitcnt lgkmcnt(7)
  s_add_u32 m0, s50, 0
  ds_read_b64_tr_b16 a[10:11], v22 offset:2048
  s_add_u32 s53, s47, 0
  buffer_load_dwordx4 v30, s[24:27], s53 offen offset:0 lds
  v_mfma_f32_16x16x32_bf16 v[48:51], a[0:3], a[24:27], 0
  s_waitcnt lgkmcnt(7)
  ds_read_b128 a[44:47], v29 offset:0
  v_mfma_f32_16x16x32_bf16 v[56:59], a[0:3], a[28:31], 0
  s_waitcnt lgkmcnt(7)
  ds_read_b128 a[48:51], v29 offset:2048
  v_mfma_f32_16x16x32_bf16 v[64:67], a[0:3], a[32:35], 0
  s_waitcnt lgkmcnt(7)
  ds_read_b128 a[52:55], v29 offset:4096
  s_add_u32 s53, s47, 8192
  buffer_load_dwordx4 v31, s[24:27], s53 offen offset:1024 lds
  v_mfma_f32_16x16x32_bf16 v[72:75], a[0:3], a[36:39], 0
  s_waitcnt lgkmcnt(7)
  ds_read_b128 a[56:59], v29 offset:6144
  v_mfma_f32_16x16x32_bf16 v[80:83], a[0:3], a[40:43], 0
  s_waitcnt lgkmcnt(6)
  ds_read_b128 a[60:63], v29 offset:8192
  v_mfma_f32_16x16x32_bf16 v[36:39], a[4:7], a[16:19], 0
  ds_read_b64_tr_b16 a[12:13], v23 offset:0
  s_add_u32 s53, s47, 16384
  buffer_load_dwordx4 v30, s[24:27], s53 offen offset:2048 lds
  v_mfma_f32_16x16x32_bf16 v[44:47], a[4:7], a[20:23], 0
  ds_read_b64_tr_b16 a[14:15], v23 offset:2048
  v_mfma_f32_16x16x32_bf16 v[52:55], a[4:7], a[24:27], 0
  ds_read_b128 a[64:67], v29 offset:10240
  v_mfma_f32_16x16x32_bf16 v[60:63], a[4:7], a[28:31], 0
  ds_read_b128 a[68:71], v29 offset:12288
  v_mfma_f32_16x16x32_bf16 v[68:71], a[4:7], a[32:35], 0
  s_add_u32 s53, s47, 24576
  buffer_load_dwordx4 v31, s[24:27], s53 offen offset:3072 lds
  v_mfma_f32_16x16x32_bf16 v[76:79], a[4:7], a[36:39], 0
  s_mov_b32 m0, s49
  s_add_u32 s65, s65, 1
  v_mfma_f32_16x16x32_bf16 v[84:87], a[4:7], a[40:43], 0
  s_waitcnt lgkmcnt(9)
  v_mfma_f32_16x16x32_bf16 v[88:91], a[8:11], a[16:19], 0
  ds_read_b64_tr_b16 a[0:1], v24 offset:0
  v_mfma_f32_16x16x32_bf16 v[96:99], a[8:11], a[20:23], 0
  ds_read_b64_tr_b16 a[2:3], v24 offset:2048
  v_mfma_f32_16x16x32_bf16 v[104:107], a[8:11], a[24:27], 0
  buffer_load_dwordx4 v14, s[28:31], s46 offen offset:0 lds
  v_mfma_f32_16x16x32_bf16 v[112:115], a[8:11], a[28:31], 0
  v_mfma_f32_16x16x32_bf16 v[120:123], a[8:11], a[32:35], 0
  v_mfma_f32_16x16x32_bf16 v[128:131], a[8:11], a[36:39], 0
  buffer_load_dwordx4 v15, s[28:31], s46 offen offset:1024 lds
  v_mfma_f32_16x16x32_bf16 v[136:139], a[8:11], a[40:43], 0
  s_waitcnt lgkmcnt(4)
  v_mfma_f32_16x16x32_bf16 v[92:95], a[12:15], a[16:19], 0
  ds_read_b64_tr_b16 a[4:5], v25 offset:0
  v_mfma_f32_16x16x32_bf16 v[100:103], a[12:15], a[20:23], 0
  ds_read_b64_tr_b16 a[6:7], v25 offset:2048
  v_mfma_f32_16x16x32_bf16 v[108:111], a[12:15], a[24:27], 0
  buffer_load_dwordx4 v16, s[28:31], s46 offen offset:2048 lds
  v_mfma_f32_16x16x32_bf16 v[116:119], a[12:15], a[28:31], 0
  v_mfma_f32_16x16x32_bf16 v[124:127], a[12:15], a[32:35], 0
  v_mfma_f32_16x16x32_bf16 v[132:135], a[12:15], a[36:39], 0
  buffer_load_dwordx4 v17, s[28:31], s46 offen offset:3072 lds
  s_add_u32 s46, s46, 262144
  v_mfma_f32_16x16x32_bf16 v[140:143], a[12:15], a[40:43], 0
  s_waitcnt lgkmcnt(2)
  s_and_b32 s65, s65, 3
  s_cselect_b32 s52, s66, s67
  s_add_u32 s49, s49, s52
  v_mfma_f32_16x16x32_bf16 v[144:147], a[0:3], a[16:19], 0
  s_add_u32 m0, s50, 4096
  ds_read_b64_tr_b16 a[8:9], v26 offset:0
  v_mfma_f32_16x16x32_bf16 v[152:155], a[0:3], a[20:23], 0
  ds_read_b64_tr_b16 a[10:11], v26 offset:2048
  v_mfma_f32_16x16x32_bf16 v[160:163], a[0:3], a[24:27], 0
  s_add_u32 s53, s47, 36864
  buffer_load_dwordx4 v30, s[24:27], s53 offen offset:0 lds
  v_mfma_f32_16x16x32_bf16 v[168:171], a[0:3], a[28:31], 0
  v_mfma_f32_16x16x32_bf16 v[176:179], a[0:3], a[32:35], 0
  v_mfma_f32_16x16x32_bf16 v[184:187], a[0:3], a[36:39], 0
  s_add_u32 s53, s47, 45056
  buffer_load_dwordx4 v31, s[24:27], s53 offen offset:1024 lds
  v_mfma_f32_16x16x32_bf16 v[192:195], a[0:3], a[40:43], 0
  s_waitcnt lgkmcnt(2)
  v_mfma_f32_16x16x32_bf16 v[148:151], a[4:7], a[16:19], 0
  ds_read_b64_tr_b16 a[12:13], v27 offset:0
  v_mfma_f32_16x16x32_bf16 v[156:159], a[4:7], a[20:23], 0
  ds_read_b64_tr_b16 a[14:15], v27 offset:2048
  v_mfma_f32_16x16x32_bf16 v[164:167], a[4:7], a[24:27], 0
  s_add_u32 s53, s47, 53248
  buffer_load_dwordx4 v30, s[24:27], s53 offen offset:2048 lds
  s_add_u32 s47, s47, 128
  v_mfma_f32_16x16x32_bf16 v[172:175], a[4:7], a[28:31], 0
  s_xor_b32 s50, s50, s57
  s_mov_b32 m0, s49
  s_add_u32 s65, s65, 1
  v_mfma_f32_16x16x32_bf16 v[180:183], a[4:7], a[32:35], 0
  v_mfma_f32_16x16x32_bf16 v[188:191], a[4:7], a[36:39], 0
  buffer_load_dwordx4 v14, s[28:31], s46 offen offset:0 lds
  v_mfma_f32_16x16x32_bf16 v[196:199], a[4:7], a[40:43], 0
  s_waitcnt lgkmcnt(2)
  v_mfma_f32_16x16x32_bf16 v[200:203], a[8:11], a[16:19], 0
  s_waitcnt vmcnt(13) lgkmcnt(0)
  s_barrier
  ds_read_b64_tr_b16 a[0:1], v20 offset:16384
  v_mfma_f32_16x16x32_bf16 v[208:211], a[8:11], a[20:23], 0
  ds_read_b64_tr_b16 a[2:3], v20 offset:18432
  v_mfma_f32_16x16x32_bf16 v[216:219], a[8:11], a[24:27], 0
  buffer_load_dwordx4 v15, s[28:31], s46 offen offset:1024 lds
  v_mfma_f32_16x16x32_bf16 v[224:227], a[8:11], a[28:31], 0
  v_mfma_f32_16x16x32_bf16 v[232:235], a[8:11], a[32:35], 0
  v_mfma_f32_16x16x32_bf16 v[240:243], a[8:11], a[36:39], 0
  buffer_load_dwordx4 v16, s[28:31], s46 offen offset:2048 lds
  v_mfma_f32_16x16x32_bf16 v[248:251], a[8:11], a[40:43], 0
  v_mfma_f32_16x16x32_bf16 v[204:207], a[12:15], a[16:19], 0
  ds_read_b64_tr_b16 a[4:5], v21 offset:16384
  v_mfma_f32_16x16x32_bf16 v[212:215], a[12:15], a[20:23], 0
  ds_read_b64_tr_b16 a[6:7], v21 offset:18432
  v_mfma_f32_16x16x32_bf16 v[220:223], a[12:15], a[24:27], 0
  buffer_load_dwordx4 v17, s[28:31], s46 offen offset:3072 lds
  s_add_u32 s46, s46, 262144
  v_mfma_f32_16x16x32_bf16 v[228:231], a[12:15], a[28:31], 0
  s_and_b32 s65, s65, 3
  s_cselect_b32 s52, s66, s67
  s_add_u32 s49, s49, s52
  v_mfma_f32_16x16x32_bf16 v[236:239], a[12:15], a[32:35], 0
  v_mfma_f32_16x16x32_bf16 v[244:247], a[12:15], a[36:39], 0
  v_mfma_f32_16x16x32_bf16 v[252:255], a[12:15], a[40:43], 0
  s_waitcnt lgkmcnt(2)
  v_mfma_f32_16x16x32_bf16 v[32:35], a[0:3], a[44:47], v[32:35]
  ds_read_b64_tr_b16 a[8:9], v22 offset:16384
  v_mfma_f32_16x16x32_bf16 v[40:43], a[0:3], a[48:51], v[40:43]
  s_mov_b32 m0, s49
  s_add_u32 s65, s65, 1
  ds_read_b64_tr_b16 a[10:11], v22 offset:18432
  v_mfma_f32_16x16x32_bf16 v[48:51], a[0:3], a[52:55], v[48:51]
  buffer_load_dwordx4 v14, s[28:31], s46 offen offset:0 lds
  v_mfma_f32_16x16x32_bf16 v[56:59], a[0:3], a[56:59], v[56:59]
  v_mfma_f32_16x16x32_bf16 v[64:67], a[0:3], a[60:63], v[64:67]
  v_mfma_f32_16x16x32_bf16 v[72:75], a[0:3], a[64:67], v[72:75]
  v_mfma_f32_16x16x32_bf16 v[80:83], a[0:3], a[68:71], v[80:83]
  s_waitcnt lgkmcnt(2)
  v_mfma_f32_16x16x32_bf16 v[36:39], a[4:7], a[44:47], v[36:39]
  ds_read_b64_tr_b16 a[12:13], v23 offset:16384
  v_mfma_f32_16x16x32_bf16 v[44:47], a[4:7], a[48:51], v[44:47]
  ds_read_b64_tr_b16 a[14:15], v23 offset:18432
  v_mfma_f32_16x16x32_bf16 v[52:55], a[4:7], a[52:55], v[52:55]
  buffer_load_dwordx4 v15, s[28:31], s46 offen offset:1024 lds
  v_mfma_f32_16x16x32_bf16 v[60:63], a[4:7], a[56:59], v[60:63]
  v_mfma_f32_16x16x32_bf16 v[68:71], a[4:7], a[60:63], v[68:71]
  v_mfma_f32_16x16x32_bf16 v[76:79], a[4:7], a[64:67], v[76:79]
  v_mfma_f32_16x16x32_bf16 v[84:87], a[4:7], a[68:71], v[84:87]
  s_waitcnt lgkmcnt(2)
  v_mfma_f32_16x16x32_bf16 v[88:91], a[8:11], a[44:47], v[88:91]
  ds_read_b64_tr_b16 a[0:1], v24 offset:16384
  v_mfma_f32_16x16x32_bf16 v[96:99], a[8:11], a[48:51], v[96:99]
  ds_read_b64_tr_b16 a[2:3], v24 offset:18432
  v_mfma_f32_16x16x32_bf16 v[104:107], a[8:11], a[52:55], v[104:107]
  buffer_load_dwordx4 v16, s[28:31], s46 offen offset:2048 lds
  v_mfma_f32_16x16x32_bf16 v[112:115], a[8:11], a[56:59], v[112:115]
  v_mfma_f32_16x16x32_bf16 v[120:123], a[8:11], a[60:63], v[120:123]
  v_mfma_f32_16x16x32_bf16 v[128:131], a[8:11], a[64:67], v[128:131]
  v_mfma_f32_16x16x32_bf16 v[136:139], a[8:11], a[68:71], v[136:139]
  s_waitcnt lgkmcnt(2)
  v_add_u32 v28, s59, v28
  v_add_u32 v29, s59, v29
  v_mfma_f32_16x16x32_bf16 v[92:95], a[12:15], a[44:47], v[92:95]
  s_sub_u32 s59, 0, s59
  ds_read_b64_tr_b16 a[4:5], v25 offset:16384
  v_mfma_f32_16x16x32_bf16 v[100:103], a[12:15], a[48:51], v[100:103]
  ds_read_b64_tr_b16 a[6:7], v25 offset:18432
  v_mfma_f32_16x16x32_bf16 v[108:111], a[12:15], a[52:55], v[108:111]
  buffer_load_dwordx4 v17, s[28:31], s46 offen offset:3072 lds
  s_add_u32 s46, s46, 262144
  v_mfma_f32_16x16x32_bf16 v[116:119], a[12:15], a[56:59], v[116:119]
  s_and_b32 s65, s65, 3
  s_cselect_b32 s52, s66, s67
  s_add_u32 s49, s49, s52
  v_mfma_f32_16x16x32_bf16 v[124:127], a[12:15], a[60:63], v[124:127]
  s_add_u32 m0, s50, 0
  v_mfma_f32_16x16x32_bf16 v[132:135], a[12:15], a[64:67], v[132:135]
  v_mfma_f32_16x16x32_bf16 v[140:143], a[12:15], a[68:71], v[140:143]
  s_waitcnt lgkmcnt(2)
  v_mfma_f32_16x16x32_bf16 v[144:147], a[0:3], a[44:47], v[144:147]
  ds_read_b64_tr_b16 a[8:9], v26 offset:16384
  v_mfma_f32_16x16x32_bf16 v[152:155], a[0:3], a[48:51], v[152:155]
  ds_read_b64_tr_b16 a[10:11], v26 offset:18432
  v_mfma_f32_16x16x32_bf16 v[160:163], a[0:3], a[52:55], v[160:163]
  s_add_u32 s53, s47, 0
  buffer_load_dwordx4 v30, s[24:27], s53 offen offset:0 lds
  v_mfma_f32_16x16x32_bf16 v[168:171], a[0:3], a[56:59], v[168:171]
  v_mfma_f32_16x16x32_bf16 v[176:179], a[0:3], a[60:63], v[176:179]
  v_add_u32 v20, s56, v20
  v_add_u32 v21, s56, v21
  v_mfma_f32_16x16x32_bf16 v[184:187], a[0:3], a[64:67], v[184:187]
  v_add_u32 v22, s56, v22
  v_add_u32 v23, s56, v23
  v_mfma_f32_16x16x32_bf16 v[192:195], a[0:3], a[68:71], v[192:195]
  s_waitcnt lgkmcnt(2)
  v_add_u32 v24, s56, v24
  v_add_u32 v25, s56, v25
  v_mfma_f32_16x16x32_bf16 v[148:151], a[4:7], a[44:47], v[148:151]
  ds_read_b64_tr_b16 a[12:13], v27 offset:16384
  v_add_u32 v26, s56, v26
  v_mfma_f32_16x16x32_bf16 v[156:159], a[4:7], a[48:51], v[156:159]
  ds_read_b64_tr_b16 a[14:15], v27 offset:18432
  v_mfma_f32_16x16x32_bf16 v[164:167], a[4:7], a[52:55], v[164:167]
  s_add_u32 s53, s47, 8192
  buffer_load_dwordx4 v31, s[24:27], s53 offen offset:1024 lds
  v_mfma_f32_16x16x32_bf16 v[172:175], a[4:7], a[56:59], v[172:175]
  v_mfma_f32_16x16x32_bf16 v[180:183], a[4:7], a[60:63], v[180:183]
  v_mfma_f32_16x16x32_bf16 v[188:191], a[4:7], a[64:67], v[188:191]
  v_add_u32 v27, s56, v27
  v_mfma_f32_16x16x32_bf16 v[196:199], a[4:7], a[68:71], v[196:199]
  s_waitcnt lgkmcnt(2)
  s_sub_u32 s56, 0, s56
  v_mfma_f32_16x16x32_bf16 v[200:203], a[8:11], a[44:47], v[200:203]
  s_waitcnt vmcnt(10) lgkmcnt(0)
  s_barrier
  ds_read_b64_tr_b16 a[0:1], v20 offset:0
  s_add_u32 s53, s47, 16384
  buffer_load_dwordx4 v30, s[24:27], s53 offen offset:2048 lds
  v_mfma_f32_16x16x32_bf16 v[208:211], a[8:11], a[48:51], v[208:211]
  ds_read_b64_tr_b16 a[2:3], v20 offset:2048
  v_mfma_f32_16x16x32_bf16 v[216:219], a[8:11], a[52:55], v[216:219]
  ds_read_b128 a[16:19], v28 offset:0
  v_mfma_f32_16x16x32_bf16 v[224:227], a[8:11], a[56:59], v[224:227]
  ds_read_b128 a[20:23], v28 offset:2048
  v_mfma_f32_16x16x32_bf16 v[232:235], a[8:11], a[60:63], v[232:235]
  ds_read_b128 a[24:27], v28 offset:4096
  v_mfma_f32_16x16x32_bf16 v[240:243], a[8:11], a[64:67], v[240:243]
  ds_read_b128 a[28:31], v28 offset:6144
  s_add_u32 s53, s47, 24576
  buffer_load_dwordx4 v31, s[24:27], s53 offen offset:3072 lds
  v_mfma_f32_16x16x32_bf16 v[248:251], a[8:11], a[68:71], v[248:251]
  s_mov_b32 m0, s17
  s_add_u32 s17, s17, 1088
  ds_read_b128 a[32:35], v28 offset:8192
  v_mfma_f32_16x16x32_bf16 v[204:207], a[12:15], a[44:47], v[204:207]
  ds_read_b128 a[36:39], v28 offset:10240
  v_mfma_f32_16x16x32_bf16 v[212:215], a[12:15], a[48:51], v[212:215]
  ds_read_b128 a[40:43], v28 offset:12288
  v_mfma_f32_16x16x32_bf16 v[220:223], a[12:15], a[52:55], v[220:223]
  ds_read_b64_tr_b16 a[4:5], v21 offset:0
  v_mfma_f32_16x16x32_bf16 v[228:231], a[12:15], a[56:59], v[228:231]
  ds_read_b64_tr_b16 a[6:7], v21 offset:2048
  v_mfma_f32_16x16x32_bf16 v[236:239], a[12:15], a[60:63], v[236:239]
  buffer_load_dwordx4 v2, s[32:35], s19 offen nt lds
  s_add_u32 s19, s19, 1024
  v_mfma_f32_16x16x32_bf16 v[244:247], a[12:15], a[64:67], v[244:247]
  v_mfma_f32_16x16x32_bf16 v[252:255], a[12:15], a[68:71], v[252:255]
attn_kernel_qloop:
  s_waitcnt lgkmcnt(8)
  v_mfma_f32_16x16x32_bf16 v[32:35], a[0:3], a[16:19], v[32:35]
  s_waitcnt lgkmcnt(7)
  ds_read_b64_tr_b16 a[8:9], v22 offset:0
  v_mfma_f32_16x16x32_bf16 v[40:43], a[0:3], a[20:23], v[40:43]
  s_waitcnt lgkmcnt(7)
  s_add_u32 m0, s50, 4096
  ds_read_b64_tr_b16 a[10:11], v22 offset:2048
  s_add_u32 s53, s47, 36864
  buffer_load_dwordx4 v30, s[24:27], s53 offen offset:0 lds
  v_mfma_f32_16x16x32_bf16 v[48:51], a[0:3], a[24:27], v[48:51]
  s_waitcnt lgkmcnt(7)
  ds_read_b128 a[44:47], v29 offset:0
  v_mfma_f32_16x16x32_bf16 v[56:59], a[0:3], a[28:31], v[56:59]
  s_waitcnt lgkmcnt(7)
  ds_read_b128 a[48:51], v29 offset:2048
  v_mfma_f32_16x16x32_bf16 v[64:67], a[0:3], a[32:35], v[64:67]
  s_waitcnt lgkmcnt(7)
  ds_read_b128 a[52:55], v29 offset:4096
  v_mfma_f32_16x16x32_bf16 v[72:75], a[0:3], a[36:39], v[72:75]
  s_waitcnt lgkmcnt(7)
  ds_read_b128 a[56:59], v29 offset:6144
  v_mfma_f32_16x16x32_bf16 v[80:83], a[0:3], a[40:43], v[80:83]
  s_waitcnt lgkmcnt(6)
  ds_read_b128 a[60:63], v29 offset:8192
  v_mfma_f32_16x16x32_bf16 v[36:39], a[4:7], a[16:19], v[36:39]
  ds_read_b64_tr_b16 a[12:13], v23 offset:0
  s_add_u32 s53, s47, 45056
  buffer_load_dwordx4 v31, s[24:27], s53 offen offset:1024 lds
  v_mfma_f32_16x16x32_bf16 v[44:47], a[4:7], a[20:23], v[44:47]
  ds_read_b64_tr_b16 a[14:15], v23 offset:2048
  v_mfma_f32_16x16x32_bf16 v[52:55], a[4:7], a[24:27], v[52:55]
  ds_read_b128 a[64:67], v29 offset:10240
  v_mfma_f32_16x16x32_bf16 v[60:63], a[4:7], a[28:31], v[60:63]
  ds_read_b128 a[68:71], v29 offset:12288
  v_mfma_f32_16x16x32_bf16 v[68:71], a[4:7], a[32:35], v[68:71]
  v_mfma_f32_16x16x32_bf16 v[76:79], a[4:7], a[36:39], v[76:79]
  v_mfma_f32_16x16x32_bf16 v[84:87], a[4:7], a[40:43], v[84:87]
  s_waitcnt lgkmcnt(9)
  s_add_u32 s53, s47, 53248
  buffer_load_dwordx4 v30, s[24:27], s53 offen offset:2048 lds
  s_add_u32 s47, s47, 128
  v_mfma_f32_16x16x32_bf16 v[88:91], a[8:11], a[16:19], v[88:91]
  s_xor_b32 s50, s50, s57
  ds_read_b64_tr_b16 a[0:1], v24 offset:0
  v_mfma_f32_16x16x32_bf16 v[96:99], a[8:11], a[20:23], v[96:99]
  s_mov_b32 m0, s49
  s_add_u32 s65, s65, 1
  ds_read_b64_tr_b16 a[2:3], v24 offset:2048
  v_mfma_f32_16x16x32_bf16 v[104:107], a[8:11], a[24:27], v[104:107]
  v_mfma_f32_16x16x32_bf16 v[112:115], a[8:11], a[28:31], v[112:115]
  v_mfma_f32_16x16x32_bf16 v[120:123], a[8:11], a[32:35], v[120:123]
  v_mfma_f32_16x16x32_bf16 v[128:131], a[8:11], a[36:39], v[128:131]
  buffer_load_dwordx4 v14, s[28:31], s46 offen offset:0 lds
  v_mfma_f32_16x16x32_bf16 v[136:139], a[8:11], a[40:43], v[136:139]
  s_waitcnt lgkmcnt(4)
  v_mfma_f32_16x16x32_bf16 v[92:95], a[12:15], a[16:19], v[92:95]
  ds_read_b64_tr_b16 a[4:5], v25 offset:0
  v_mfma_f32_16x16x32_bf16 v[100:103], a[12:15], a[20:23], v[100:103]
  ds_read_b64_tr_b16 a[6:7], v25 offset:2048
  v_mfma_f32_16x16x32_bf16 v[108:111], a[12:15], a[24:27], v[108:111]
  v_mfma_f32_16x16x32_bf16 v[116:119], a[12:15], a[28:31], v[116:119]
  v_mfma_f32_16x16x32_bf16 v[124:127], a[12:15], a[32:35], v[124:127]
  buffer_load_dwordx4 v15, s[28:31], s46 offen offset:1024 lds
  v_mfma_f32_16x16x32_bf16 v[132:135], a[12:15], a[36:39], v[132:135]
  v_mfma_f32_16x16x32_bf16 v[140:143], a[12:15], a[40:43], v[140:143]
  s_waitcnt lgkmcnt(2)
  v_mfma_f32_16x16x32_bf16 v[144:147], a[0:3], a[16:19], v[144:147]
  ds_read_b64_tr_b16 a[8:9], v26 offset:0
  v_mfma_f32_16x16x32_bf16 v[152:155], a[0:3], a[20:23], v[152:155]
  ds_read_b64_tr_b16 a[10:11], v26 offset:2048
  v_mfma_f32_16x16x32_bf16 v[160:163], a[0:3], a[24:27], v[160:163]
  v_mfma_f32_16x16x32_bf16 v[168:171], a[0:3], a[28:31], v[168:171]
  buffer_load_dwordx4 v16, s[28:31], s46 offen offset:2048 lds
  v_mfma_f32_16x16x32_bf16 v[176:179], a[0:3], a[32:35], v[176:179]
  v_mfma_f32_16x16x32_bf16 v[184:187], a[0:3], a[36:39], v[184:187]
  v_mfma_f32_16x16x32_bf16 v[192:195], a[0:3], a[40:43], v[192:195]
  s_waitcnt lgkmcnt(2)
  v_mfma_f32_16x16x32_bf16 v[148:151], a[4:7], a[16:19], v[148:151]
  ds_read_b64_tr_b16 a[12:13], v27 offset:0
  v_mfma_f32_16x16x32_bf16 v[156:159], a[4:7], a[20:23], v[156:159]
  ds_read_b64_tr_b16 a[14:15], v27 offset:2048
  v_mfma_f32_16x16x32_bf16 v[164:167], a[4:7], a[24:27], v[164:167]
  buffer_load_dwordx4 v17, s[28:31], s46 offen offset:3072 lds
  s_add_u32 s46, s46, 262144
  v_mfma_f32_16x16x32_bf16 v[172:175], a[4:7], a[28:31], v[172:175]
  s_and_b32 s65, s65, 3
  s_cselect_b32 s52, s66, s67
  s_add_u32 s49, s49, s52
  v_mfma_f32_16x16x32_bf16 v[180:183], a[4:7], a[32:35], v[180:183]
  v_mfma_f32_16x16x32_bf16 v[188:191], a[4:7], a[36:39], v[188:191]
  v_mfma_f32_16x16x32_bf16 v[196:199], a[4:7], a[40:43], v[196:199]
  s_waitcnt lgkmcnt(2)
  v_mfma_f32_16x16x32_bf16 v[200:203], a[8:11], a[16:19], v[200:203]
  s_waitcnt vmcnt(16) lgkmcnt(0)
  s_barrier
  ds_read_b64_tr_b16 a[0:1], v20 offset:16384
  v_mfma_f32_16x16x32_bf16 v[208:211], a[8:11], a[20:23], v[208:211]
  ds_read_b64_tr_b16 a[2:3], v20 offset:18432
  v_mfma_f32_16x16x32_bf16 v[216:219], a[8:11], a[24:27], v[216:219]
  v_mfma_f32_16x16x32_bf16 v[224:227], a[8:11], a[28:31], v[224:227]
  v_mfma_f32_16x16x32_bf16 v[232:235], a[8:11], a[32:35], v[232:235]
  v_mfma_f32_16x16x32_bf16 v[240:243], a[8:11], a[36:39], v[240:243]
  v_mfma_f32_16x16x32_bf16 v[248:251], a[8:11], a[40:43], v[248:251]
  v_mfma_f32_16x16x32_bf16 v[204:207], a[12:15], a[16:19], v[204:207]
  ds_read_b64_tr_b16 a[4:5], v21 offset:16384
  v_mfma_f32_16x16x32_bf16 v[212:215], a[12:15], a[20:23], v[212:215]
  ds_read_b64_tr_b16 a[6:7], v21 offset:18432
  v_mfma_f32_16x16x32_bf16 v[220:223], a[12:15], a[24:27], v[220:223]
  v_mfma_f32_16x16x32_bf16 v[228:231], a[12:15], a[28:31], v[228:231]
  v_mfma_f32_16x16x32_bf16 v[236:239], a[12:15], a[32:35], v[236:239]
  v_mfma_f32_16x16x32_bf16 v[244:247], a[12:15], a[36:39], v[244:247]
  v_mfma_f32_16x16x32_bf16 v[252:255], a[12:15], a[40:43], v[252:255]
  s_waitcnt lgkmcnt(2)
  v_mfma_f32_16x16x32_bf16 v[32:35], a[0:3], a[44:47], v[32:35]
  ds_read_b64_tr_b16 a[8:9], v22 offset:16384
  v_mfma_f32_16x16x32_bf16 v[40:43], a[0:3], a[48:51], v[40:43]
  s_mov_b32 m0, s49
  s_add_u32 s65, s65, 1
  ds_read_b64_tr_b16 a[10:11], v22 offset:18432
  v_mfma_f32_16x16x32_bf16 v[48:51], a[0:3], a[52:55], v[48:51]
  buffer_load_dwordx4 v14, s[28:31], s46 offen offset:0 lds
  v_mfma_f32_16x16x32_bf16 v[56:59], a[0:3], a[56:59], v[56:59]
  v_mfma_f32_16x16x32_bf16 v[64:67], a[0:3], a[60:63], v[64:67]
  v_mfma_f32_16x16x32_bf16 v[72:75], a[0:3], a[64:67], v[72:75]
  v_mfma_f32_16x16x32_bf16 v[80:83], a[0:3], a[68:71], v[80:83]
  s_waitcnt lgkmcnt(2)
  v_mfma_f32_16x16x32_bf16 v[36:39], a[4:7], a[44:47], v[36:39]
  ds_read_b64_tr_b16 a[12:13], v23 offset:16384
  v_mfma_f32_16x16x32_bf16 v[44:47], a[4:7], a[48:51], v[44:47]
  ds_read_b64_tr_b16 a[14:15], v23 offset:18432
  v_mfma_f32_16x16x32_bf16 v[52:55], a[4:7], a[52:55], v[52:55]
  buffer_load_dwordx4 v15, s[28:31], s46 offen offset:1024 lds
  v_mfma_f32_16x16x32_bf16 v[60:63], a[4:7], a[56:59], v[60:63]
  v_mfma_f32_16x16x32_bf16 v[68:71], a[4:7], a[60:63], v[68:71]
  v_mfma_f32_16x16x32_bf16 v[76:79], a[4:7], a[64:67], v[76:79]
  v_mfma_f32_16x16x32_bf16 v[84:87], a[4:7], a[68:71], v[84:87]
  s_waitcnt lgkmcnt(2)
  v_mfma_f32_16x16x32_bf16 v[88:91], a[8:11], a[44:47], v[88:91]
  ds_read_b64_tr_b16 a[0:1], v24 offset:16384
  v_mfma_f32_16x16x32_bf16 v[96:99], a[8:11], a[48:51], v[96:99]
  ds_read_b64_tr_b16 a[2:3], v24 offset:18432
  v_mfma_f32_16x16x32_bf16 v[104:107], a[8:11], a[52:55], v[104:107]
  buffer_load_dwordx4 v16, s[28:31], s46 offen offset:2048 lds
  v_mfma_f32_16x16x32_bf16 v[112:115], a[8:11], a[56:59], v[112:115]
  v_mfma_f32_16x16x32_bf16 v[120:123], a[8:11], a[60:63], v[120:123]
  v_mfma_f32_16x16x32_bf16 v[128:131], a[8:11], a[64:67], v[128:131]
  v_mfma_f32_16x16x32_bf16 v[136:139], a[8:11], a[68:71], v[136:139]
  s_waitcnt lgkmcnt(2)
  v_add_u32 v28, s59, v28
  v_add_u32 v29, s59, v29
  v_mfma_f32_16x16x32_bf16 v[92:95], a[12:15], a[44:47], v[92:95]
  s_sub_u32 s59, 0, s59
  ds_read_b64_tr_b16 a[4:5], v25 offset:16384
  v_mfma_f32_16x16x32_bf16 v[100:103], a[12:15], a[48:51], v[100:103]
  ds_read_b64_tr_b16 a[6:7], v25 offset:18432
  v_mfma_f32_16x16x32_bf16 v[108:111], a[12:15], a[52:55], v[108:111]
  buffer_load_dwordx4 v17, s[28:31], s46 offen offset:3072 lds
  s_add_u32 s46, s46, 262144
  v_mfma_f32_16x16x32_bf16 v[116:119], a[12:15], a[56:59], v[116:119]
  s_and_b32 s65, s65, 3
  s_cselect_b32 s52, s66, s67
  s_add_u32 s49, s49, s52
  v_mfma_f32_16x16x32_bf16 v[124:127], a[12:15], a[60:63], v[124:127]
  s_add_u32 m0, s50, 0
  v_mfma_f32_16x16x32_bf16 v[132:135], a[12:15], a[64:67], v[132:135]
  v_mfma_f32_16x16x32_bf16 v[140:143], a[12:15], a[68:71], v[140:143]
  s_waitcnt lgkmcnt(2)
  v_mfma_f32_16x16x32_bf16 v[144:147], a[0:3], a[44:47], v[144:147]
  ds_read_b64_tr_b16 a[8:9], v26 offset:16384
  v_mfma_f32_16x16x32_bf16 v[152:155], a[0:3], a[48:51], v[152:155]
  ds_read_b64_tr_b16 a[10:11], v26 offset:18432
  v_mfma_f32_16x16x32_bf16 v[160:163], a[0:3], a[52:55], v[160:163]
  s_add_u32 s53, s47, 0
  buffer_load_dwordx4 v30, s[24:27], s53 offen offset:0 lds
  v_mfma_f32_16x16x32_bf16 v[168:171], a[0:3], a[56:59], v[168:171]
  v_mfma_f32_16x16x32_bf16 v[176:179], a[0:3], a[60:63], v[176:179]
  v_add_u32 v20, s56, v20
  v_add_u32 v21, s56, v21
  v_mfma_f32_16x16x32_bf16 v[184:187], a[0:3], a[64:67], v[184:187]
  v_add_u32 v22, s56, v22
  v_add_u32 v23, s56, v23
  v_mfma_f32_16x16x32_bf16 v[192:195], a[0:3], a[68:71], v[192:195]
  s_waitcnt lgkmcnt(2)
  v_add_u32 v24, s56, v24
  v_add_u32 v25, s56, v25
  v_mfma_f32_16x16x32_bf16 v[148:151], a[4:7], a[44:47], v[148:151]
  ds_read_b64_tr_b16 a[12:13], v27 offset:16384
  v_add_u32 v26, s56, v26
  v_mfma_f32_16x16x32_bf16 v[156:159], a[4:7], a[48:51], v[156:159]
  ds_read_b64_tr_b16 a[14:15], v27 offset:18432
  v_mfma_f32_16x16x32_bf16 v[164:167], a[4:7], a[52:55], v[164:167]
  s_add_u32 s53, s47, 8192
  buffer_load_dwordx4 v31, s[24:27], s53 offen offset:1024 lds
  v_mfma_f32_16x16x32_bf16 v[172:175], a[4:7], a[56:59], v[172:175]
  v_mfma_f32_16x16x32_bf16 v[180:183], a[4:7], a[60:63], v[180:183]
  v_mfma_f32_16x16x32_bf16 v[188:191], a[4:7], a[64:67], v[188:191]
  v_add_u32 v27, s56, v27
  v_mfma_f32_16x16x32_bf16 v[196:199], a[4:7], a[68:71], v[196:199]
  s_waitcnt lgkmcnt(2)
  s_sub_u32 s56, 0, s56
  v_mfma_f32_16x16x32_bf16 v[200:203], a[8:11], a[44:47], v[200:203]
  s_waitcnt vmcnt(10) lgkmcnt(0)
  s_barrier
  ds_read_b64_tr_b16 a[0:1], v20 offset:0
  s_add_u32 s53, s47, 16384
  buffer_load_dwordx4 v30, s[24:27], s53 offen offset:2048 lds
  v_mfma_f32_16x16x32_bf16 v[208:211], a[8:11], a[48:51], v[208:211]
  ds_read_b64_tr_b16 a[2:3], v20 offset:2048
  v_mfma_f32_16x16x32_bf16 v[216:219], a[8:11], a[52:55], v[216:219]
  ds_read_b128 a[16:19], v28 offset:0
  v_mfma_f32_16x16x32_bf16 v[224:227], a[8:11], a[56:59], v[224:227]
  ds_read_b128 a[20:23], v28 offset:2048
  v_mfma_f32_16x16x32_bf16 v[232:235], a[8:11], a[60:63], v[232:235]
  ds_read_b128 a[24:27], v28 offset:4096
  v_mfma_f32_16x16x32_bf16 v[240:243], a[8:11], a[64:67], v[240:243]
  ds_read_b128 a[28:31], v28 offset:6144
  s_add_u32 s53, s47, 24576
  buffer_load_dwordx4 v31, s[24:27], s53 offen offset:3072 lds
  v_mfma_f32_16x16x32_bf16 v[248:251], a[8:11], a[68:71], v[248:251]
  s_mov_b32 m0, s17
  s_add_u32 s17, s17, 1088
  ds_read_b128 a[32:35], v28 offset:8192
  v_mfma_f32_16x16x32_bf16 v[204:207], a[12:15], a[44:47], v[204:207]
  ds_read_b128 a[36:39], v28 offset:10240
  v_mfma_f32_16x16x32_bf16 v[212:215], a[12:15], a[48:51], v[212:215]
  ds_read_b128 a[40:43], v28 offset:12288
  v_mfma_f32_16x16x32_bf16 v[220:223], a[12:15], a[52:55], v[220:223]
  ds_read_b64_tr_b16 a[4:5], v21 offset:0
  v_mfma_f32_16x16x32_bf16 v[228:231], a[12:15], a[56:59], v[228:231]
  ds_read_b64_tr_b16 a[6:7], v21 offset:2048
  v_mfma_f32_16x16x32_bf16 v[236:239], a[12:15], a[60:63], v[236:239]
  buffer_load_dwordx4 v2, s[32:35], s19 offen nt lds
  s_add_u32 s19, s19, 1024
  v_mfma_f32_16x16x32_bf16 v[244:247], a[12:15], a[64:67], v[244:247]
  v_mfma_f32_16x16x32_bf16 v[252:255], a[12:15], a[68:71], v[252:255]
  s_add_u32 s55, s55, 1
  s_cmp_lt_u32 s55, 6
  s_cbranch_scc1 attn_kernel_qloop
  s_waitcnt lgkmcnt(8)
  v_mfma_f32_16x16x32_bf16 v[32:35], a[0:3], a[16:19], v[32:35]
  s_waitcnt lgkmcnt(7)
  ds_read_b64_tr_b16 a[8:9], v22 offset:0
  v_mfma_f32_16x16x32_bf16 v[40:43], a[0:3], a[20:23], v[40:43]
  s_waitcnt lgkmcnt(7)
  s_add_u32 m0, s50, 4096
  ds_read_b64_tr_b16 a[10:11], v22 offset:2048
  s_add_u32 s53, s47, 36864
  buffer_load_dwordx4 v30, s[24:27], s53 offen offset:0 lds
  v_mfma_f32_16x16x32_bf16 v[48:51], a[0:3], a[24:27], v[48:51]
  s_waitcnt lgkmcnt(7)
  ds_read_b128 a[44:47], v29 offset:0
  v_mfma_f32_16x16x32_bf16 v[56:59], a[0:3], a[28:31], v[56:59]
  s_waitcnt lgkmcnt(7)
  ds_read_b128 a[48:51], v29 offset:2048
  v_mfma_f32_16x16x32_bf16 v[64:67], a[0:3], a[32:35], v[64:67]
  s_waitcnt lgkmcnt(7)
  ds_read_b128 a[52:55], v29 offset:4096
  v_mfma_f32_16x16x32_bf16 v[72:75], a[0:3], a[36:39], v[72:75]
  s_waitcnt lgkmcnt(7)
  ds_read_b128 a[56:59], v29 offset:6144
  v_mfma_f32_16x16x32_bf16 v[80:83], a[0:3], a[40:43], v[80:83]
  s_waitcnt lgkmcnt(6)
  ds_read_b128 a[60:63], v29 offset:8192
  s_add_u32 s53, s47, 45056
  buffer_load_dwordx4 v31, s[24:27], s53 offen offset:1024 lds
  v_mfma_f32_16x16x32_bf16 v[36:39], a[4:7], a[16:19], v[36:39]
  ds_read_b64_tr_b16 a[12:13], v23 offset:0
  v_mfma_f32_16x16x32_bf16 v[44:47], a[4:7], a[20:23], v[44:47]
  ds_read_b64_tr_b16 a[14:15], v23 offset:2048
  v_mfma_f32_16x16x32_bf16 v[52:55], a[4:7], a[24:27], v[52:55]
  ds_read_b128 a[64:67], v29 offset:10240
  v_mfma_f32_16x16x32_bf16 v[60:63], a[4:7], a[28:31], v[60:63]
  ds_read_b128 a[68:71], v29 offset:12288
  v_mfma_f32_16x16x32_bf16 v[68:71], a[4:7], a[32:35], v[68:71]
  s_add_u32 s53, s47, 53248
  buffer_load_dwordx4 v30, s[24:27], s53 offen offset:2048 lds
  s_add_u32 s47, s47, 128
  v_mfma_f32_16x16x32_bf16 v[76:79], a[4:7], a[36:39], v[76:79]
  s_xor_b32 s50, s50, s57
  s_mov_b32 m0, s49
  s_add_u32 s65, s65, 1
  v_mfma_f32_16x16x32_bf16 v[84:87], a[4:7], a[40:43], v[84:87]
  s_waitcnt lgkmcnt(9)
  v_mfma_f32_16x16x32_bf16 v[88:91], a[8:11], a[16:19], v[88:91]
  ds_read_b64_tr_b16 a[0:1], v24 offset:0
  v_mfma_f32_16x16x32_bf16 v[96:99], a[8:11], a[20:23], v[96:99]
  ds_read_b64_tr_b16 a[2:3], v24 offset:2048
  v_mfma_f32_16x16x32_bf16 v[104:107], a[8:11], a[24:27], v[104:107]
  buffer_load_dwordx4 v14, s[28:31], s46 offen offset:0 lds
  v_mfma_f32_16x16x32_bf16 v[112:115], a[8:11], a[28:31], v[112:115]
  v_mfma_f32_16x16x32_bf16 v[120:123], a[8:11], a[32:35], v[120:123]
  v_mfma_f32_16x16x32_bf16 v[128:131], a[8:11], a[36:39], v[128:131]
  v_mfma_f32_16x16x32_bf16 v[136:139], a[8:11], a[40:43], v[136:139]
  s_waitcnt lgkmcnt(4)
  v_mfma_f32_16x16x32_bf16 v[92:95], a[12:15], a[16:19], v[92:95]
  ds_read_b64_tr_b16 a[4:5], v25 offset:0
  v_mfma_f32_16x16x32_bf16 v[100:103], a[12:15], a[20:23], v[100:103]
  ds_read_b64_tr_b16 a[6:7], v25 offset:2048
  v_mfma_f32_16x16x32_bf16 v[108:111], a[12:15], a[24:27], v[108:111]
  buffer_load_dwordx4 v15, s[28:31], s46 offen offset:1024 lds
  v_mfma_f32_16x16x32_bf16 v[116:119], a[12:15], a[28:31], v[116:119]
  v_mfma_f32_16x16x32_bf16 v[124:127], a[12:15], a[32:35], v[124:127]
  v_mfma_f32_16x16x32_bf16 v[132:135], a[12:15], a[36:39], v[132:135]
  v_mfma_f32_16x16x32_bf16 v[140:143], a[12:15], a[40:43], v[140:143]
  s_waitcnt lgkmcnt(2)
  v_mfma_f32_16x16x32_bf16 v[144:147], a[0:3], a[16:19], v[144:147]
  ds_read_b64_tr_b16 a[8:9], v26 offset:0
  v_mfma_f32_16x16x32_bf16 v[152:155], a[0:3], a[20:23], v[152:155]
  ds_read_b64_tr_b16 a[10:11], v26 offset:2048
  v_mfma_f32_16x16x32_bf16 v[160:163], a[0:3], a[24:27], v[160:163]
  buffer_load_dwordx4 v16, s[28:31], s46 offen offset:2048 lds
  v_mfma_f32_16x16x32_bf16 v[168:171], a[0:3], a[28:31], v[168:171]
  v_mfma_f32_16x16x32_bf16 v[176:179], a[0:3], a[32:35], v[176:179]
  v_mfma_f32_16x16x32_bf16 v[184:187], a[0:3], a[36:39], v[184:187]
  v_mfma_f32_16x16x32_bf16 v[192:195], a[0:3], a[40:43], v[192:195]
  s_waitcnt lgkmcnt(2)
  v_mfma_f32_16x16x32_bf16 v[148:151], a[4:7], a[16:19], v[148:151]
  ds_read_b64_tr_b16 a[12:13], v27 offset:0
  v_mfma_f32_16x16x32_bf16 v[156:159], a[4:7], a[20:23], v[156:159]
  ds_read_b64_tr_b16 a[14:15], v27 offset:2048
  v_mfma_f32_16x16x32_bf16 v[164:167], a[4:7], a[24:27], v[164:167]
  buffer_load_dwordx4 v17, s[28:31], s46 offen offset:3072 lds
  s_add_u32 s46, s46, 262144
  v_mfma_f32_16x16x32_bf16 v[172:175], a[4:7], a[28:31], v[172:175]
  s_and_b32 s65, s65, 3
  s_cselect_b32 s52, s66, s67
  s_add_u32 s49, s49, s52
  v_mfma_f32_16x16x32_bf16 v[180:183], a[4:7], a[32:35], v[180:183]
  s_mov_b32 m0, s17
  s_add_u32 s17, s17, 1088
  v_mfma_f32_16x16x32_bf16 v[188:191], a[4:7], a[36:39], v[188:191]
  v_mfma_f32_16x16x32_bf16 v[196:199], a[4:7], a[40:43], v[196:199]
  s_waitcnt lgkmcnt(2)
  v_mfma_f32_16x16x32_bf16 v[200:203], a[8:11], a[16:19], v[200:203]
  s_waitcnt vmcnt(16) lgkmcnt(0)
  s_barrier
  ds_read_b64_tr_b16 a[0:1], v20 offset:16384
  v_mfma_f32_16x16x32_bf16 v[208:211], a[8:11], a[20:23], v[208:211]
  ds_read_b64_tr_b16 a[2:3], v20 offset:18432
  v_mfma_f32_16x16x32_bf16 v[216:219], a[8:11], a[24:27], v[216:219]
  buffer_load_dwordx4 v2, s[32:35], s19 offen nt lds
  s_add_u32 s19, s19, 1024
  v_mfma_f32_16x16x32_bf16 v[224:227], a[8:11], a[28:31], v[224:227]
  v_mfma_f32_16x16x32_bf16 v[232:235], a[8:11], a[32:35], v[232:235]
  v_mfma_f32_16x16x32_bf16 v[240:243], a[8:11], a[36:39], v[240:243]
  v_mfma_f32_16x16x32_bf16 v[248:251], a[8:11], a[40:43], v[248:251]
  v_mfma_f32_16x16x32_bf16 v[204:207], a[12:15], a[16:19], v[204:207]
  ds_read_b64_tr_b16 a[4:5], v21 offset:16384
  v_mfma_f32_16x16x32_bf16 v[212:215], a[12:15], a[20:23], v[212:215]
  ds_read_b64_tr_b16 a[6:7], v21 offset:18432
  v_mfma_f32_16x16x32_bf16 v[220:223], a[12:15], a[24:27], v[220:223]
  global_load_dword v0, v13, s[96:97]
  v_mfma_f32_16x16x32_bf16 v[228:231], a[12:15], a[28:31], v[228:231]
  v_mfma_f32_16x16x32_bf16 v[236:239], a[12:15], a[32:35], v[236:239]
  v_mfma_f32_16x16x32_bf16 v[244:247], a[12:15], a[36:39], v[244:247]
  v_mfma_f32_16x16x32_bf16 v[252:255], a[12:15], a[40:43], v[252:255]
  s_waitcnt lgkmcnt(2)
  v_mfma_f32_16x16x32_bf16 v[32:35], a[0:3], a[44:47], v[32:35]
  ds_read_b64_tr_b16 a[8:9], v22 offset:16384
  v_mfma_f32_16x16x32_bf16 v[40:43], a[0:3], a[48:51], v[40:43]
  s_add_u32 m0, s51, 0
  s_add_u32 s64, s64, 1
  ds_read_b64_tr_b16 a[10:11], v22 offset:18432
  v_mfma_f32_16x16x32_bf16 v[48:51], a[0:3], a[52:55], v[48:51]
  buffer_load_dwordx4 v2, s[32:35], s48 offen offset:0 nt lds
  v_mfma_f32_16x16x32_bf16 v[56:59], a[0:3], a[56:59], v[56:59]
  v_mfma_f32_16x16x32_bf16 v[64:67], a[0:3], a[60:63], v[64:67]
  v_mfma_f32_16x16x32_bf16 v[72:75], a[0:3], a[64:67], v[72:75]
  v_mfma_f32_16x16x32_bf16 v[80:83], a[0:3], a[68:71], v[80:83]
  s_waitcnt lgkmcnt(2)
  v_mfma_f32_16x16x32_bf16 v[36:39], a[4:7], a[44:47], v[36:39]
  ds_read_b64_tr_b16 a[12:13], v23 offset:16384
  v_mfma_f32_16x16x32_bf16 v[44:47], a[4:7], a[48:51], v[44:47]
  ds_read_b64_tr_b16 a[14:15], v23 offset:18432
  v_mfma_f32_16x16x32_bf16 v[52:55], a[4:7], a[52:55], v[52:55]
  buffer_load_dwordx4 v3, s[32:35], s48 offen offset:1088 nt lds
  v_mfma_f32_16x16x32_bf16 v[60:63], a[4:7], a[56:59], v[60:63]
  v_mfma_f32_16x16x32_bf16 v[68:71], a[4:7], a[60:63], v[68:71]
  v_mfma_f32_16x16x32_bf16 v[76:79], a[4:7], a[64:67], v[76:79]
  v_mfma_f32_16x16x32_bf16 v[84:87], a[4:7], a[68:71], v[84:87]
  s_waitcnt lgkmcnt(2)
  v_mfma_f32_16x16x32_bf16 v[88:91], a[8:11], a[44:47], v[88:91]
  ds_read_b64_tr_b16 a[0:1], v24 offset:16384
  v_mfma_f32_16x16x32_bf16 v[96:99], a[8:11], a[48:51], v[96:99]
  ds_read_b64_tr_b16 a[2:3], v24 offset:18432
  v_mfma_f32_16x16x32_bf16 v[104:107], a[8:11], a[52:55], v[104:107]
  buffer_load_dwordx4 v4, s[32:35], s48 offen offset:2176 nt lds
  v_mfma_f32_16x16x32_bf16 v[112:115], a[8:11], a[56:59], v[112:115]
  v_mfma_f32_16x16x32_bf16 v[120:123], a[8:11], a[60:63], v[120:123]
  v_mfma_f32_16x16x32_bf16 v[128:131], a[8:11], a[64:67], v[128:131]
  v_mfma_f32_16x16x32_bf16 v[136:139], a[8:11], a[68:71], v[136:139]
  s_waitcnt lgkmcnt(2)
  v_add_u32 v28, s59, v28
  v_add_u32 v29, s59, v29
  v_mfma_f32_16x16x32_bf16 v[92:95], a[12:15], a[44:47], v[92:95]
  s_sub_u32 s59, 0, s59
  ds_read_b64_tr_b16 a[4:5], v25 offset:16384
  v_mfma_f32_16x16x32_bf16 v[100:103], a[12:15], a[48:51], v[100:103]
  ds_read_b64_tr_b16 a[6:7], v25 offset:18432
  v_mfma_f32_16x16x32_bf16 v[108:111], a[12:15], a[52:55], v[108:111]
  buffer_load_dwordx4 v5, s[32:35], s48 offen offset:3264 nt lds
  v_mfma_f32_16x16x32_bf16 v[116:119], a[12:15], a[56:59], v[116:119]
  s_add_u32 m0, s51, 4352
  s_add_u32 s48, s48, 4096
  v_mfma_f32_16x16x32_bf16 v[124:127], a[12:15], a[60:63], v[124:127]
  v_mfma_f32_16x16x32_bf16 v[132:135], a[12:15], a[64:67], v[132:135]
  v_mfma_f32_16x16x32_bf16 v[140:143], a[12:15], a[68:71], v[140:143]
  s_waitcnt lgkmcnt(2)
  v_mfma_f32_16x16x32_bf16 v[144:147], a[0:3], a[44:47], v[144:147]
  ds_read_b64_tr_b16 a[8:9], v26 offset:16384
  v_mfma_f32_16x16x32_bf16 v[152:155], a[0:3], a[48:51], v[152:155]
  ds_read_b64_tr_b16 a[10:11], v26 offset:18432
  v_mfma_f32_16x16x32_bf16 v[160:163], a[0:3], a[52:55], v[160:163]
  buffer_load_dwordx4 v2, s[32:35], s48 offen offset:0 nt lds
  v_mfma_f32_16x16x32_bf16 v[168:171], a[0:3], a[56:59], v[168:171]
  v_mfma_f32_16x16x32_bf16 v[176:179], a[0:3], a[60:63], v[176:179]
  v_add_u32 v20, s56, v20
  v_add_u32 v21, s56, v21
  v_mfma_f32_16x16x32_bf16 v[184:187], a[0:3], a[64:67], v[184:187]
  v_add_u32 v22, s56, v22
  v_add_u32 v23, s56, v23
  v_mfma_f32_16x16x32_bf16 v[192:195], a[0:3], a[68:71], v[192:195]
  s_waitcnt lgkmcnt(2)
  v_add_u32 v24, s56, v24
  v_add_u32 v25, s56, v25
  v_mfma_f32_16x16x32_bf16 v[148:151], a[4:7], a[44:47], v[148:151]
  ds_read_b64_tr_b16 a[12:13], v27 offset:16384
  v_add_u32 v26, s56, v26
  v_mfma_f32_16x16x32_bf16 v[156:159], a[4:7], a[48:51], v[156:159]
  ds_read_b64_tr_b16 a[14:15], v27 offset:18432
  v_mfma_f32_16x16x32_bf16 v[164:167], a[4:7], a[52:55], v[164:167]
  buffer_load_dwordx4 v3, s[32:35], s48 offen offset:1088 nt lds
  v_mfma_f32_16x16x32_bf16 v[172:175], a[4:7], a[56:59], v[172:175]
  v_mfma_f32_16x16x32_bf16 v[180:183], a[4:7], a[60:63], v[180:183]
  v_mfma_f32_16x16x32_bf16 v[188:191], a[4:7], a[64:67], v[188:191]
  v_add_u32 v27, s56, v27
  v_mfma_f32_16x16x32_bf16 v[196:199], a[4:7], a[68:71], v[196:199]
  s_waitcnt lgkmcnt(2)
  s_sub_u32 s56, 0, s56
  v_mfma_f32_16x16x32_bf16 v[200:203], a[8:11], a[44:47], v[200:203]
  s_waitcnt vmcnt(8) lgkmcnt(0)
  s_barrier
  ds_read_b64_tr_b16 a[0:1], v20 offset:0
  v_mfma_f32_16x16x32_bf16 v[208:211], a[8:11], a[48:51], v[208:211]
  ds_read_b64_tr_b16 a[2:3], v20 offset:2048
  buffer_load_dwordx4 v4, s[32:35], s48 offen offset:2176 nt lds
  v_mfma_f32_16x16x32_bf16 v[216:219], a[8:11], a[52:55], v[216:219]
  ds_read_b128 a[16:19], v28 offset:0
  v_mfma_f32_16x16x32_bf16 v[224:227], a[8:11], a[56:59], v[224:227]
  ds_read_b128 a[20:23], v28 offset:2048
  v_mfma_f32_16x16x32_bf16 v[232:235], a[8:11], a[60:63], v[232:235]
  ds_read_b128 a[24:27], v28 offset:4096
  v_mfma_f32_16x16x32_bf16 v[240:243], a[8:11], a[64:67], v[240:243]
  ds_read_b128 a[28:31], v28 offset:6144
  v_mfma_f32_16x16x32_bf16 v[248:251], a[8:11], a[68:71], v[248:251]
  ds_read_b128 a[32:35], v28 offset:8192
  v_mfma_f32_16x16x32_bf16 v[204:207], a[12:15], a[44:47], v[204:207]
  ds_read_b128 a[36:39], v28 offset:10240
  buffer_load_dwordx4 v5, s[32:35], s48 offen offset:3264 nt lds
  v_mfma_f32_16x16x32_bf16 v[212:215], a[12:15], a[48:51], v[212:215]
  s_and_b32 s52, s64, 3
  s_cselect_b32 s52, s68, s69
  ds_read_b128 a[40:43], v28 offset:12288
  v_mfma_f32_16x16x32_bf16 v[220:223], a[12:15], a[52:55], v[220:223]
  s_add_u32 s48, s48, 4096
  s_add_u32 s51, s51, s52
  ds_read_b64_tr_b16 a[4:5], v21 offset:0
  v_mfma_f32_16x16x32_bf16 v[228:231], a[12:15], a[56:59], v[228:231]
  ds_read_b64_tr_b16 a[6:7], v21 offset:2048
  v_mfma_f32_16x16x32_bf16 v[236:239], a[12:15], a[60:63], v[236:239]
  v_mfma_f32_16x16x32_bf16 v[244:247], a[12:15], a[64:67], v[244:247]
  v_mfma_f32_16x16x32_bf16 v[252:255], a[12:15], a[68:71], v[252:255]
  s_waitcnt lgkmcnt(8)
  v_mfma_f32_16x16x32_bf16 v[32:35], a[0:3], a[16:19], v[32:35]
  s_waitcnt lgkmcnt(7)
  ds_read_b64_tr_b16 a[8:9], v20 offset:16384
  v_mfma_f32_16x16x32_bf16 v[40:43], a[0:3], a[20:23], v[40:43]
  s_waitcnt lgkmcnt(7)
  ds_read_b64_tr_b16 a[10:11], v20 offset:18432
  v_mfma_f32_16x16x32_bf16 v[48:51], a[0:3], a[24:27], v[48:51]
  s_waitcnt lgkmcnt(7)
  ds_read_b128 a[44:47], v29 offset:0
  v_mfma_f32_16x16x32_bf16 v[56:59], a[0:3], a[28:31], v[56:59]
  s_waitcnt lgkmcnt(7)
  ds_read_b128 a[48:51], v29 offset:2048
  v_mfma_f32_16x16x32_bf16 v[64:67], a[0:3], a[32:35], v[64:67]
  s_waitcnt lgkmcnt(7)
  ds_read_b128 a[52:55], v29 offset:4096
  v_mfma_f32_16x16x32_bf16 v[72:75], a[0:3], a[36:39], v[72:75]
  s_waitcnt lgkmcnt(7)
  ds_read_b128 a[56:59], v29 offset:6144
  v_mfma_f32_16x16x32_bf16 v[80:83], a[0:3], a[40:43], v[80:83]
  s_waitcnt lgkmcnt(6)
  ds_read_b128 a[60:63], v29 offset:8192
  v_mfma_f32_16x16x32_bf16 v[36:39], a[4:7], a[16:19], v[36:39]
  ds_read_b64_tr_b16 a[12:13], v21 offset:16384
  v_mfma_f32_16x16x32_bf16 v[44:47], a[4:7], a[20:23], v[44:47]
  ds_read_b64_tr_b16 a[14:15], v21 offset:18432
  v_mfma_f32_16x16x32_bf16 v[52:55], a[4:7], a[24:27], v[52:55]
  ds_read_b128 a[64:67], v29 offset:10240
  v_mfma_f32_16x16x32_bf16 v[60:63], a[4:7], a[28:31], v[60:63]
  ds_read_b128 a[68:71], v29 offset:12288
  v_mfma_f32_16x16x32_bf16 v[68:71], a[4:7], a[32:35], v[68:71]
  v_mfma_f32_16x16x32_bf16 v[76:79], a[4:7], a[36:39], v[76:79]
  v_mfma_f32_16x16x32_bf16 v[84:87], a[4:7], a[40:43], v[84:87]
  s_waitcnt lgkmcnt(8)
  v_mfma_f32_16x16x32_bf16 v[32:35], a[8:11], a[44:47], v[32:35]
  s_waitcnt lgkmcnt(7)
  ds_read_b64_tr_b16 a[0:1], v22 offset:0
  v_mfma_f32_16x16x32_bf16 v[40:43], a[8:11], a[48:51], v[40:43]
  s_waitcnt lgkmcnt(7)
  ds_read_b64_tr_b16 a[2:3], v22 offset:2048
  v_mfma_f32_16x16x32_bf16 v[48:51], a[8:11], a[52:55], v[48:51]
  s_waitcnt lgkmcnt(7)
  v_mfma_f32_16x16x32_bf16 v[56:59], a[8:11], a[56:59], v[56:59]
  s_waitcnt lgkmcnt(6)
  v_mfma_f32_16x16x32_bf16 v[64:67], a[8:11], a[60:63], v[64:67]
  s_waitcnt lgkmcnt(3)
  v_mfma_f32_16x16x32_bf16 v[72:75], a[8:11], a[64:67], v[72:75]
  s_waitcnt lgkmcnt(2)
  v_mfma_f32_16x16x32_bf16 v[80:83], a[8:11], a[68:71], v[80:83]
  s_barrier
  v_mfma_f32_16x16x32_bf16 v[36:39], a[12:15], a[44:47], v[36:39]
  ds_read_b64_tr_b16 a[4:5], v23 offset:0
  v_mfma_f32_16x16x32_bf16 v[44:47], a[12:15], a[48:51], v[44:47]
  ds_read_b64_tr_b16 a[6:7], v23 offset:2048
  v_mfma_f32_16x16x32_bf16 v[52:55], a[12:15], a[52:55], v[52:55]
  v_mfma_f32_16x16x32_bf16 v[60:63], a[12:15], a[56:59], v[60:63]
  v_mfma_f32_16x16x32_bf16 v[68:71], a[12:15], a[60:63], v[68:71]
  v_mul_f32 v32, s60, v32
  v_mul_f32 v33, s60, v33
  v_mfma_f32_16x16x32_bf16 v[76:79], a[12:15], a[64:67], v[76:79]
  v_mul_f32 v34, s60, v34
  v_mul_f32 v35, s60, v35
  v_mfma_f32_16x16x32_bf16 v[84:87], a[12:15], a[68:71], v[84:87]
  s_waitcnt lgkmcnt(2)
  v_mul_f32 v36, s60, v36
  v_mul_f32 v37, s60, v37
  v_mfma_f32_16x16x32_bf16 v[88:91], a[0:3], a[16:19], v[88:91]
  ds_read_b64_tr_b16 a[8:9], v22 offset:16384
  v_mul_f32 v38, s60, v38
  v_mul_f32 v56, s60, v56
  v_mul_f32 v57, s60, v57
  v_mul_f32 v58, s60, v58
  v_mul_f32 v59, s60, v59
  v_mul_f32 v60, s60, v60
  v_mul_f32 v61, s60, v61
  v_mul_f32 v62, s60, v62
  v_mul_f32 v63, s60, v63
  v_cvt_pk_bf16_f32 v56, v56, v57
  v_cvt_pk_bf16_f32 v57, v58, v59
  v_cvt_pk_bf16_f32 v58, v60, v61
  v_cvt_pk_bf16_f32 v59, v62, v63
  v_mfma_f32_16x16x32_bf16 v[96:99], a[0:3], a[20:23], v[96:99]
  ds_read_b64_tr_b16 a[10:11], v22 offset:18432
  v_mul_f32 v39, s60, v39
  v_mul_f32 v64, s60, v64
  v_mul_f32 v65, s60, v65
  v_mul_f32 v66, s60, v66
  v_mul_f32 v67, s60, v67
  v_mul_f32 v68, s60, v68
  v_mul_f32 v69, s60, v69
  v_mul_f32 v70, s60, v70
  v_mul_f32 v71, s60, v71
  v_cvt_pk_bf16_f32 v64, v64, v65
  v_cvt_pk_bf16_f32 v65, v66, v67
  v_cvt_pk_bf16_f32 v66, v68, v69
  v_cvt_pk_bf16_f32 v67, v70, v71
  v_mfma_f32_16x16x32_bf16 v[104:107], a[0:3], a[24:27], v[104:107]
  v_cvt_pk_bf16_f32 v32, v32, v33
  v_cvt_pk_bf16_f32 v33, v34, v35
  v_mul_f32 v72, s60, v72
  v_mul_f32 v73, s60, v73
  v_mul_f32 v74, s60, v74
  v_mul_f32 v75, s60, v75
  v_mul_f32 v76, s60, v76
  v_mul_f32 v77, s60, v77
  v_mul_f32 v78, s60, v78
  v_mul_f32 v79, s60, v79
  v_cvt_pk_bf16_f32 v72, v72, v73
  v_cvt_pk_bf16_f32 v73, v74, v75
  v_cvt_pk_bf16_f32 v74, v76, v77
  v_cvt_pk_bf16_f32 v75, v78, v79
  v_mfma_f32_16x16x32_bf16 v[112:115], a[0:3], a[28:31], v[112:115]
  v_cvt_pk_bf16_f32 v34, v36, v37
  v_cvt_pk_bf16_f32 v35, v38, v39
  v_mul_f32 v80, s60, v80
  v_mul_f32 v81, s60, v81
  v_mul_f32 v82, s60, v82
  v_mul_f32 v83, s60, v83
  v_mul_f32 v84, s60, v84
  v_mul_f32 v85, s60, v85
  v_mul_f32 v86, s60, v86
  v_mul_f32 v87, s60, v87
  v_cvt_pk_bf16_f32 v80, v80, v81
  v_cvt_pk_bf16_f32 v81, v82, v83
  v_cvt_pk_bf16_f32 v82, v84, v85
  v_cvt_pk_bf16_f32 v83, v86, v87
  v_mfma_f32_16x16x32_bf16 v[120:123], a[0:3], a[32:35], v[120:123]
  v_mul_f32 v40, s60, v40
  v_mul_f32 v41, s60, v41
  v_mfma_f32_16x16x32_bf16 v[128:131], a[0:3], a[36:39], v[128:131]
  v_permlane32_swap_b32 v32, v34
  v_permlane32_swap_b32 v33, v35
  v_mfma_f32_16x16x32_bf16 v[136:139], a[0:3], a[40:43], v[136:139]
  s_waitcnt lgkmcnt(2)
  v_mul_f32 v42, s60, v42
  v_mul_f32 v43, s60, v43
  v_mfma_f32_16x16x32_bf16 v[92:95], a[4:7], a[16:19], v[92:95]
  ds_read_b64_tr_b16 a[12:13], v23 offset:16384
  v_permlane16_swap_b32 v32, v34
  v_mfma_f32_16x16x32_bf16 v[100:103], a[4:7], a[20:23], v[100:103]
  ds_read_b64_tr_b16 a[14:15], v23 offset:18432
  v_permlane16_swap_b32 v33, v35
  v_mfma_f32_16x16x32_bf16 v[108:111], a[4:7], a[24:27], v[108:111]
  v_mul_f32 v44, s60, v44
  v_mul_f32 v45, s60, v45
  v_mfma_f32_16x16x32_bf16 v[116:119], a[4:7], a[28:31], v[116:119]
  v_mul_f32 v46, s60, v46
  v_mul_f32 v47, s60, v47
  v_cvt_pk_bf16_f32 v40, v40, v41
  v_cvt_pk_bf16_f32 v41, v42, v43
  v_cvt_pk_bf16_f32 v42, v44, v45
  v_cvt_pk_bf16_f32 v43, v46, v47
  v_mfma_f32_16x16x32_bf16 v[124:127], a[4:7], a[32:35], v[124:127]
  v_mul_f32 v48, s60, v48
  v_mul_f32 v49, s60, v49
  v_mul_f32 v50, s60, v50
  v_mul_f32 v51, s60, v51
  v_mul_f32 v52, s60, v52
  v_mul_f32 v53, s60, v53
  v_mul_f32 v54, s60, v54
  v_mul_f32 v55, s60, v55
  v_cvt_pk_bf16_f32 v48, v48, v49
  v_cvt_pk_bf16_f32 v49, v50, v51
  v_cvt_pk_bf16_f32 v50, v52, v53
  v_cvt_pk_bf16_f32 v51, v54, v55
  v_mfma_f32_16x16x32_bf16 v[132:135], a[4:7], a[36:39], v[132:135]
  v_permlane32_swap_b32 v40, v42
  v_permlane32_swap_b32 v41, v43
  v_mfma_f32_16x16x32_bf16 v[140:143], a[4:7], a[40:43], v[140:143]
  s_waitcnt lgkmcnt(2)
  v_permlane32_swap_b32 v48, v50
  v_permlane32_swap_b32 v49, v51
  v_mfma_f32_16x16x32_bf16 v[88:91], a[8:11], a[44:47], v[88:91]
  ds_read_b64_tr_b16 a[0:1], v24 offset:0
  v_permlane16_swap_b32 v40, v42
  v_mfma_f32_16x16x32_bf16 v[96:99], a[8:11], a[48:51], v[96:99]
  ds_read_b64_tr_b16 a[2:3], v24 offset:2048
  v_permlane16_swap_b32 v41, v43
  v_mfma_f32_16x16x32_bf16 v[104:107], a[8:11], a[52:55], v[104:107]
  v_permlane16_swap_b32 v48, v50
  v_permlane16_swap_b32 v49, v51
  v_mfma_f32_16x16x32_bf16 v[112:115], a[8:11], a[56:59], v[112:115]
  v_permlane32_swap_b32 v56, v58
  v_permlane32_swap_b32 v57, v59
  v_mfma_f32_16x16x32_bf16 v[120:123], a[8:11], a[60:63], v[120:123]
  v_permlane32_swap_b32 v64, v66
  v_permlane32_swap_b32 v65, v67
  v_mfma_f32_16x16x32_bf16 v[128:131], a[8:11], a[64:67], v[128:131]
  v_permlane16_swap_b32 v56, v58
  v_permlane16_swap_b32 v57, v59
  v_mfma_f32_16x16x32_bf16 v[136:139], a[8:11], a[68:71], v[136:139]
  s_waitcnt lgkmcnt(2)
  v_permlane16_swap_b32 v64, v66
  v_permlane16_swap_b32 v65, v67
  v_mfma_f32_16x16x32_bf16 v[92:95], a[12:15], a[44:47], v[92:95]
  ds_read_b64_tr_b16 a[4:5], v25 offset:0
  v_permlane32_swap_b32 v72, v74
  v_mfma_f32_16x16x32_bf16 v[100:103], a[12:15], a[48:51], v[100:103]
  ds_read_b64_tr_b16 a[6:7], v25 offset:2048
  v_permlane32_swap_b32 v73, v75
  v_mfma_f32_16x16x32_bf16 v[108:111], a[12:15], a[52:55], v[108:111]
  v_permlane32_swap_b32 v80, v82
  v_permlane32_swap_b32 v81, v83
  v_mfma_f32_16x16x32_bf16 v[116:119], a[12:15], a[56:59], v[116:119]
  v_permlane16_swap_b32 v72, v74
  v_permlane16_swap_b32 v73, v75
  v_mfma_f32_16x16x32_bf16 v[124:127], a[12:15], a[60:63], v[124:127]
  v_permlane16_swap_b32 v80, v82
  v_permlane16_swap_b32 v81, v83
  v_mfma_f32_16x16x32_bf16 v[132:135], a[12:15], a[64:67], v[132:135]
  v_mul_f32 v88, s60, v88
  v_mul_f32 v89, s60, v89
  v_mfma_f32_16x16x32_bf16 v[140:143], a[12:15], a[68:71], v[140:143]
  s_waitcnt lgkmcnt(2)
  v_mul_f32 v90, s60, v90
  v_mul_f32 v91, s60, v91
  v_mul_f32 v104, s60, v104
  v_mul_f32 v105, s60, v105
  v_mul_f32 v106, s60, v106
  v_mul_f32 v107, s60, v107
  v_mul_f32 v108, s60, v108
  v_mul_f32 v109, s60, v109
  v_mul_f32 v110, s60, v110
  v_mul_f32 v111, s60, v111
  v_cvt_pk_bf16_f32 v104, v104, v105
  v_cvt_pk_bf16_f32 v105, v106, v107
  v_cvt_pk_bf16_f32 v106, v108, v109
  v_cvt_pk_bf16_f32 v107, v110, v111
  v_mfma_f32_16x16x32_bf16 v[144:147], a[0:3], a[16:19], v[144:147]
  s_add_u32 m0, s51, 0
  s_add_u32 s64, s64, 1
  ds_read_b64_tr_b16 a[8:9], v24 offset:16384
  v_mul_f32 v112, s60, v112
  v_mul_f32 v113, s60, v113
  v_mul_f32 v114, s60, v114
  v_mul_f32 v115, s60, v115
  v_mul_f32 v116, s60, v116
  v_mul_f32 v117, s60, v117
  v_mul_f32 v118, s60, v118
  v_mul_f32 v119, s60, v119
  v_cvt_pk_bf16_f32 v112, v112, v113
  v_cvt_pk_bf16_f32 v113, v114, v115
  v_cvt_pk_bf16_f32 v114, v116, v117
  v_cvt_pk_bf16_f32 v115, v118, v119
  v_mfma_f32_16x16x32_bf16 v[152:155], a[0:3], a[20:23], v[152:155]
  ds_read_b64_tr_b16 a[10:11], v24 offset:18432
  v_mul_f32 v92, s60, v92
  v_mul_f32 v120, s60, v120
  v_mul_f32 v121, s60, v121
  v_mul_f32 v122, s60, v122
  v_mul_f32 v123, s60, v123
  v_mul_f32 v124, s60, v124
  v_mul_f32 v125, s60, v125
  v_mul_f32 v126, s60, v126
  v_mul_f32 v127, s60, v127
  v_cvt_pk_bf16_f32 v120, v120, v121
  v_cvt_pk_bf16_f32 v121, v122, v123
  v_cvt_pk_bf16_f32 v122, v124, v125
  v_cvt_pk_bf16_f32 v123, v126, v127
  v_mfma_f32_16x16x32_bf16 v[160:163], a[0:3], a[24:27], v[160:163]
  buffer_load_dwordx4 v2, s[32:35], s48 offen offset:0 nt lds
  v_mul_f32 v93, s60, v93
  v_mul_f32 v128, s60, v128
  v_mul_f32 v129, s60, v129
  v_mul_f32 v130, s60, v130
  v_mul_f32 v131, s60, v131
  v_mul_f32 v132, s60, v132
  v_mul_f32 v133, s60, v133
  v_mul_f32 v134, s60, v134
  v_mul_f32 v135, s60, v135
  v_cvt_pk_bf16_f32 v128, v128, v129
  v_cvt_pk_bf16_f32 v129, v130, v131
  v_cvt_pk_bf16_f32 v130, v132, v133
  v_cvt_pk_bf16_f32 v131, v134, v135
  v_mfma_f32_16x16x32_bf16 v[168:171], a[0:3], a[28:31], v[168:171]
  v_mul_f32 v94, s60, v94
  v_mul_f32 v95, s60, v95
  v_mul_f32 v136, s60, v136
  v_mul_f32 v137, s60, v137
  v_mul_f32 v138, s60, v138
  v_mul_f32 v139, s60, v139
  v_mul_f32 v140, s60, v140
  v_mul_f32 v141, s60, v141
  v_mul_f32 v142, s60, v142
  v_mul_f32 v143, s60, v143
  v_cvt_pk_bf16_f32 v136, v136, v137
  v_cvt_pk_bf16_f32 v137, v138, v139
  v_cvt_pk_bf16_f32 v138, v140, v141
  v_cvt_pk_bf16_f32 v139, v142, v143
  v_mfma_f32_16x16x32_bf16 v[176:179], a[0:3], a[32:35], v[176:179]
  s_waitcnt vmcnt(10)
  s_barrier
  v_cvt_pk_bf16_f32 v88, v88, v89
  v_cvt_pk_bf16_f32 v89, v90, v91
  v_mfma_f32_16x16x32_bf16 v[184:187], a[0:3], a[36:39], v[184:187]
  v_cvt_pk_bf16_f32 v90, v92, v93
  v_cvt_pk_bf16_f32 v91, v94, v95
  v_mfma_f32_16x16x32_bf16 v[192:195], a[0:3], a[40:43], v[192:195]
  s_waitcnt lgkmcnt(2)
  v_mul_f32 v96, s60, v96
  v_mul_f32 v97, s60, v97
  v_mfma_f32_16x16x32_bf16 v[148:151], a[4:7], a[16:19], v[148:151]
  ds_read_b64_tr_b16 a[12:13], v25 offset:16384
  v_permlane32_swap_b32 v88, v90
  v_mfma_f32_16x16x32_bf16 v[156:159], a[4:7], a[20:23], v[156:159]
  ds_read_b64_tr_b16 a[14:15], v25 offset:18432
  v_permlane32_swap_b32 v89, v91
  v_mfma_f32_16x16x32_bf16 v[164:167], a[4:7], a[24:27], v[164:167]
  buffer_load_dwordx4 v3, s[32:35], s48 offen offset:1088 nt lds
  v_mul_f32 v98, s60, v98
  v_mul_f32 v99, s60, v99
  v_mul_f32 v100, s60, v100
  v_mul_f32 v101, s60, v101
  v_mul_f32 v102, s60, v102
  v_mul_f32 v103, s60, v103
  v_cvt_pk_bf16_f32 v96, v96, v97
  v_cvt_pk_bf16_f32 v97, v98, v99
  v_cvt_pk_bf16_f32 v98, v100, v101
  v_cvt_pk_bf16_f32 v99, v102, v103
  v_mfma_f32_16x16x32_bf16 v[172:175], a[4:7], a[28:31], v[172:175]
  v_permlane16_swap_b32 v88, v90
  v_permlane16_swap_b32 v89, v91
  v_mfma_f32_16x16x32_bf16 v[180:183], a[4:7], a[32:35], v[180:183]
  v_permlane32_swap_b32 v96, v98
  v_permlane32_swap_b32 v97, v99
  v_mfma_f32_16x16x32_bf16 v[188:191], a[4:7], a[36:39], v[188:191]
  v_permlane32_swap_b32 v104, v106
  v_permlane32_swap_b32 v105, v107
  v_mfma_f32_16x16x32_bf16 v[196:199], a[4:7], a[40:43], v[196:199]
  s_waitcnt lgkmcnt(2)
  v_permlane16_swap_b32 v96, v98
  v_permlane16_swap_b32 v97, v99
  v_mfma_f32_16x16x32_bf16 v[144:147], a[8:11], a[44:47], v[144:147]
  ds_read_b64_tr_b16 a[0:1], v26 offset:0
  v_permlane16_swap_b32 v104, v106
  v_mfma_f32_16x16x32_bf16 v[152:155], a[8:11], a[48:51], v[152:155]
  ds_read_b64_tr_b16 a[2:3], v26 offset:2048
  v_permlane16_swap_b32 v105, v107
  v_mfma_f32_16x16x32_bf16 v[160:163], a[8:11], a[52:55], v[160:163]
  buffer_load_dwordx4 v4, s[32:35], s48 offen offset:2176 nt lds
  v_permlane32_swap_b32 v112, v114
  v_mfma_f32_16x16x32_bf16 v[168:171], a[8:11], a[56:59], v[168:171]
  v_permlane32_swap_b32 v113, v115
  v_permlane32_swap_b32 v120, v122
  v_mfma_f32_16x16x32_bf16 v[176:179], a[8:11], a[60:63], v[176:179]
  v_permlane32_swap_b32 v121, v123
  v_permlane32_swap_b32 v128, v130
  v_mfma_f32_16x16x32_bf16 v[184:187], a[8:11], a[64:67], v[184:187]
  v_permlane16_swap_b32 v112, v114
  v_permlane16_swap_b32 v113, v115
  v_mfma_f32_16x16x32_bf16 v[192:195], a[8:11], a[68:71], v[192:195]
  s_waitcnt lgkmcnt(2)
  v_permlane16_swap_b32 v120, v122
  v_permlane16_swap_b32 v121, v123
  v_mfma_f32_16x16x32_bf16 v[148:151], a[12:15], a[44:47], v[148:151]
  ds_read_b64_tr_b16 a[4:5], v27 offset:0
  v_permlane32_swap_b32 v129, v131
  v_mfma_f32_16x16x32_bf16 v[156:159], a[12:15], a[48:51], v[156:159]
  ds_read_b64_tr_b16 a[6:7], v27 offset:2048
  v_permlane32_swap_b32 v136, v138
  v_mfma_f32_16x16x32_bf16 v[164:167], a[12:15], a[52:55], v[164:167]
  buffer_load_dwordx4 v5, s[32:35], s48 offen offset:3264 nt lds
  v_permlane16_swap_b32 v128, v130
  v_mfma_f32_16x16x32_bf16 v[172:175], a[12:15], a[56:59], v[172:175]
  s_add_u32 m0, s51, 4352
  s_add_u32 s48, s48, 4096
  v_permlane16_swap_b32 v129, v131
  v_mfma_f32_16x16x32_bf16 v[180:183], a[12:15], a[60:63], v[180:183]
  v_permlane32_swap_b32 v137, v139
  v_mul_f32 v144, s60, v144
  v_mfma_f32_16x16x32_bf16 v[188:191], a[12:15], a[64:67], v[188:191]
  v_mul_f32 v145, s60, v145
  v_mul_f32 v146, s60, v146
  v_mfma_f32_16x16x32_bf16 v[196:199], a[12:15], a[68:71], v[196:199]
  s_waitcnt lgkmcnt(2)
  v_permlane16_swap_b32 v136, v138
  v_permlane16_swap_b32 v137, v139
  v_mul_f32 v160, s60, v160
  v_mul_f32 v161, s60, v161
  v_mul_f32 v162, s60, v162
  v_mul_f32 v163, s60, v163
  v_mul_f32 v164, s60, v164
  v_mul_f32 v165, s60, v165
  v_mul_f32 v166, s60, v166
  v_mul_f32 v167, s60, v167
  v_cvt_pk_bf16_f32 v160, v160, v161
  v_cvt_pk_bf16_f32 v161, v162, v163
  v_cvt_pk_bf16_f32 v162, v164, v165
  v_cvt_pk_bf16_f32 v163, v166, v167
  v_mfma_f32_16x16x32_bf16 v[200:203], a[0:3], a[16:19], v[200:203]
  ds_read_b64_tr_b16 a[8:9], v26 offset:16384
  v_mul_f32 v147, s60, v147
  v_mul_f32 v168, s60, v168
  v_mul_f32 v169, s60, v169
  v_mul_f32 v170, s60, v170
  v_mul_f32 v171, s60, v171
  v_mul_f32 v172, s60, v172
  v_mul_f32 v173, s60, v173
  v_mul_f32 v174, s60, v174
  v_mul_f32 v175, s60, v175
  v_cvt_pk_bf16_f32 v168, v168, v169
  v_cvt_pk_bf16_f32 v169, v170, v171
  v_cvt_pk_bf16_f32 v170, v172, v173
  v_cvt_pk_bf16_f32 v171, v174, v175
  v_mfma_f32_16x16x32_bf16 v[208:211], a[0:3], a[20:23], v[208:211]
  ds_read_b64_tr_b16 a[10:11], v26 offset:18432
  v_mul_f32 v148, s60, v148
  v_mul_f32 v176, s60, v176
  v_mul_f32 v177, s60, v177
  v_mul_f32 v178, s60, v178
  v_mul_f32 v179, s60, v179
  v_mul_f32 v180, s60, v180
  v_mul_f32 v181, s60, v181
  v_mul_f32 v182, s60, v182
  v_mul_f32 v183, s60, v183
  v_cvt_pk_bf16_f32 v176, v176, v177
  v_cvt_pk_bf16_f32 v177, v178, v179
  v_cvt_pk_bf16_f32 v178, v180, v181
  v_cvt_pk_bf16_f32 v179, v182, v183
  v_mfma_f32_16x16x32_bf16 v[216:219], a[0:3], a[24:27], v[216:219]
  buffer_load_dwordx4 v2, s[32:35], s48 offen offset:0 nt lds
  v_mul_f32 v149, s60, v149
  v_mul_f32 v184, s60, v184
  v_mul_f32 v185, s60, v185
  v_mul_f32 v186, s60, v186
  v_mul_f32 v187, s60, v187
  v_mul_f32 v188, s60, v188
  v_mul_f32 v189, s60, v189
  v_mul_f32 v190, s60, v190
  v_mul_f32 v191, s60, v191
  v_cvt_pk_bf16_f32 v184, v184, v185
  v_cvt_pk_bf16_f32 v185, v186, v187
  v_cvt_pk_bf16_f32 v186, v188, v189
  v_cvt_pk_bf16_f32 v187, v190, v191
  v_mfma_f32_16x16x32_bf16 v[224:227], a[0:3], a[28:31], v[224:227]
  v_mul_f32 v150, s60, v150
  v_mul_f32 v151, s60, v151
  v_mul_f32 v192, s60, v192
  v_mul_f32 v193, s60, v193
  v_mul_f32 v194, s60, v194
  v_mul_f32 v195, s60, v195
  v_mul_f32 v196, s60, v196
  v_mul_f32 v197, s60, v197
  v_mul_f32 v198, s60, v198
  v_mul_f32 v199, s60, v199
  v_cvt_pk_bf16_f32 v192, v192, v193
  v_cvt_pk_bf16_f32 v193, v194, v195
  v_cvt_pk_bf16_f32 v194, v196, v197
  v_cvt_pk_bf16_f32 v195, v198, v199
  v_mfma_f32_16x16x32_bf16 v[232:235], a[0:3], a[32:35], v[232:235]
  v_cvt_pk_bf16_f32 v144, v144, v145
  v_cvt_pk_bf16_f32 v145, v146, v147
  v_mfma_f32_16x16x32_bf16 v[240:243], a[0:3], a[36:39], v[240:243]
  v_cvt_pk_bf16_f32 v146, v148, v149
  v_cvt_pk_bf16_f32 v147, v150, v151
  v_mfma_f32_16x16x32_bf16 v[248:251], a[0:3], a[40:43], v[248:251]
  s_waitcnt lgkmcnt(2)
  v_mul_f32 v152, s60, v152
  v_mul_f32 v153, s60, v153
  v_mfma_f32_16x16x32_bf16 v[204:207], a[4:7], a[16:19], v[204:207]
  ds_read_b64_tr_b16 a[12:13], v27 offset:16384
  v_permlane32_swap_b32 v144, v146
  v_mfma_f32_16x16x32_bf16 v[212:215], a[4:7], a[20:23], v[212:215]
  ds_read_b64_tr_b16 a[14:15], v27 offset:18432
  v_permlane32_swap_b32 v145, v147
  v_mfma_f32_16x16x32_bf16 v[220:223], a[4:7], a[24:27], v[220:223]
  buffer_load_dwordx4 v3, s[32:35], s48 offen offset:1088 nt lds
  v_mul_f32 v154, s60, v154
  v_mul_f32 v155, s60, v155
  v_mul_f32 v156, s60, v156
  v_mul_f32 v157, s60, v157
  v_mul_f32 v158, s60, v158
  v_mul_f32 v159, s60, v159
  v_cvt_pk_bf16_f32 v152, v152, v153
  v_cvt_pk_bf16_f32 v153, v154, v155
  v_cvt_pk_bf16_f32 v154, v156, v157
  v_cvt_pk_bf16_f32 v155, v158, v159
  v_mfma_f32_16x16x32_bf16 v[228:231], a[4:7], a[28:31], v[228:231]
  v_permlane16_swap_b32 v144, v146
  v_permlane16_swap_b32 v145, v147
  v_mfma_f32_16x16x32_bf16 v[236:239], a[4:7], a[32:35], v[236:239]
  v_permlane32_swap_b32 v152, v154
  v_permlane32_swap_b32 v153, v155
  v_mfma_f32_16x16x32_bf16 v[244:247], a[4:7], a[36:39], v[244:247]
  v_permlane32_swap_b32 v160, v162
  v_permlane32_swap_b32 v161, v163
  v_mfma_f32_16x16x32_bf16 v[252:255], a[4:7], a[40:43], v[252:255]
  s_waitcnt lgkmcnt(2)
  v_permlane16_swap_b32 v152, v154
  v_permlane16_swap_b32 v153, v155
  v_mfma_f32_16x16x32_bf16 v[200:203], a[8:11], a[44:47], v[200:203]
  v_permlane16_swap_b32 v160, v162
  v_permlane16_swap_b32 v161, v163
  v_mfma_f32_16x16x32_bf16 v[208:211], a[8:11], a[48:51], v[208:211]
  buffer_load_dwordx4 v4, s[32:35], s48 offen offset:2176 nt lds
  v_permlane32_swap_b32 v168, v170
  v_mfma_f32_16x16x32_bf16 v[216:219], a[8:11], a[52:55], v[216:219]
  v_permlane32_swap_b32 v169, v171
  v_permlane32_swap_b32 v176, v178
  v_mfma_f32_16x16x32_bf16 v[224:227], a[8:11], a[56:59], v[224:227]
  v_permlane32_swap_b32 v177, v179
  v_permlane32_swap_b32 v184, v186
  v_mfma_f32_16x16x32_bf16 v[232:235], a[8:11], a[60:63], v[232:235]
  v_permlane16_swap_b32 v168, v170
  v_permlane16_swap_b32 v169, v171
  v_mfma_f32_16x16x32_bf16 v[240:243], a[8:11], a[64:67], v[240:243]
  v_permlane16_swap_b32 v176, v178
  v_permlane16_swap_b32 v177, v179
  v_mfma_f32_16x16x32_bf16 v[248:251], a[8:11], a[68:71], v[248:251]
  s_waitcnt lgkmcnt(0)
  v_permlane32_swap_b32 v185, v187
  v_permlane32_swap_b32 v192, v194
  v_mfma_f32_16x16x32_bf16 v[204:207], a[12:15], a[44:47], v[204:207]
  s_and_b32 s52, s64, 3
  s_cselect_b32 s52, s68, s69
  buffer_load_dwordx4 v5, s[32:35], s48 offen offset:3264 nt lds
  s_add_u32 s48, s48, 4096
  s_add_u32 s51, s51, s52
  v_mfma_f32_16x16x32_bf16 v[212:215], a[12:15], a[48:51], v[212:215]
  v_permlane16_swap_b32 v184, v186
  v_permlane16_swap_b32 v185, v187
  v_mfma_f32_16x16x32_bf16 v[220:223], a[12:15], a[52:55], v[220:223]
  ds_read_b128 v[36:39], v6 offset:0
  v_permlane32_swap_b32 v193, v195
  v_mfma_f32_16x16x32_bf16 v[228:231], a[12:15], a[56:59], v[228:231]
  ds_read_b128 v[44:47], v6 offset:64
  v_mfma_f32_16x16x32_bf16 v[236:239], a[12:15], a[60:63], v[236:239]
  v_permlane16_swap_b32 v192, v194
  v_permlane16_swap_b32 v193, v195
  v_mfma_f32_16x16x32_bf16 v[244:247], a[12:15], a[64:67], v[244:247]
  ds_read_b128 v[52:55], v6 offset:128
  v_mfma_f32_16x16x32_bf16 v[252:255], a[12:15], a[68:71], v[252:255]
  ds_read_b128 v[60:63], v6 offset:192
  ds_read_b128 v[68:71], v6 offset:4352
  ds_read_b128 v[76:79], v6 offset:4416
  ds_read_b128 v[84:87], v6 offset:4480
  ds_read_b128 v[92:95], v6 offset:4544
  ds_read_b64_tr_b16 v[100:101], v7 offset:0
  ds_read_b64_tr_b16 v[102:103], v7 offset:4352
  ds_read_b64_tr_b16 v[108:109], v8 offset:0
  ds_read_b64_tr_b16 v[110:111], v8 offset:4352
  ds_read_b64_tr_b16 v[116:117], v7 offset:64
  ds_read_b64_tr_b16 v[118:119], v7 offset:4416
  ds_read_b64_tr_b16 v[124:125], v8 offset:64
  ds_read_b64_tr_b16 v[126:127], v8 offset:4416
  ds_read_b64_tr_b16 v[132:133], v9 offset:0
  ds_read_b64_tr_b16 v[134:135], v9 offset:4352
  ds_read_b64_tr_b16 v[140:141], v10 offset:0
  ds_read_b64_tr_b16 v[142:143], v10 offset:4352
  ds_read_b64_tr_b16 v[148:149], v9 offset:64
  ds_read_b64_tr_b16 v[150:151], v9 offset:4416
  ds_read_b64_tr_b16 v[156:157], v10 offset:64
  ds_read_b64_tr_b16 v[158:159], v10 offset:4416
  s_mov_b32 s55, 0
  s_nop 4
  v_pk_mul_f32 v[200:201], v[200:201], s[60:61]
  v_pk_mul_f32 v[202:203], v[202:203], s[60:61]
  v_pk_mul_f32 v[204:205], v[204:205], s[60:61]
  v_pk_mul_f32 v[206:207], v[206:207], s[60:61]
  v_cvt_pk_bf16_f32 v200, v200, v201
  v_cvt_pk_bf16_f32 v201, v202, v203
  v_cvt_pk_bf16_f32 v202, v204, v205
  v_cvt_pk_bf16_f32 v203, v206, v207
  v_pk_mul_f32 v[208:209], v[208:209], s[60:61]
  v_pk_mul_f32 v[210:211], v[210:211], s[60:61]
  v_pk_mul_f32 v[212:213], v[212:213], s[60:61]
  v_pk_mul_f32 v[214:215], v[214:215], s[60:61]
  v_cvt_pk_bf16_f32 v208, v208, v209
  v_cvt_pk_bf16_f32 v209, v210, v211
  v_cvt_pk_bf16_f32 v210, v212, v213
  v_cvt_pk_bf16_f32 v211, v214, v215
  v_permlane32_swap_b32 v200, v202
  v_permlane32_swap_b32 v201, v203
  v_pk_mul_f32 v[216:217], v[216:217], s[60:61]
  v_pk_mul_f32 v[218:219], v[218:219], s[60:61]
  v_pk_mul_f32 v[220:221], v[220:221], s[60:61]
  v_pk_mul_f32 v[222:223], v[222:223], s[60:61]
  v_cvt_pk_bf16_f32 v216, v216, v217
  v_cvt_pk_bf16_f32 v217, v218, v219
  v_cvt_pk_bf16_f32 v218, v220, v221
  v_cvt_pk_bf16_f32 v219, v222, v223
  v_permlane32_swap_b32 v208, v210
  v_permlane32_swap_b32 v209, v211
  v_permlane16_swap_b32 v200, v202
  v_permlane16_swap_b32 v201, v203
  v_pk_mul_f32 v[224:225], v[224:225], s[60:61]
  v_pk_mul_f32 v[226:227], v[226:227], s[60:61]
  v_pk_mul_f32 v[228:229], v[228:229], s[60:61]
  v_pk_mul_f32 v[230:231], v[230:231], s[60:61]
  v_cvt_pk_bf16_f32 v224, v224, v225
  v_cvt_pk_bf16_f32 v225, v226, v227
  v_cvt_pk_bf16_f32 v226, v228, v229
  v_cvt_pk_bf16_f32 v227, v230, v231
  v_permlane32_swap_b32 v216, v218
  v_permlane32_swap_b32 v217, v219
  v_permlane16_swap_b32 v208, v210
  v_permlane16_swap_b32 v209, v211
  v_pk_mul_f32 v[232:233], v[232:233], s[60:61]
  v_pk_mul_f32 v[234:235], v[234:235], s[60:61]
  v_pk_mul_f32 v[236:237], v[236:237], s[60:61]
  v_pk_mul_f32 v[238:239], v[238:239], s[60:61]
  v_cvt_pk_bf16_f32 v232, v232, v233
  v_cvt_pk_bf16_f32 v233, v234, v235
  v_cvt_pk_bf16_f32 v234, v236, v237
  v_cvt_pk_bf16_f32 v235, v238, v239
  v_permlane32_swap_b32 v224, v226
  v_permlane32_swap_b32 v225, v227
  v_permlane16_swap_b32 v216, v218
  v_permlane16_swap_b32 v217, v219
  v_pk_mul_f32 v[240:241], v[240:241], s[60:61]
  v_pk_mul_f32 v[242:243], v[242:243], s[60:61]
  v_pk_mul_f32 v[244:245], v[244:245], s[60:61]
  v_pk_mul_f32 v[246:247], v[246:247], s[60:61]
  v_cvt_pk_bf16_f32 v240, v240, v241
  v_cvt_pk_bf16_f32 v241, v242, v243
  v_cvt_pk_bf16_f32 v242, v244, v245
  v_cvt_pk_bf16_f32 v243, v246, v247
  v_permlane32_swap_b32 v232, v234
  v_permlane32_swap_b32 v233, v235
  v_permlane16_swap_b32 v224, v226
  v_permlane16_swap_b32 v225, v227
  v_pk_mul_f32 v[248:249], v[248:249], s[60:61]
  v_pk_mul_f32 v[250:251], v[250:251], s[60:61]
  v_pk_mul_f32 v[252:253], v[252:253], s[60:61]
  v_pk_mul_f32 v[254:255], v[254:255], s[60:61]
  v_cvt_pk_bf16_f32 v248, v248, v249
  v_cvt_pk_bf16_f32 v249, v250, v251
  v_cvt_pk_bf16_f32 v250, v252, v253
  v_cvt_pk_bf16_f32 v251, v254, v255
  v_permlane32_swap_b32 v240, v242
  v_permlane32_swap_b32 v241, v243
  v_permlane16_swap_b32 v232, v234
  v_permlane16_swap_b32 v233, v235
  s_nop 1
  v_permlane32_swap_b32 v248, v250
  v_permlane32_swap_b32 v249, v251
  v_permlane16_swap_b32 v240, v242
  v_permlane16_swap_b32 v241, v243
  s_nop 1
  v_permlane16_swap_b32 v248, v250
  v_permlane16_swap_b32 v249, v251
  s_waitcnt lgkmcnt(15)
  v_mfma_f32_16x16x32_bf16 v[164:167], v[36:39], v[32:35], 0
  s_waitcnt lgkmcnt(15)
  v_mfma_f32_16x16x32_bf16 v[164:167], v[44:47], v[88:91], v[164:167]
  s_waitcnt lgkmcnt(15)
  v_mfma_f32_16x16x32_bf16 v[164:167], v[52:55], v[144:147], v[164:167]
  s_waitcnt lgkmcnt(15)
  v_mfma_f32_16x16x32_bf16 v[164:167], v[60:63], v[200:203], v[164:167]
  s_waitcnt lgkmcnt(15)
  v_mfma_f32_16x16x32_bf16 v[172:175], v[68:71], v[32:35], 0
  s_waitcnt lgkmcnt(15)
  v_mfma_f32_16x16x32_bf16 v[172:175], v[76:79], v[88:91], v[172:175]
  s_waitcnt lgkmcnt(15)
  v_mfma_f32_16x16x32_bf16 v[172:175], v[84:87], v[144:147], v[172:175]
  s_waitcnt lgkmcnt(15)
  v_mfma_f32_16x16x32_bf16 v[172:175], v[92:95], v[200:203], v[172:175]
  v_mfma_f32_16x16x32_bf16 v[180:183], v[36:39], v[40:43], 0
  v_mfma_f32_16x16x32_bf16 v[180:183], v[44:47], v[96:99], v[180:183]
  v_max3_f32 v11, v164, v165, v166
  s_nop 4
  v_max3_f32 v11, v11, v167, v172
  v_max3_f32 v11, v11, v173, v174
  v_max_f32 v11, v11, v175
  v_mov_b32 v12, v11
  s_nop 1
  v_permlane32_swap_b32 v12, v11
  v_mfma_f32_16x16x32_bf16 v[180:183], v[52:55], v[152:155], v[180:183]
  v_max_f32 v11, v12, v11
  v_mov_b32 v12, v11
  s_nop 1
  v_permlane16_swap_b32 v12, v11
  v_max_f32 v11, v12, v11
  v_sub_f32 v164, v164, v11
  v_sub_f32 v165, v165, v11
  v_mfma_f32_16x16x32_bf16 v[180:183], v[60:63], v[208:211], v[180:183]
  v_sub_f32 v166, v166, v11
  v_sub_f32 v167, v167, v11
  v_sub_f32 v172, v172, v11
  v_sub_f32 v173, v173, v11
  v_sub_f32 v174, v174, v11
  v_sub_f32 v175, v175, v11
  v_mfma_f32_16x16x32_bf16 v[188:191], v[68:71], v[40:43], 0
  v_exp_f32 v164, v164
  v_exp_f32 v165, v165
  v_exp_f32 v166, v166
  v_exp_f32 v167, v167
  v_exp_f32 v172, v172
  v_exp_f32 v173, v173
  v_mfma_f32_16x16x32_bf16 v[188:191], v[76:79], v[96:99], v[188:191]
  v_exp_f32 v174, v174
  v_exp_f32 v175, v175
  v_sub_f32 v212, 0, v11
  v_sub_f32 v213, 0, v11
  v_sub_f32 v214, 0, v11
  v_sub_f32 v215, 0, v11
  v_mfma_f32_16x16x32_bf16 v[188:191], v[84:87], v[152:155], v[188:191]
  v_cvt_pk_bf16_f32 v24, v164, v165
  v_cvt_pk_bf16_f32 v25, v166, v167
  v_cvt_pk_bf16_f32 v26, v172, v173
  v_cvt_pk_bf16_f32 v27, v174, v175
  v_mfma_f32_16x16x32_bf16 v[188:191], v[92:95], v[208:211], v[188:191]
  s_waitcnt lgkmcnt(14)
  v_mfma_f32_16x16x32_bf16 a[0:3], v[100:103], v[24:27], 0
  s_waitcnt lgkmcnt(12)
  v_mfma_f32_16x16x32_bf16 a[4:7], v[108:111], v[24:27], 0
  s_waitcnt lgkmcnt(10)
  v_max3_f32 v11, v180, v181, v182
  s_nop 1
  v_max3_f32 v11, v11, v183, v188
  v_max3_f32 v11, v11, v189, v190
  v_mfma_f32_16x16x32_bf16 a[8:11], v[116:119], v[24:27], 0
  s_waitcnt lgkmcnt(8)
  v_max_f32 v11, v11, v191
  v_mov_b32 v12, v11
  v_mfma_f32_16x16x32_bf16 a[12:15], v[124:127], v[24:27], 0
  s_waitcnt lgkmcnt(6)
  v_permlane32_swap_b32 v12, v11
  v_max_f32 v11, v12, v11
  v_mfma_f32_16x16x32_bf16 a[16:19], v[132:135], v[24:27], 0
  s_waitcnt lgkmcnt(4)
  v_mov_b32 v12, v11
  s_nop 1
  v_permlane16_swap_b32 v12, v11
  v_mfma_f32_16x16x32_bf16 a[20:23], v[140:143], v[24:27], 0
  s_waitcnt lgkmcnt(2)
  v_max_f32 v11, v12, v11
  v_sub_f32 v180, v180, v11
  v_mfma_f32_16x16x32_bf16 a[24:27], v[148:151], v[24:27], 0
  s_waitcnt lgkmcnt(0)
  v_sub_f32 v181, v181, v11
  v_sub_f32 v182, v182, v11
  v_mfma_f32_16x16x32_bf16 a[28:31], v[156:159], v[24:27], 0
  v_sub_f32 v183, v183, v11
  v_sub_f32 v188, v188, v11
  v_mfma_f32_16x16x32_bf16 a[224:227], a[252:255], v[24:27], 0
  v_sub_f32 v189, v189, v11
  v_sub_f32 v190, v190, v11
  v_sub_f32 v191, v191, v11
  v_mfma_f32_16x16x32_bf16 v[164:167], v[36:39], v[48:51], 0
  v_exp_f32 v180, v180
  v_exp_f32 v181, v181
  v_mfma_f32_16x16x32_bf16 v[164:167], v[44:47], v[104:107], v[164:167]
  v_exp_f32 v182, v182
  v_exp_f32 v183, v183
  v_mfma_f32_16x16x32_bf16 v[164:167], v[52:55], v[160:163], v[164:167]
  v_exp_f32 v188, v188
  v_exp_f32 v189, v189
  v_mfma_f32_16x16x32_bf16 v[164:167], v[60:63], v[216:219], v[164:167]
  v_exp_f32 v190, v190
  v_exp_f32 v191, v191
  v_mfma_f32_16x16x32_bf16 v[172:175], v[68:71], v[48:51], 0
  v_sub_f32 v220, 0, v11
  v_sub_f32 v221, 0, v11
  v_mfma_f32_16x16x32_bf16 v[172:175], v[76:79], v[104:107], v[172:175]
  v_sub_f32 v222, 0, v11
  v_sub_f32 v223, 0, v11
  v_mfma_f32_16x16x32_bf16 v[172:175], v[84:87], v[160:163], v[172:175]
  v_cvt_pk_bf16_f32 v24, v180, v181
  v_cvt_pk_bf16_f32 v25, v182, v183
  v_cvt_pk_bf16_f32 v26, v188, v189
  v_cvt_pk_bf16_f32 v27, v190, v191
  v_mfma_f32_16x16x32_bf16 v[172:175], v[92:95], v[216:219], v[172:175]
  s_nop 0
  v_mfma_f32_16x16x32_bf16 a[32:35], v[100:103], v[24:27], 0
  s_add_u32 s63, s63, 1
  s_and_b32 s63, s63, 3
  s_cselect_b32 s70, s68, s69
  v_mfma_f32_16x16x32_bf16 a[36:39], v[108:111], v[24:27], 0
  s_waitcnt vmcnt(8)
  s_barrier
  v_max3_f32 v11, v164, v165, v166
  v_max3_f32 v11, v11, v167, v172
  v_max3_f32 v11, v11, v173, v174
  v_mfma_f32_16x16x32_bf16 a[40:43], v[116:119], v[24:27], 0
  s_add_u32 m0, s51, 0
  s_add_u32 s64, s64, 1
  buffer_load_dwordx4 v2, s[32:35], s48 offen offset:0 nt lds
  v_max_f32 v11, v11, v175
  v_mov_b32 v12, v11
  v_mfma_f32_16x16x32_bf16 a[44:47], v[124:127], v[24:27], 0
  s_nop 0
  v_permlane32_swap_b32 v12, v11
  v_max_f32 v11, v12, v11
  v_mfma_f32_16x16x32_bf16 a[48:51], v[132:135], v[24:27], 0
  v_mov_b32 v12, v11
  s_nop 1
  v_permlane16_swap_b32 v12, v11
  v_mfma_f32_16x16x32_bf16 a[52:55], v[140:143], v[24:27], 0
  v_max_f32 v11, v12, v11
  v_sub_f32 v164, v164, v11
  v_mfma_f32_16x16x32_bf16 a[56:59], v[148:151], v[24:27], 0
  v_sub_f32 v165, v165, v11
  v_sub_f32 v166, v166, v11
  v_mfma_f32_16x16x32_bf16 a[60:63], v[156:159], v[24:27], 0
  buffer_load_dwordx4 v3, s[32:35], s48 offen offset:1088 nt lds
  v_sub_f32 v167, v167, v11
  v_sub_f32 v172, v172, v11
  v_mfma_f32_16x16x32_bf16 a[228:231], a[252:255], v[24:27], 0
  v_sub_f32 v173, v173, v11
  v_sub_f32 v174, v174, v11
  v_sub_f32 v175, v175, v11
  v_mfma_f32_16x16x32_bf16 v[180:183], v[36:39], v[56:59], 0
  v_exp_f32 v164, v164
  v_exp_f32 v165, v165
  v_mfma_f32_16x16x32_bf16 v[180:183], v[44:47], v[112:115], v[180:183]
  v_exp_f32 v166, v166
  v_exp_f32 v167, v167
  v_mfma_f32_16x16x32_bf16 v[180:183], v[52:55], v[168:171], v[180:183]
  v_exp_f32 v172, v172
  v_exp_f32 v173, v173
  v_mfma_f32_16x16x32_bf16 v[180:183], v[60:63], v[224:227], v[180:183]
  buffer_load_dwordx4 v4, s[32:35], s48 offen offset:2176 nt lds
  v_exp_f32 v174, v174
  v_exp_f32 v175, v175
  v_mfma_f32_16x16x32_bf16 v[188:191], v[68:71], v[56:59], 0
  v_sub_f32 v228, 0, v11
  v_sub_f32 v229, 0, v11
  v_mfma_f32_16x16x32_bf16 v[188:191], v[76:79], v[112:115], v[188:191]
  v_sub_f32 v230, 0, v11
  v_sub_f32 v231, 0, v11
  v_mfma_f32_16x16x32_bf16 v[188:191], v[84:87], v[168:171], v[188:191]
  v_cvt_pk_bf16_f32 v24, v164, v165
  v_cvt_pk_bf16_f32 v25, v166, v167
  v_cvt_pk_bf16_f32 v26, v172, v173
  v_cvt_pk_bf16_f32 v27, v174, v175
  v_mfma_f32_16x16x32_bf16 v[188:191], v[92:95], v[224:227], v[188:191]
  v_add_u32 v7, s70, v7
  v_add_u32 v8, s70, v8
  v_mfma_f32_16x16x32_bf16 a[64:67], v[100:103], v[24:27], 0
  buffer_load_dwordx4 v5, s[32:35], s48 offen offset:3264 nt lds
  s_add_u32 m0, s51, 4352
  s_add_u32 s48, s48, 4096
  v_mfma_f32_16x16x32_bf16 a[68:71], v[108:111], v[24:27], 0
  s_add_u32 s62, s62, 1
  v_max3_f32 v11, v180, v181, v182
  v_max3_f32 v11, v11, v183, v188
  v_max3_f32 v11, v11, v189, v190
  v_mfma_f32_16x16x32_bf16 a[72:75], v[116:119], v[24:27], 0
  v_max_f32 v11, v11, v191
  v_mov_b32 v12, v11
  v_mfma_f32_16x16x32_bf16 a[76:79], v[124:127], v[24:27], 0
  s_nop 0
  v_permlane32_swap_b32 v12, v11
  v_max_f32 v11, v12, v11
  v_mfma_f32_16x16x32_bf16 a[80:83], v[132:135], v[24:27], 0
  v_mov_b32 v12, v11
  s_nop 1
  v_permlane16_swap_b32 v12, v11
  v_mfma_f32_16x16x32_bf16 a[84:87], v[140:143], v[24:27], 0
  buffer_load_dwordx4 v2, s[32:35], s48 offen offset:0 nt lds
  v_max_f32 v11, v12, v11
  v_sub_f32 v180, v180, v11
  v_mfma_f32_16x16x32_bf16 a[88:91], v[148:151], v[24:27], 0
  v_sub_f32 v181, v181, v11
  v_sub_f32 v182, v182, v11
  v_mfma_f32_16x16x32_bf16 a[92:95], v[156:159], v[24:27], 0
  v_sub_f32 v183, v183, v11
  v_sub_f32 v188, v188, v11
  v_mfma_f32_16x16x32_bf16 a[232:235], a[252:255], v[24:27], 0
  v_sub_f32 v189, v189, v11
  v_sub_f32 v190, v190, v11
  v_sub_f32 v191, v191, v11
  v_mfma_f32_16x16x32_bf16 v[164:167], v[36:39], v[64:67], 0
  v_exp_f32 v180, v180
  v_exp_f32 v181, v181
  v_mfma_f32_16x16x32_bf16 v[164:167], v[44:47], v[120:123], v[164:167]
  buffer_load_dwordx4 v3, s[32:35], s48 offen offset:1088 nt lds
  v_exp_f32 v182, v182
  v_exp_f32 v183, v183
  v_mfma_f32_16x16x32_bf16 v[164:167], v[52:55], v[176:179], v[164:167]
  v_exp_f32 v188, v188
  v_exp_f32 v189, v189
  v_mfma_f32_16x16x32_bf16 v[164:167], v[60:63], v[232:235], v[164:167]
  v_exp_f32 v190, v190
  v_exp_f32 v191, v191
  v_mfma_f32_16x16x32_bf16 v[172:175], v[68:71], v[64:67], 0
  v_sub_f32 v236, 0, v11
  v_sub_f32 v237, 0, v11
  v_mfma_f32_16x16x32_bf16 v[172:175], v[76:79], v[120:123], v[172:175]
  v_sub_f32 v238, 0, v11
  v_sub_f32 v239, 0, v11
  v_mfma_f32_16x16x32_bf16 v[172:175], v[84:87], v[176:179], v[172:175]
  v_cvt_pk_bf16_f32 v24, v180, v181
  v_cvt_pk_bf16_f32 v25, v182, v183
  v_cvt_pk_bf16_f32 v26, v188, v189
  v_cvt_pk_bf16_f32 v27, v190, v191
  v_mfma_f32_16x16x32_bf16 v[172:175], v[92:95], v[232:235], v[172:175]
  buffer_load_dwordx4 v4, s[32:35], s48 offen offset:2176 nt lds
  v_add_u32 v9, s70, v9
  v_mfma_f32_16x16x32_bf16 a[96:99], v[100:103], v[24:27], 0
  s_and_b32 s62, s62, 3
  s_cselect_b32 s71, s68, s69
  v_add_u32 v10, s70, v10
  v_mfma_f32_16x16x32_bf16 a[100:103], v[108:111], v[24:27], 0
  v_max3_f32 v11, v164, v165, v166
  v_max3_f32 v11, v11, v167, v172
  v_max3_f32 v11, v11, v173, v174
  v_mfma_f32_16x16x32_bf16 a[104:107], v[116:119], v[24:27], 0
  v_max_f32 v11, v11, v175
  v_mov_b32 v12, v11
  v_mfma_f32_16x16x32_bf16 a[108:111], v[124:127], v[24:27], 0
  s_nop 0
  v_permlane32_swap_b32 v12, v11
  v_max_f32 v11, v12, v11
  v_mfma_f32_16x16x32_bf16 a[112:115], v[132:135], v[24:27], 0
  s_and_b32 s52, s64, 3
  s_cselect_b32 s52, s68, s69
  buffer_load_dwordx4 v5, s[32:35], s48 offen offset:3264 nt lds
  v_mov_b32 v12, v11
  s_nop 1
  v_permlane16_swap_b32 v12, v11
  v_mfma_f32_16x16x32_bf16 a[116:119], v[140:143], v[24:27], 0
  s_add_u32 s48, s48, 4096
  s_add_u32 s51, s51, s52
  v_max_f32 v11, v12, v11
  v_sub_f32 v164, v164, v11
  v_mfma_f32_16x16x32_bf16 a[120:123], v[148:151], v[24:27], 0
  s_cmp_eq_u32 s64, 16
  s_cselect_b32 s16, 0, s16
  v_sub_f32 v165, v165, v11
  v_sub_f32 v166, v166, v11
  v_mfma_f32_16x16x32_bf16 a[124:127], v[156:159], v[24:27], 0
  v_sub_f32 v167, v167, v11
  v_sub_f32 v172, v172, v11
  v_mfma_f32_16x16x32_bf16 a[236:239], a[252:255], v[24:27], 0
  v_sub_f32 v173, v173, v11
  v_sub_f32 v174, v174, v11
  v_sub_f32 v175, v175, v11
  v_mfma_f32_16x16x32_bf16 v[180:183], v[36:39], v[72:75], 0
  buffer_load_dword v0, v2, s[12:15], s16 offen offset:0
  v_exp_f32 v164, v164
  v_exp_f32 v165, v165
  v_mfma_f32_16x16x32_bf16 v[180:183], v[44:47], v[128:131], v[180:183]
  v_exp_f32 v166, v166
  v_exp_f32 v167, v167
  v_mfma_f32_16x16x32_bf16 v[180:183], v[52:55], v[184:187], v[180:183]
  v_exp_f32 v172, v172
  v_exp_f32 v173, v173
  v_mfma_f32_16x16x32_bf16 v[180:183], v[60:63], v[240:243], v[180:183]
  v_exp_f32 v174, v174
  v_exp_f32 v175, v175
  v_mfma_f32_16x16x32_bf16 v[188:191], v[68:71], v[72:75], 0
  v_sub_f32 v244, 0, v11
  v_sub_f32 v245, 0, v11
  v_mfma_f32_16x16x32_bf16 v[188:191], v[76:79], v[128:131], v[188:191]
  v_sub_f32 v246, 0, v11
  v_sub_f32 v247, 0, v11
  v_mfma_f32_16x16x32_bf16 v[188:191], v[84:87], v[184:187], v[188:191]
  v_cvt_pk_bf16_f32 v24, v164, v165
  v_cvt_pk_bf16_f32 v25, v166, v167
  v_cvt_pk_bf16_f32 v26, v172, v173
  v_cvt_pk_bf16_f32 v27, v174, v175
  v_mfma_f32_16x16x32_bf16 v[188:191], v[92:95], v[240:243], v[188:191]
  buffer_load_dword v0, v2, s[12:15], s16 offen offset:1024
  v_add_u32 v6, s71, v6
  v_mfma_f32_16x16x32_bf16 a[128:131], v[100:103], v[24:27], 0
  v_mfma_f32_16x16x32_bf16 a[132:135], v[108:111], v[24:27], 0
  v_max3_f32 v11, v180, v181, v182
  s_nop 2
  v_max3_f32 v11, v11, v183, v188
  v_max3_f32 v11, v11, v189, v190
  v_mfma_f32_16x16x32_bf16 a[136:139], v[116:119], v[24:27], 0
  v_max_f32 v11, v11, v191
  v_mov_b32 v12, v11
  v_mfma_f32_16x16x32_bf16 a[140:143], v[124:127], v[24:27], 0
  s_nop 0
  v_permlane32_swap_b32 v12, v11
  v_max_f32 v11, v12, v11
  v_mfma_f32_16x16x32_bf16 a[144:147], v[132:135], v[24:27], 0
  buffer_load_dword v0, v2, s[12:15], s16 offen offset:2048
  v_mov_b32 v12, v11
  s_nop 1
  v_permlane16_swap_b32 v12, v11
  v_mfma_f32_16x16x32_bf16 a[148:151], v[140:143], v[24:27], 0
  s_add_u32 s16, s16, 3072
  v_max_f32 v11, v12, v11
  v_sub_f32 v180, v180, v11
  v_mfma_f32_16x16x32_bf16 a[152:155], v[148:151], v[24:27], 0
  v_sub_f32 v181, v181, v11
  v_sub_f32 v182, v182, v11
  v_mfma_f32_16x16x32_bf16 a[156:159], v[156:159], v[24:27], 0
  v_sub_f32 v183, v183, v11
  v_sub_f32 v188, v188, v11
  v_mfma_f32_16x16x32_bf16 a[240:243], a[252:255], v[24:27], 0
  v_sub_f32 v189, v189, v11
  v_sub_f32 v190, v190, v11
  v_sub_f32 v191, v191, v11
  v_mfma_f32_16x16x32_bf16 v[196:199], v[36:39], v[80:83], 0
  ds_read_b128 v[36:39], v6 offset:0
  v_exp_f32 v180, v180
  v_exp_f32 v181, v181
  v_mfma_f32_16x16x32_bf16 v[196:199], v[44:47], v[136:139], v[196:199]
  v_exp_f32 v182, v182
  v_exp_f32 v183, v183
  v_mfma_f32_16x16x32_bf16 v[196:199], v[52:55], v[192:195], v[196:199]
  ds_read_b128 v[44:47], v6 offset:64
  v_exp_f32 v188, v188
  v_exp_f32 v189, v189
  v_mfma_f32_16x16x32_bf16 v[196:199], v[60:63], v[248:251], v[196:199]
  v_exp_f32 v190, v190
  v_exp_f32 v191, v191
  v_mfma_f32_16x16x32_bf16 v[204:207], v[68:71], v[80:83], 0
  ds_read_b128 v[52:55], v6 offset:128
  v_sub_f32 v252, 0, v11
  v_sub_f32 v253, 0, v11
  v_mfma_f32_16x16x32_bf16 v[204:207], v[76:79], v[136:139], v[204:207]
  v_sub_f32 v254, 0, v11
  v_sub_f32 v255, 0, v11
  v_mfma_f32_16x16x32_bf16 v[204:207], v[84:87], v[192:195], v[204:207]
  ds_read_b128 v[60:63], v6 offset:192
  v_cvt_pk_bf16_f32 v24, v180, v181
  v_cvt_pk_bf16_f32 v25, v182, v183
  v_cvt_pk_bf16_f32 v26, v188, v189
  v_cvt_pk_bf16_f32 v27, v190, v191
  v_mfma_f32_16x16x32_bf16 v[204:207], v[92:95], v[248:251], v[204:207]
  ds_read_b128 v[68:71], v6 offset:4352
  v_mfma_f32_16x16x32_bf16 a[160:163], v[100:103], v[24:27], 0
  v_mfma_f32_16x16x32_bf16 a[164:167], v[108:111], v[24:27], 0
  ds_read_b128 v[76:79], v6 offset:4416
  v_max3_f32 v11, v196, v197, v198
  s_nop 2
  v_max3_f32 v11, v11, v199, v204
  v_max3_f32 v11, v11, v205, v206
  v_mfma_f32_16x16x32_bf16 a[168:171], v[116:119], v[24:27], 0
  v_max_f32 v11, v11, v207
  v_mov_b32 v12, v11
  v_mfma_f32_16x16x32_bf16 a[172:175], v[124:127], v[24:27], 0
  ds_read_b128 v[84:87], v6 offset:4480
  v_permlane32_swap_b32 v12, v11
  v_max_f32 v11, v12, v11
  v_mfma_f32_16x16x32_bf16 a[176:179], v[132:135], v[24:27], 0
  v_mov_b32 v12, v11
  s_nop 1
  v_permlane16_swap_b32 v12, v11
  v_mfma_f32_16x16x32_bf16 a[180:183], v[140:143], v[24:27], 0
  ds_read_b128 v[92:95], v6 offset:4544
  v_max_f32 v11, v12, v11
  v_sub_f32 v196, v196, v11
  v_mfma_f32_16x16x32_bf16 a[184:187], v[148:151], v[24:27], 0
  v_sub_f32 v197, v197, v11
  v_sub_f32 v198, v198, v11
  v_mfma_f32_16x16x32_bf16 a[188:191], v[156:159], v[24:27], 0
  v_sub_f32 v199, v199, v11
  v_sub_f32 v204, v204, v11
  v_mfma_f32_16x16x32_bf16 a[244:247], a[252:255], v[24:27], 0
  s_waitcnt lgkmcnt(7)
  v_sub_f32 v205, v205, v11
  v_sub_f32 v206, v206, v11
  v_sub_f32 v207, v207, v11
  v_mfma_f32_16x16x32_bf16 v[164:167], v[36:39], v[32:35], v[212:215]
  s_waitcnt lgkmcnt(6)
  v_exp_f32 v196, v196
  v_exp_f32 v197, v197
  v_mfma_f32_16x16x32_bf16 v[164:167], v[44:47], v[88:91], v[164:167]
  s_waitcnt lgkmcnt(5)
  v_exp_f32 v198, v198
  v_exp_f32 v199, v199
  v_mfma_f32_16x16x32_bf16 v[164:167], v[52:55], v[144:147], v[164:167]
  s_waitcnt lgkmcnt(4)
  v_exp_f32 v204, v204
  v_exp_f32 v205, v205
  v_mfma_f32_16x16x32_bf16 v[164:167], v[60:63], v[200:203], v[164:167]
  s_waitcnt lgkmcnt(3)
  v_exp_f32 v206, v206
  v_exp_f32 v207, v207
  v_mfma_f32_16x16x32_bf16 v[172:175], v[68:71], v[32:35], v[212:215]
  s_waitcnt lgkmcnt(2)
  v_sub_f32 v20, 0, v11
  v_sub_f32 v21, 0, v11
  v_mfma_f32_16x16x32_bf16 v[172:175], v[76:79], v[88:91], v[172:175]
  s_waitcnt lgkmcnt(1)
  v_sub_f32 v22, 0, v11
  v_sub_f32 v23, 0, v11
  v_mfma_f32_16x16x32_bf16 v[172:175], v[84:87], v[144:147], v[172:175]
  s_waitcnt lgkmcnt(0)
  v_cvt_pk_bf16_f32 v24, v196, v197
  v_cvt_pk_bf16_f32 v25, v198, v199
  v_cvt_pk_bf16_f32 v26, v204, v205
  v_cvt_pk_bf16_f32 v27, v206, v207
  v_mfma_f32_16x16x32_bf16 v[172:175], v[92:95], v[200:203], v[172:175]
attn_kernel_aloop:
  s_nop 0
  v_mfma_f32_16x16x32_bf16 a[192:195], v[100:103], v[24:27], a[192:195]
  v_mfma_f32_16x16x32_bf16 a[196:199], v[108:111], v[24:27], a[196:199]
  ds_read_b64_tr_b16 v[100:101], v7 offset:0
  ds_read_b64_tr_b16 v[102:103], v7 offset:4352
  v_max3_f32 v11, v164, v165, v166
  v_exp_f32 v31, v167
  v_mfma_f32_16x16x32_bf16 a[200:203], v[116:119], v[24:27], a[200:203]
  ds_read_b64_tr_b16 v[108:109], v8 offset:0
  v_mfma_f32_16x16x32_bf16 a[204:207], v[124:127], v[24:27], a[204:207]
  v_mfma_f32_16x16x32_bf16 a[208:211], v[132:135], v[24:27], a[208:211]
  ds_read_b64_tr_b16 v[110:111], v8 offset:4352
  ds_read_b64_tr_b16 v[116:117], v7 offset:64
  v_max3_f32 v12, v172, v173, v174
  v_max3_f32 v11, v11, v167, v175
  v_mfma_f32_16x16x32_bf16 a[212:215], v[140:143], v[24:27], a[212:215]
  ds_read_b64_tr_b16 v[118:119], v7 offset:4416
  v_max_f32 v11, v11, v12
  v_mfma_f32_16x16x32_bf16 a[216:219], v[148:151], v[24:27], a[216:219]
  v_mfma_f32_16x16x32_bf16 a[220:223], v[156:159], v[24:27], a[220:223]
  ds_read_b64_tr_b16 v[124:125], v8 offset:64
  v_cmp_lt_f32 vcc, s58, v11
  v_exp_f32 v28, v164
  v_mfma_f32_16x16x32_bf16 a[248:251], a[252:255], v[24:27], a[248:251]
  ds_read_b64_tr_b16 v[126:127], v8 offset:4416
  v_exp_f32 v14, v172
  v_mfma_f32_16x16x32_bf16 v[180:183], v[36:39], v[40:43], v[220:223]
  s_cbranch_vccnz attn_kernel_slow0
attn_kernel_back0:
  v_mfma_f32_16x16x32_bf16 v[180:183], v[44:47], v[96:99], v[180:183]
  ds_read_b64_tr_b16 v[132:133], v9 offset:0
  v_exp_f32 v15, v173
  v_mfma_f32_16x16x32_bf16 v[180:183], v[52:55], v[152:155], v[180:183]
  v_exp_f32 v29, v165
  v_cvt_pk_bf16_f32 v26, v14, v15
  v_mfma_f32_16x16x32_bf16 v[180:183], v[60:63], v[208:211], v[180:183]
  v_mfma_f32_16x16x32_bf16 v[188:191], v[68:71], v[40:43], v[220:223]
  ds_read_b64_tr_b16 v[134:135], v9 offset:4352
  v_exp_f32 v16, v174
  v_exp_f32 v30, v166
  v_mfma_f32_16x16x32_bf16 v[188:191], v[76:79], v[96:99], v[188:191]
  ds_read_b64_tr_b16 v[140:141], v10 offset:0
  v_exp_f32 v17, v175
  v_cvt_pk_bf16_f32 v25, v30, v31
  v_mfma_f32_16x16x32_bf16 v[188:191], v[84:87], v[152:155], v[188:191]
  v_mfma_f32_16x16x32_bf16 v[188:191], v[92:95], v[208:211], v[188:191]
  s_waitcnt lgkmcnt(9)
  ds_read_b64_tr_b16 v[142:143], v10 offset:4352
  ds_read_b64_tr_b16 v[148:149], v9 offset:64
  v_cvt_pk_bf16_f32 v24, v28, v29
  v_cvt_pk_bf16_f32 v27, v16, v17
  s_nop 1
  v_mfma_f32_16x16x32_bf16 a[0:3], v[100:103], v[24:27], a[0:3]
  s_waitcnt lgkmcnt(9)
  ds_read_b64_tr_b16 v[150:151], v9 offset:4416
  v_max3_f32 v11, v180, v181, v182
  v_mfma_f32_16x16x32_bf16 a[4:7], v[108:111], v[24:27], a[4:7]
  s_waitcnt lgkmcnt(8)
  v_mfma_f32_16x16x32_bf16 a[8:11], v[116:119], v[24:27], a[8:11]
  s_waitcnt lgkmcnt(6)
  ds_read_b64_tr_b16 v[156:157], v10 offset:64
  ds_read_b64_tr_b16 v[158:159], v10 offset:4416
  v_mfma_f32_16x16x32_bf16 a[12:15], v[124:127], v[24:27], a[12:15]
  s_waitcnt lgkmcnt(6)
  v_max3_f32 v12, v188, v189, v190
  v_max3_f32 v11, v11, v183, v191
  v_mfma_f32_16x16x32_bf16 a[16:19], v[132:135], v[24:27], a[16:19]
  s_waitcnt lgkmcnt(4)
  v_mfma_f32_16x16x32_bf16 a[20:23], v[140:143], v[24:27], a[20:23]
  s_waitcnt lgkmcnt(2)
  v_max_f32 v11, v11, v12
  v_cmp_lt_f32 vcc, s58, v11
  v_exp_f32 v28, v180
  v_mfma_f32_16x16x32_bf16 a[24:27], v[148:151], v[24:27], a[24:27]
  s_cbranch_vccnz attn_kernel_slow1
attn_kernel_back1:
  s_waitcnt lgkmcnt(0)
  v_mfma_f32_16x16x32_bf16 a[28:31], v[156:159], v[24:27], a[28:31]
  v_mfma_f32_16x16x32_bf16 a[224:227], a[252:255], v[24:27], a[224:227]
  v_exp_f32 v29, v181
  v_exp_f32 v30, v182
  v_mfma_f32_16x16x32_bf16 v[164:167], v[36:39], v[48:51], v[228:231]
  v_exp_f32 v31, v183
  v_mfma_f32_16x16x32_bf16 v[164:167], v[44:47], v[104:107], v[164:167]
  v_mfma_f32_16x16x32_bf16 v[164:167], v[52:55], v[160:163], v[164:167]
  v_exp_f32 v14, v188
  v_exp_f32 v15, v189
  v_mfma_f32_16x16x32_bf16 v[164:167], v[60:63], v[216:219], v[164:167]
  v_exp_f32 v16, v190
  v_mfma_f32_16x16x32_bf16 v[172:175], v[68:71], v[48:51], v[228:231]
  v_mfma_f32_16x16x32_bf16 v[172:175], v[76:79], v[104:107], v[172:175]
  v_exp_f32 v17, v191
  v_cvt_pk_bf16_f32 v24, v28, v29
  v_cvt_pk_bf16_f32 v25, v30, v31
  v_mfma_f32_16x16x32_bf16 v[172:175], v[84:87], v[160:163], v[172:175]
  v_cvt_pk_bf16_f32 v26, v14, v15
  v_cvt_pk_bf16_f32 v27, v16, v17
  v_mfma_f32_16x16x32_bf16 v[172:175], v[92:95], v[216:219], v[172:175]
  s_nop 0
  v_mfma_f32_16x16x32_bf16 a[32:35], v[100:103], v[24:27], a[32:35]
  s_add_u32 s63, s63, 1
  v_max3_f32 v11, v164, v165, v166
  v_mfma_f32_16x16x32_bf16 a[36:39], v[108:111], v[24:27], a[36:39]
  s_waitcnt vmcnt(11)
  s_barrier
  v_exp_f32 v28, v164
  v_mfma_f32_16x16x32_bf16 a[40:43], v[116:119], v[24:27], a[40:43]
  v_mfma_f32_16x16x32_bf16 a[44:47], v[124:127], v[24:27], a[44:47]
  s_add_u32 m0, s51, 0
  s_add_u32 s64, s64, 1
  buffer_load_dwordx4 v2, s[32:35], s48 offen offset:0 nt lds
  v_exp_f32 v29, v165
  v_max3_f32 v12, v172, v173, v174
  v_max3_f32 v11, v11, v167, v175
  v_mfma_f32_16x16x32_bf16 a[48:51], v[132:135], v[24:27], a[48:51]
  v_max_f32 v11, v11, v12
  v_cmp_lt_f32 vcc, s58, v11
  v_mfma_f32_16x16x32_bf16 a[52:55], v[140:143], v[24:27], a[52:55]
  v_mfma_f32_16x16x32_bf16 a[56:59], v[148:151], v[24:27], a[56:59]
  v_exp_f32 v30, v166
  s_cbranch_vccnz attn_kernel_slow2
attn_kernel_back2:
  v_mfma_f32_16x16x32_bf16 a[60:63], v[156:159], v[24:27], a[60:63]
  buffer_load_dwordx4 v3, s[32:35], s48 offen offset:1088 nt lds
  v_exp_f32 v31, v167
  v_mfma_f32_16x16x32_bf16 a[228:231], a[252:255], v[24:27], a[228:231]
  v_mfma_f32_16x16x32_bf16 v[180:183], v[36:39], v[56:59], v[236:239]
  v_exp_f32 v14, v172
  v_exp_f32 v15, v173
  v_mfma_f32_16x16x32_bf16 v[180:183], v[44:47], v[112:115], v[180:183]
  v_exp_f32 v16, v174
  v_mfma_f32_16x16x32_bf16 v[180:183], v[52:55], v[168:171], v[180:183]
  v_mfma_f32_16x16x32_bf16 v[180:183], v[60:63], v[224:227], v[180:183]
  v_exp_f32 v17, v175
  v_cvt_pk_bf16_f32 v24, v28, v29
  v_cvt_pk_bf16_f32 v25, v30, v31
  v_mfma_f32_16x16x32_bf16 v[188:191], v[68:71], v[56:59], v[236:239]
  v_cvt_pk_bf16_f32 v26, v14, v15
  v_cvt_pk_bf16_f32 v27, v16, v17
  v_mfma_f32_16x16x32_bf16 v[188:191], v[76:79], v[112:115], v[188:191]
  v_mfma_f32_16x16x32_bf16 v[188:191], v[84:87], v[168:171], v[188:191]
  s_and_b32 s63, s63, 3
  s_cselect_b32 s70, s68, s69
  buffer_load_dwordx4 v4, s[32:35], s48 offen offset:2176 nt lds
  v_add_u32 v7, s70, v7
  v_add_u32 v8, s70, v8
  v_mfma_f32_16x16x32_bf16 v[188:191], v[92:95], v[224:227], v[188:191]
  v_add_u32 v9, s70, v9
  v_add_u32 v10, s70, v10
  v_mfma_f32_16x16x32_bf16 a[64:67], v[100:103], v[24:27], a[64:67]
  v_mfma_f32_16x16x32_bf16 a[68:71], v[108:111], v[24:27], a[68:71]
  s_add_u32 s62, s62, 1
  v_max3_f32 v11, v180, v181, v182
  v_exp_f32 v28, v180
  v_mfma_f32_16x16x32_bf16 a[72:75], v[116:119], v[24:27], a[72:75]
  buffer_load_dwordx4 v5, s[32:35], s48 offen offset:3264 nt lds
  v_exp_f32 v29, v181
  v_mfma_f32_16x16x32_bf16 a[76:79], v[124:127], v[24:27], a[76:79]
  v_mfma_f32_16x16x32_bf16 a[80:83], v[132:135], v[24:27], a[80:83]
  s_add_u32 m0, s51, 4352
  s_add_u32 s48, s48, 4096
  v_max3_f32 v12, v188, v189, v190
  v_max3_f32 v11, v11, v183, v191
  v_max_f32 v11, v11, v12
  v_cmp_lt_f32 vcc, s58, v11
  v_mfma_f32_16x16x32_bf16 a[84:87], v[140:143], v[24:27], a[84:87]
  v_exp_f32 v30, v182
  v_mfma_f32_16x16x32_bf16 a[88:91], v[148:151], v[24:27], a[88:91]
  s_cbranch_vccnz attn_kernel_slow3
attn_kernel_back3:
  v_mfma_f32_16x16x32_bf16 a[92:95], v[156:159], v[24:27], a[92:95]
  buffer_load_dwordx4 v2, s[32:35], s48 offen offset:0 nt lds
  v_exp_f32 v31, v183
  v_mfma_f32_16x16x32_bf16 a[232:235], a[252:255], v[24:27], a[232:235]
  v_exp_f32 v14, v188
  v_mfma_f32_16x16x32_bf16 v[164:167], v[36:39], v[64:67], v[244:247]
  v_mfma_f32_16x16x32_bf16 v[164:167], v[44:47], v[120:123], v[164:167]
  v_exp_f32 v15, v189
  v_exp_f32 v16, v190
  v_mfma_f32_16x16x32_bf16 v[164:167], v[52:55], v[176:179], v[164:167]
  v_exp_f32 v17, v191
  v_mfma_f32_16x16x32_bf16 v[164:167], v[60:63], v[232:235], v[164:167]
  v_mfma_f32_16x16x32_bf16 v[172:175], v[68:71], v[64:67], v[244:247]
  v_cvt_pk_bf16_f32 v24, v28, v29
  v_cvt_pk_bf16_f32 v25, v30, v31
  v_cvt_pk_bf16_f32 v26, v14, v15
  v_cvt_pk_bf16_f32 v27, v16, v17
  v_mfma_f32_16x16x32_bf16 v[172:175], v[76:79], v[120:123], v[172:175]
  s_and_b32 s62, s62, 3
  s_cselect_b32 s71, s68, s69
  buffer_load_dwordx4 v3, s[32:35], s48 offen offset:1088 nt lds
  v_mfma_f32_16x16x32_bf16 v[172:175], v[84:87], v[176:179], v[172:175]
  v_mfma_f32_16x16x32_bf16 v[172:175], v[92:95], v[232:235], v[172:175]
  v_add_u32 v6, s71, v6
  v_mfma_f32_16x16x32_bf16 a[96:99], v[100:103], v[24:27], a[96:99]
  v_max3_f32 v11, v164, v165, v166
  v_mfma_f32_16x16x32_bf16 a[100:103], v[108:111], v[24:27], a[100:103]
  v_mfma_f32_16x16x32_bf16 a[104:107], v[116:119], v[24:27], a[104:107]
  buffer_load_dwordx4 v4, s[32:35], s48 offen offset:2176 nt lds
  v_exp_f32 v28, v164
  v_exp_f32 v29, v165
  v_mfma_f32_16x16x32_bf16 a[108:111], v[124:127], v[24:27], a[108:111]
  v_max3_f32 v12, v172, v173, v174
  v_max3_f32 v11, v11, v167, v175
  v_mfma_f32_16x16x32_bf16 a[112:115], v[132:135], v[24:27], a[112:115]
  v_mfma_f32_16x16x32_bf16 a[116:119], v[140:143], v[24:27], a[116:119]
  v_max_f32 v11, v11, v12
  v_cmp_lt_f32 vcc, s58, v11
  v_exp_f32 v30, v166
  v_mfma_f32_16x16x32_bf16 a[120:123], v[148:151], v[24:27], a[120:123]
  s_cbranch_vccnz attn_kernel_slow4
attn_kernel_back4:
  v_mfma_f32_16x16x32_bf16 a[124:127], v[156:159], v[24:27], a[124:127]
  v_mfma_f32_16x16x32_bf16 a[236:239], a[252:255], v[24:27], a[236:239]
  s_and_b32 s52, s64, 3
  s_cselect_b32 s52, s68, s69
  buffer_load_dwordx4 v5, s[32:35], s48 offen offset:3264 nt lds
  s_add_u32 s48, s48, 4096
  s_add_u32 s51, s51, s52
  v_exp_f32 v31, v167
  v_exp_f32 v14, v172
  v_mfma_f32_16x16x32_bf16 v[180:183], v[36:39], v[72:75], v[252:255]
  s_cmp_eq_u32 s64, 16
  s_cselect_b32 s16, 0, s16
  v_exp_f32 v15, v173
  v_mfma_f32_16x16x32_bf16 v[180:183], v[44:47], v[128:131], v[180:183]
  v_mfma_f32_16x16x32_bf16 v[180:183], v[52:55], v[184:187], v[180:183]
  v_exp_f32 v16, v174
  v_exp_f32 v17, v175
  v_mfma_f32_16x16x32_bf16 v[180:183], v[60:63], v[240:243], v[180:183]
  v_cvt_pk_bf16_f32 v24, v28, v29
  v_cvt_pk_bf16_f32 v25, v30, v31
  v_mfma_f32_16x16x32_bf16 v[188:191], v[68:71], v[72:75], v[252:255]
  v_mfma_f32_16x16x32_bf16 v[188:191], v[76:79], v[128:131], v[188:191]
  buffer_load_dword v0, v2, s[12:15], s16 offen offset:0
  v_cvt_pk_bf16_f32 v26, v14, v15
  v_cvt_pk_bf16_f32 v27, v16, v17
  v_mfma_f32_16x16x32_bf16 v[188:191], v[84:87], v[184:187], v[188:191]
  v_mfma_f32_16x16x32_bf16 v[188:191], v[92:95], v[240:243], v[188:191]
  v_mfma_f32_16x16x32_bf16 a[128:131], v[100:103], v[24:27], a[128:131]
  v_max3_f32 v11, v180, v181, v182
  v_mfma_f32_16x16x32_bf16 a[132:135], v[108:111], v[24:27], a[132:135]
  v_exp_f32 v28, v180
  v_mfma_f32_16x16x32_bf16 a[136:139], v[116:119], v[24:27], a[136:139]
  v_mfma_f32_16x16x32_bf16 a[140:143], v[124:127], v[24:27], a[140:143]
  buffer_load_dword v0, v2, s[12:15], s16 offen offset:1024
  v_exp_f32 v29, v181
  v_max3_f32 v12, v188, v189, v190
  v_max3_f32 v11, v11, v183, v191
  v_mfma_f32_16x16x32_bf16 a[144:147], v[132:135], v[24:27], a[144:147]
  v_max_f32 v11, v11, v12
  v_cmp_lt_f32 vcc, s58, v11
  v_mfma_f32_16x16x32_bf16 a[148:151], v[140:143], v[24:27], a[148:151]
  v_mfma_f32_16x16x32_bf16 a[152:155], v[148:151], v[24:27], a[152:155]
  v_exp_f32 v30, v182
  s_cbranch_vccnz attn_kernel_slow5
attn_kernel_back5:
  v_mfma_f32_16x16x32_bf16 a[156:159], v[156:159], v[24:27], a[156:159]
  buffer_load_dword v0, v2, s[12:15], s16 offen offset:2048
  v_exp_f32 v31, v183
  v_mfma_f32_16x16x32_bf16 a[240:243], a[252:255], v[24:27], a[240:243]
  v_mfma_f32_16x16x32_bf16 v[196:199], v[36:39], v[80:83], v[20:23]
  s_add_u32 s16, s16, 3072
  ds_read_b128 v[36:39], v6 offset:0
  v_exp_f32 v14, v188
  v_cvt_pk_bf16_f32 v24, v28, v29
  v_mfma_f32_16x16x32_bf16 v[196:199], v[44:47], v[136:139], v[196:199]
  v_exp_f32 v15, v189
  v_mfma_f32_16x16x32_bf16 v[196:199], v[52:55], v[192:195], v[196:199]
  v_mfma_f32_16x16x32_bf16 v[196:199], v[60:63], v[248:251], v[196:199]
  ds_read_b128 v[44:47], v6 offset:64
  v_cvt_pk_bf16_f32 v25, v30, v31
  v_exp_f32 v16, v190
  v_mfma_f32_16x16x32_bf16 v[204:207], v[68:71], v[80:83], v[20:23]
  ds_read_b128 v[52:55], v6 offset:128
  v_cvt_pk_bf16_f32 v26, v14, v15
  v_mfma_f32_16x16x32_bf16 v[204:207], v[76:79], v[136:139], v[204:207]
  v_mfma_f32_16x16x32_bf16 v[204:207], v[84:87], v[192:195], v[204:207]
  ds_read_b128 v[60:63], v6 offset:192
  v_exp_f32 v17, v191
  s_nop 0
  v_cvt_pk_bf16_f32 v27, v16, v17
  v_mfma_f32_16x16x32_bf16 v[204:207], v[92:95], v[248:251], v[204:207]
  ds_read_b128 v[68:71], v6 offset:4352
  v_mfma_f32_16x16x32_bf16 a[160:163], v[100:103], v[24:27], a[160:163]
  v_mfma_f32_16x16x32_bf16 a[164:167], v[108:111], v[24:27], a[164:167]
  ds_read_b128 v[76:79], v6 offset:4416
  v_max3_f32 v11, v196, v197, v198
  v_mfma_f32_16x16x32_bf16 a[168:171], v[116:119], v[24:27], a[168:171]
  v_exp_f32 v28, v196
  v_mfma_f32_16x16x32_bf16 a[172:175], v[124:127], v[24:27], a[172:175]
  v_mfma_f32_16x16x32_bf16 a[176:179], v[132:135], v[24:27], a[176:179]
  ds_read_b128 v[84:87], v6 offset:4480
  v_max3_f32 v12, v204, v205, v206
  v_max3_f32 v11, v11, v199, v207
  v_max_f32 v11, v11, v12
  v_mfma_f32_16x16x32_bf16 a[180:183], v[140:143], v[24:27], a[180:183]
  ds_read_b128 v[92:95], v6 offset:4544
  v_cmp_lt_f32 vcc, s58, v11
  v_mfma_f32_16x16x32_bf16 a[184:187], v[148:151], v[24:27], a[184:187]
  v_mfma_f32_16x16x32_bf16 a[188:191], v[156:159], v[24:27], a[188:191]
  v_exp_f32 v29, v197
  s_cbranch_vccnz attn_kernel_slow6
attn_kernel_back6:
  v_mfma_f32_16x16x32_bf16 a[244:247], a[252:255], v[24:27], a[244:247]
  s_waitcnt lgkmcnt(7)
  v_exp_f32 v30, v198
  v_mfma_f32_16x16x32_bf16 v[164:167], v[36:39], v[32:35], v[212:215]
  s_waitcnt lgkmcnt(6)
  v_mfma_f32_16x16x32_bf16 v[164:167], v[44:47], v[88:91], v[164:167]
  s_waitcnt lgkmcnt(5)
  v_exp_f32 v31, v199
  v_exp_f32 v14, v204
  v_mfma_f32_16x16x32_bf16 v[164:167], v[52:55], v[144:147], v[164:167]
  s_waitcnt lgkmcnt(4)
  v_exp_f32 v15, v205
  v_mfma_f32_16x16x32_bf16 v[164:167], v[60:63], v[200:203], v[164:167]
  s_waitcnt lgkmcnt(3)
  v_mfma_f32_16x16x32_bf16 v[172:175], v[68:71], v[32:35], v[212:215]
  s_waitcnt lgkmcnt(2)
  v_exp_f32 v16, v206
  v_exp_f32 v17, v207
  v_mfma_f32_16x16x32_bf16 v[172:175], v[76:79], v[88:91], v[172:175]
  s_waitcnt lgkmcnt(1)
  v_cvt_pk_bf16_f32 v24, v28, v29
  v_cvt_pk_bf16_f32 v25, v30, v31
  v_mfma_f32_16x16x32_bf16 v[172:175], v[84:87], v[144:147], v[172:175]
  s_waitcnt lgkmcnt(0)
  v_mfma_f32_16x16x32_bf16 v[172:175], v[92:95], v[200:203], v[172:175]
  v_cvt_pk_bf16_f32 v26, v14, v15
  v_cvt_pk_bf16_f32 v27, v16, v17
  s_add_u32 s55, s55, 1
  s_cmp_lt_u32 s55, 14
  s_cbranch_scc1 attn_kernel_aloop
  v_mfma_f32_16x16x32_bf16 a[192:195], v[100:103], v[24:27], a[192:195]
  ds_read_b64_tr_b16 v[100:101], v7 offset:0
  v_max3_f32 v11, v164, v165, v166
  v_lshlrev_b32 v6, 4, v1
  v_mfma_f32_16x16x32_bf16 a[196:199], v[108:111], v[24:27], a[196:199]
  ds_read_b64_tr_b16 v[102:103], v7 offset:4352
  v_exp_f32 v31, v167
  v_mfma_f32_16x16x32_bf16 a[200:203], v[116:119], v[24:27], a[200:203]
  ds_read_b64_tr_b16 v[108:109], v8 offset:0
  v_mfma_f32_16x16x32_bf16 a[204:207], v[124:127], v[24:27], a[204:207]
  ds_read_b64_tr_b16 v[110:111], v8 offset:4352
  v_max3_f32 v12, v172, v173, v174
  v_mfma_f32_16x16x32_bf16 a[208:211], v[132:135], v[24:27], a[208:211]
  ds_read_b64_tr_b16 v[116:117], v7 offset:64
  v_max3_f32 v11, v11, v167, v175
  v_mfma_f32_16x16x32_bf16 a[212:215], v[140:143], v[24:27], a[212:215]
  ds_read_b64_tr_b16 v[118:119], v7 offset:4416
  v_max_f32 v11, v11, v12
  v_mfma_f32_16x16x32_bf16 a[216:219], v[148:151], v[24:27], a[216:219]
  ds_read_b64_tr_b16 v[124:125], v8 offset:64
  v_cmp_lt_f32 vcc, s58, v11
  v_mfma_f32_16x16x32_bf16 a[220:223], v[156:159], v[24:27], a[220:223]
  v_exp_f32 v28, v164
  v_mfma_f32_16x16x32_bf16 a[248:251], a[252:255], v[24:27], a[248:251]
  ds_read_b64_tr_b16 v[126:127], v8 offset:4416
  v_exp_f32 v14, v172
  v_mfma_f32_16x16x32_bf16 v[180:183], v[36:39], v[40:43], v[220:223]
  s_cbranch_vccnz attn_kernel_slowL0
attn_kernel_backL0:
  v_mfma_f32_16x16x32_bf16 v[180:183], v[44:47], v[96:99], v[180:183]
  ds_read_b64_tr_b16 v[132:133], v9 offset:0
  v_exp_f32 v15, v173
  v_mfma_f32_16x16x32_bf16 v[180:183], v[52:55], v[152:155], v[180:183]
  v_exp_f32 v29, v165
  v_cvt_pk_bf16_f32 v26, v14, v15
  v_mfma_f32_16x16x32_bf16 v[180:183], v[60:63], v[208:211], v[180:183]
  ds_read_b64_tr_b16 v[134:135], v9 offset:4352
  v_exp_f32 v16, v174
  v_mfma_f32_16x16x32_bf16 v[188:191], v[68:71], v[40:43], v[220:223]
  v_exp_f32 v30, v166
  v_mfma_f32_16x16x32_bf16 v[188:191], v[76:79], v[96:99], v[188:191]
  ds_read_b64_tr_b16 v[140:141], v10 offset:0
  v_exp_f32 v17, v175
  v_cvt_pk_bf16_f32 v25, v30, v31
  v_mfma_f32_16x16x32_bf16 v[188:191], v[84:87], v[152:155], v[188:191]
  ds_read_b64_tr_b16 v[142:143], v10 offset:4352
  v_cvt_pk_bf16_f32 v24, v28, v29
  v_cvt_pk_bf16_f32 v27, v16, v17
  v_mfma_f32_16x16x32_bf16 v[188:191], v[92:95], v[208:211], v[188:191]
  s_waitcnt lgkmcnt(10)
  ds_read_b64_tr_b16 v[148:149], v9 offset:64
  v_mfma_f32_16x16x32_bf16 a[0:3], v[100:103], v[24:27], a[0:3]
  s_waitcnt lgkmcnt(9)
  ds_read_b64_tr_b16 v[150:151], v9 offset:4416
  v_max3_f32 v11, v180, v181, v182
  v_mfma_f32_16x16x32_bf16 a[4:7], v[108:111], v[24:27], a[4:7]
  s_waitcnt lgkmcnt(8)
  ds_read_b64_tr_b16 v[156:157], v10 offset:64
  v_mfma_f32_16x16x32_bf16 a[8:11], v[116:119], v[24:27], a[8:11]
  s_waitcnt lgkmcnt(7)
  ds_read_b64_tr_b16 v[158:159], v10 offset:4416
  v_mfma_f32_16x16x32_bf16 a[12:15], v[124:127], v[24:27], a[12:15]
  s_waitcnt lgkmcnt(6)
  v_max3_f32 v12, v188, v189, v190
  v_max3_f32 v11, v11, v183, v191
  v_mfma_f32_16x16x32_bf16 a[16:19], v[132:135], v[24:27], a[16:19]
  s_waitcnt lgkmcnt(4)
  v_max_f32 v11, v11, v12
  v_cmp_lt_f32 vcc, s58, v11
  v_mfma_f32_16x16x32_bf16 a[20:23], v[140:143], v[24:27], a[20:23]
  s_waitcnt lgkmcnt(2)
  v_exp_f32 v28, v180
  v_mfma_f32_16x16x32_bf16 a[24:27], v[148:151], v[24:27], a[24:27]
  s_cbranch_vccnz attn_kernel_slowL1
attn_kernel_backL1:
  s_waitcnt lgkmcnt(0)
  v_mfma_f32_16x16x32_bf16 a[28:31], v[156:159], v[24:27], a[28:31]
  v_exp_f32 v29, v181
  v_mfma_f32_16x16x32_bf16 a[224:227], a[252:255], v[24:27], a[224:227]
  v_exp_f32 v30, v182
  v_mfma_f32_16x16x32_bf16 v[164:167], v[36:39], v[48:51], v[228:231]
  v_exp_f32 v31, v183
  v_mfma_f32_16x16x32_bf16 v[164:167], v[44:47], v[104:107], v[164:167]
  v_exp_f32 v14, v188
  v_mfma_f32_16x16x32_bf16 v[164:167], v[52:55], v[160:163], v[164:167]
  v_exp_f32 v15, v189
  v_mfma_f32_16x16x32_bf16 v[164:167], v[60:63], v[216:219], v[164:167]
  v_exp_f32 v16, v190
  v_accvgpr_read_b32 v214, a224
  v_rcp_f32 v212, v214
  v_accvgpr_read_b32 v32, a0
  v_accvgpr_read_b32 v33, a1
  v_accvgpr_read_b32 v34, a2
  v_accvgpr_read_b32 v35, a3
  v_mfma_f32_16x16x32_bf16 v[172:175], v[68:71], v[48:51], v[228:231]
  v_exp_f32 v17, v191
  v_accvgpr_read_b32 v88, a4
  v_accvgpr_read_b32 v89, a5
  v_accvgpr_read_b32 v90, a6
  v_accvgpr_read_b32 v91, a7
  v_mul_f32 v32, v32, v212
  v_mfma_f32_16x16x32_bf16 v[172:175], v[76:79], v[104:107], v[172:175]
  v_cvt_pk_bf16_f32 v24, v28, v29
  v_cvt_pk_bf16_f32 v25, v30, v31
  v_mul_f32 v33, v33, v212
  v_mul_f32 v34, v34, v212
  v_mul_f32 v35, v35, v212
  v_mul_f32 v88, v88, v212
  v_mul_f32 v89, v89, v212
  v_mfma_f32_16x16x32_bf16 v[172:175], v[84:87], v[160:163], v[172:175]
  v_cvt_pk_bf16_f32 v26, v14, v15
  v_cvt_pk_bf16_f32 v27, v16, v17
  v_mul_f32 v90, v90, v212
  v_mul_f32 v91, v91, v212
  v_cvt_pk_bf16_f32 v144, v32, v33
  v_cvt_pk_bf16_f32 v145, v34, v35
  v_cvt_pk_bf16_f32 v146, v88, v89
  v_mfma_f32_16x16x32_bf16 v[172:175], v[92:95], v[216:219], v[172:175]
  v_cvt_pk_bf16_f32 v147, v90, v91
  s_mov_b32 s70, 0
  buffer_store_dwordx4 v[144:147], v6, s[36:39], s70 offen offset:0 sc1
  v_accvgpr_read_b32 v32, a8
  v_accvgpr_read_b32 v33, a9
  v_accvgpr_read_b32 v34, a10
  v_mfma_f32_16x16x32_bf16 a[32:35], v[100:103], v[24:27], a[32:35]
  v_max3_f32 v11, v164, v165, v166
  v_accvgpr_read_b32 v35, a11
  v_accvgpr_read_b32 v88, a12
  v_accvgpr_read_b32 v89, a13
  v_accvgpr_read_b32 v90, a14
  v_accvgpr_read_b32 v91, a15
  v_mfma_f32_16x16x32_bf16 a[36:39], v[108:111], v[24:27], a[36:39]
  v_exp_f32 v28, v164
  v_mul_f32 v32, v32, v212
  v_mul_f32 v33, v33, v212
  v_mul_f32 v34, v34, v212
  v_mul_f32 v35, v35, v212
  v_mul_f32 v88, v88, v212
  v_mfma_f32_16x16x32_bf16 a[40:43], v[116:119], v[24:27], a[40:43]
  v_exp_f32 v29, v165
  v_mul_f32 v89, v89, v212
  v_mul_f32 v90, v90, v212
  v_mul_f32 v91, v91, v212
  v_cvt_pk_bf16_f32 v200, v32, v33
  v_cvt_pk_bf16_f32 v201, v34, v35
  v_mfma_f32_16x16x32_bf16 a[44:47], v[124:127], v[24:27], a[44:47]
  v_max3_f32 v12, v172, v173, v174
  v_max3_f32 v11, v11, v167, v175
  v_cvt_pk_bf16_f32 v202, v88, v89
  v_cvt_pk_bf16_f32 v203, v90, v91
  buffer_store_dwordx4 v[200:203], v6, s[36:39], s70 offen offset:1024 sc1
  v_accvgpr_read_b32 v32, a16
  v_accvgpr_read_b32 v33, a17
  v_mfma_f32_16x16x32_bf16 a[48:51], v[132:135], v[24:27], a[48:51]
  v_max_f32 v11, v11, v12
  v_cmp_lt_f32 vcc, s58, v11
  v_accvgpr_read_b32 v34, a18
  v_accvgpr_read_b32 v35, a19
  v_accvgpr_read_b32 v88, a20
  v_accvgpr_read_b32 v89, a21
  v_accvgpr_read_b32 v90, a22
  v_mfma_f32_16x16x32_bf16 a[52:55], v[140:143], v[24:27], a[52:55]
  v_exp_f32 v30, v166
  v_accvgpr_read_b32 v91, a23
  v_mul_f32 v32, v32, v212
  v_mul_f32 v33, v33, v212
  v_mul_f32 v34, v34, v212
  v_mul_f32 v35, v35, v212
  v_mfma_f32_16x16x32_bf16 a[56:59], v[148:151], v[24:27], a[56:59]
  s_cbranch_vccnz attn_kernel_slowL2
attn_kernel_backL2:
  v_mul_f32 v88, v88, v212
  v_mul_f32 v89, v89, v212
  v_mul_f32 v90, v90, v212
  v_mul_f32 v91, v91, v212
  v_cvt_pk_bf16_f32 v144, v32, v33
  v_mfma_f32_16x16x32_bf16 a[60:63], v[156:159], v[24:27], a[60:63]
  v_exp_f32 v31, v167
  v_cvt_pk_bf16_f32 v145, v34, v35
  v_cvt_pk_bf16_f32 v146, v88, v89
  v_cvt_pk_bf16_f32 v147, v90, v91
  buffer_store_dwordx4 v[144:147], v6, s[36:39], s70 offen offset:2048 sc1
  v_accvgpr_read_b32 v32, a24
  v_mfma_f32_16x16x32_bf16 a[228:231], a[252:255], v[24:27], a[228:231]
  v_exp_f32 v14, v172
  v_accvgpr_read_b32 v33, a25
  v_accvgpr_read_b32 v34, a26
  v_accvgpr_read_b32 v35, a27
  v_accvgpr_read_b32 v88, a28
  v_accvgpr_read_b32 v89, a29
  v_mfma_f32_16x16x32_bf16 v[180:183], v[36:39], v[56:59], v[236:239]
  v_exp_f32 v15, v173
  v_accvgpr_read_b32 v90, a30
  v_accvgpr_read_b32 v91, a31
  v_mul_f32 v32, v32, v212
  v_mul_f32 v33, v33, v212
  v_mul_f32 v34, v34, v212
  v_mfma_f32_16x16x32_bf16 v[180:183], v[44:47], v[112:115], v[180:183]
  v_exp_f32 v16, v174
  v_mul_f32 v35, v35, v212
  v_mul_f32 v88, v88, v212
  v_mul_f32 v89, v89, v212
  v_mul_f32 v90, v90, v212
  v_mul_f32 v91, v91, v212
  v_mfma_f32_16x16x32_bf16 v[180:183], v[52:55], v[168:171], v[180:183]
  v_exp_f32 v17, v175
  v_cvt_pk_bf16_f32 v200, v32, v33
  v_cvt_pk_bf16_f32 v201, v34, v35
  v_cvt_pk_bf16_f32 v202, v88, v89
  v_cvt_pk_bf16_f32 v203, v90, v91
  buffer_store_dwordx4 v[200:203], v6, s[36:39], s70 offen offset:3072 sc1
  v_mfma_f32_16x16x32_bf16 v[180:183], v[60:63], v[224:227], v[180:183]
  v_cvt_pk_bf16_f32 v24, v28, v29
  v_cvt_pk_bf16_f32 v25, v30, v31
  v_accvgpr_read_b32 v222, a228
  v_rcp_f32 v220, v222
  v_accvgpr_read_b32 v40, a32
  v_accvgpr_read_b32 v41, a33
  v_accvgpr_read_b32 v42, a34
  v_accvgpr_read_b32 v43, a35
  v_mfma_f32_16x16x32_bf16 v[188:191], v[68:71], v[56:59], v[236:239]
  v_cvt_pk_bf16_f32 v26, v14, v15
  v_cvt_pk_bf16_f32 v27, v16, v17
  v_accvgpr_read_b32 v96, a36
  v_accvgpr_read_b32 v97, a37
  v_accvgpr_read_b32 v98, a38
  v_accvgpr_read_b32 v99, a39
  v_mul_f32 v40, v40, v220
  v_mfma_f32_16x16x32_bf16 v[188:191], v[76:79], v[112:115], v[188:191]
  v_mul_f32 v41, v41, v220
  v_mul_f32 v42, v42, v220
  v_mul_f32 v43, v43, v220
  v_mul_f32 v96, v96, v220
  v_mul_f32 v97, v97, v220
  v_mfma_f32_16x16x32_bf16 v[188:191], v[84:87], v[168:171], v[188:191]
  v_mul_f32 v98, v98, v220
  v_mul_f32 v99, v99, v220
  v_cvt_pk_bf16_f32 v152, v40, v41
  v_cvt_pk_bf16_f32 v153, v42, v43
  v_cvt_pk_bf16_f32 v154, v96, v97
  v_mfma_f32_16x16x32_bf16 v[188:191], v[92:95], v[224:227], v[188:191]
  v_cvt_pk_bf16_f32 v155, v98, v99
  s_mov_b32 s70, 131072
  buffer_store_dwordx4 v[152:155], v6, s[36:39], s70 offen offset:0 sc1
  v_accvgpr_read_b32 v40, a40
  v_accvgpr_read_b32 v41, a41
  v_accvgpr_read_b32 v42, a42
  v_mfma_f32_16x16x32_bf16 a[64:67], v[100:103], v[24:27], a[64:67]
  v_max3_f32 v11, v180, v181, v182
  v_accvgpr_read_b32 v43, a43
  v_accvgpr_read_b32 v96, a44
  v_accvgpr_read_b32 v97, a45
  v_accvgpr_read_b32 v98, a46
  v_accvgpr_read_b32 v99, a47
  v_mfma_f32_16x16x32_bf16 a[68:71], v[108:111], v[24:27], a[68:71]
  v_exp_f32 v28, v180
  v_mul_f32 v40, v40, v220
  v_mul_f32 v41, v41, v220
  v_mul_f32 v42, v42, v220
  v_mul_f32 v43, v43, v220
  v_mul_f32 v96, v96, v220
  v_mfma_f32_16x16x32_bf16 a[72:75], v[116:119], v[24:27], a[72:75]
  v_exp_f32 v29, v181
  v_mul_f32 v97, v97, v220
  v_mul_f32 v98, v98, v220
  v_mul_f32 v99, v99, v220
  v_cvt_pk_bf16_f32 v208, v40, v41
  v_cvt_pk_bf16_f32 v209, v42, v43
  v_mfma_f32_16x16x32_bf16 a[76:79], v[124:127], v[24:27], a[76:79]
  v_max3_f32 v12, v188, v189, v190
  v_max3_f32 v11, v11, v183, v191
  v_cvt_pk_bf16_f32 v210, v96, v97
  v_cvt_pk_bf16_f32 v211, v98, v99
  buffer_store_dwordx4 v[208:211], v6, s[36:39], s70 offen offset:1024 sc1
  v_accvgpr_read_b32 v40, a48
  v_accvgpr_read_b32 v41, a49
  v_mfma_f32_16x16x32_bf16 a[80:83], v[132:135], v[24:27], a[80:83]
  v_max_f32 v11, v11, v12
  v_cmp_lt_f32 vcc, s58, v11
  v_accvgpr_read_b32 v42, a50
  v_accvgpr_read_b32 v43, a51
  v_accvgpr_read_b32 v96, a52
  v_accvgpr_read_b32 v97, a53
  v_accvgpr_read_b32 v98, a54
  v_mfma_f32_16x16x32_bf16 a[84:87], v[140:143], v[24:27], a[84:87]
  v_exp_f32 v30, v182
  v_accvgpr_read_b32 v99, a55
  v_mul_f32 v40, v40, v220
  v_mul_f32 v41, v41, v220
  v_mul_f32 v42, v42, v220
  v_mul_f32 v43, v43, v220
  v_mfma_f32_16x16x32_bf16 a[88:91], v[148:151], v[24:27], a[88:91]
  s_cbranch_vccnz attn_kernel_slowL3
attn_kernel_backL3:
  v_mul_f32 v96, v96, v220
  v_mul_f32 v97, v97, v220
  v_mul_f32 v98, v98, v220
  v_mul_f32 v99, v99, v220
  v_cvt_pk_bf16_f32 v152, v40, v41
  v_mfma_f32_16x16x32_bf16 a[92:95], v[156:159], v[24:27], a[92:95]
  v_exp_f32 v31, v183
  v_cvt_pk_bf16_f32 v153, v42, v43
  v_cvt_pk_bf16_f32 v154, v96, v97
  v_cvt_pk_bf16_f32 v155, v98, v99
  buffer_store_dwordx4 v[152:155], v6, s[36:39], s70 offen offset:2048 sc1
  v_accvgpr_read_b32 v40, a56
  v_mfma_f32_16x16x32_bf16 a[232:235], a[252:255], v[24:27], a[232:235]
  v_exp_f32 v14, v188
  v_accvgpr_read_b32 v41, a57
  v_accvgpr_read_b32 v42, a58
  v_accvgpr_read_b32 v43, a59
  v_accvgpr_read_b32 v96, a60
  v_accvgpr_read_b32 v97, a61
  v_mfma_f32_16x16x32_bf16 v[164:167], v[36:39], v[64:67], v[244:247]
  v_exp_f32 v15, v189
  v_accvgpr_read_b32 v98, a62
  v_accvgpr_read_b32 v99, a63
  v_mul_f32 v40, v40, v220
  v_mul_f32 v41, v41, v220
  v_mul_f32 v42, v42, v220
  v_mfma_f32_16x16x32_bf16 v[164:167], v[44:47], v[120:123], v[164:167]
  v_exp_f32 v16, v190
  v_mul_f32 v43, v43, v220
  v_mul_f32 v96, v96, v220
  v_mul_f32 v97, v97, v220
  v_mul_f32 v98, v98, v220
  v_mul_f32 v99, v99, v220
  v_mfma_f32_16x16x32_bf16 v[164:167], v[52:55], v[176:179], v[164:167]
  v_exp_f32 v17, v191
  v_cvt_pk_bf16_f32 v208, v40, v41
  v_cvt_pk_bf16_f32 v209, v42, v43
  v_cvt_pk_bf16_f32 v210, v96, v97
  v_cvt_pk_bf16_f32 v211, v98, v99
  buffer_store_dwordx4 v[208:211], v6, s[36:39], s70 offen offset:3072 sc1
  v_mfma_f32_16x16x32_bf16 v[164:167], v[60:63], v[232:235], v[164:167]
  v_cvt_pk_bf16_f32 v24, v28, v29
  v_cvt_pk_bf16_f32 v25, v30, v31
  v_accvgpr_read_b32 v230, a232
  v_rcp_f32 v228, v230
  v_accvgpr_read_b32 v48, a64
  v_accvgpr_read_b32 v49, a65
  v_accvgpr_read_b32 v50, a66
  v_accvgpr_read_b32 v51, a67
  v_mfma_f32_16x16x32_bf16 v[172:175], v[68:71], v[64:67], v[244:247]
  v_cvt_pk_bf16_f32 v26, v14, v15
  v_cvt_pk_bf16_f32 v27, v16, v17
  v_accvgpr_read_b32 v104, a68
  v_accvgpr_read_b32 v105, a69
  v_accvgpr_read_b32 v106, a70
  v_accvgpr_read_b32 v107, a71
  v_mul_f32 v48, v48, v228
  v_mfma_f32_16x16x32_bf16 v[172:175], v[76:79], v[120:123], v[172:175]
  v_mul_f32 v49, v49, v228
  v_mul_f32 v50, v50, v228
  v_mul_f32 v51, v51, v228
  v_mul_f32 v104, v104, v228
  v_mul_f32 v105, v105, v228
  v_mfma_f32_16x16x32_bf16 v[172:175], v[84:87], v[176:179], v[172:175]
  v_mul_f32 v106, v106, v228
  v_mul_f32 v107, v107, v228
  v_cvt_pk_bf16_f32 v160, v48, v49
  v_cvt_pk_bf16_f32 v161, v50, v51
  v_cvt_pk_bf16_f32 v162, v104, v105
  v_mfma_f32_16x16x32_bf16 v[172:175], v[92:95], v[232:235], v[172:175]
  v_cvt_pk_bf16_f32 v163, v106, v107
  s_mov_b32 s70, 262144
  buffer_store_dwordx4 v[160:163], v6, s[36:39], s70 offen offset:0 sc1
  v_accvgpr_read_b32 v48, a72
  v_accvgpr_read_b32 v49, a73
  v_accvgpr_read_b32 v50, a74
  v_mfma_f32_16x16x32_bf16 a[96:99], v[100:103], v[24:27], a[96:99]
  v_max3_f32 v11, v164, v165, v166
  v_accvgpr_read_b32 v51, a75
  v_accvgpr_read_b32 v104, a76
  v_accvgpr_read_b32 v105, a77
  v_accvgpr_read_b32 v106, a78
  v_accvgpr_read_b32 v107, a79
  v_mfma_f32_16x16x32_bf16 a[100:103], v[108:111], v[24:27], a[100:103]
  v_exp_f32 v28, v164
  v_mul_f32 v48, v48, v228
  v_mul_f32 v49, v49, v228
  v_mul_f32 v50, v50, v228
  v_mul_f32 v51, v51, v228
  v_mul_f32 v104, v104, v228
  v_mfma_f32_16x16x32_bf16 a[104:107], v[116:119], v[24:27], a[104:107]
  v_exp_f32 v29, v165
  v_mul_f32 v105, v105, v228
  v_mul_f32 v106, v106, v228
  v_mul_f32 v107, v107, v228
  v_cvt_pk_bf16_f32 v216, v48, v49
  v_cvt_pk_bf16_f32 v217, v50, v51
  v_mfma_f32_16x16x32_bf16 a[108:111], v[124:127], v[24:27], a[108:111]
  v_max3_f32 v12, v172, v173, v174
  v_max3_f32 v11, v11, v167, v175
  v_cvt_pk_bf16_f32 v218, v104, v105
  v_cvt_pk_bf16_f32 v219, v106, v107
  buffer_store_dwordx4 v[216:219], v6, s[36:39], s70 offen offset:1024 sc1
  v_accvgpr_read_b32 v48, a80
  v_accvgpr_read_b32 v49, a81
  v_mfma_f32_16x16x32_bf16 a[112:115], v[132:135], v[24:27], a[112:115]
  v_max_f32 v11, v11, v12
  v_cmp_lt_f32 vcc, s58, v11
  v_accvgpr_read_b32 v50, a82
  v_accvgpr_read_b32 v51, a83
  v_accvgpr_read_b32 v104, a84
  v_accvgpr_read_b32 v105, a85
  v_accvgpr_read_b32 v106, a86
  v_mfma_f32_16x16x32_bf16 a[116:119], v[140:143], v[24:27], a[116:119]
  v_exp_f32 v30, v166
  v_accvgpr_read_b32 v107, a87
  v_mul_f32 v48, v48, v228
  v_mul_f32 v49, v49, v228
  v_mul_f32 v50, v50, v228
  v_mul_f32 v51, v51, v228
  v_mfma_f32_16x16x32_bf16 a[120:123], v[148:151], v[24:27], a[120:123]
  s_cbranch_vccnz attn_kernel_slowL4
attn_kernel_backL4:
  v_mul_f32 v104, v104, v228
  v_mul_f32 v105, v105, v228
  v_mul_f32 v106, v106, v228
  v_mul_f32 v107, v107, v228
  v_cvt_pk_bf16_f32 v160, v48, v49
  v_mfma_f32_16x16x32_bf16 a[124:127], v[156:159], v[24:27], a[124:127]
  v_exp_f32 v31, v167
  v_cvt_pk_bf16_f32 v161, v50, v51
  v_cvt_pk_bf16_f32 v162, v104, v105
  v_cvt_pk_bf16_f32 v163, v106, v107
  buffer_store_dwordx4 v[160:163], v6, s[36:39], s70 offen offset:2048 sc1
  v_accvgpr_read_b32 v48, a88
  v_mfma_f32_16x16x32_bf16 a[236:239], a[252:255], v[24:27], a[236:239]
  v_exp_f32 v14, v172
  v_accvgpr_read_b32 v49, a89
  v_accvgpr_read_b32 v50, a90
  v_accvgpr_read_b32 v51, a91
  v_accvgpr_read_b32 v104, a92
  v_accvgpr_read_b32 v105, a93
  v_mfma_f32_16x16x32_bf16 v[180:183], v[36:39], v[72:75], v[252:255]
  v_exp_f32 v15, v173
  v_accvgpr_read_b32 v106, a94
  v_accvgpr_read_b32 v107, a95
  v_mul_f32 v48, v48, v228
  v_mul_f32 v49, v49, v228
  v_mul_f32 v50, v50, v228
  v_mfma_f32_16x16x32_bf16 v[180:183], v[44:47], v[128:131], v[180:183]
  v_exp_f32 v16, v174
  v_mul_f32 v51, v51, v228
  v_mul_f32 v104, v104, v228
  v_mul_f32 v105, v105, v228
  v_mul_f32 v106, v106, v228
  v_mul_f32 v107, v107, v228
  v_mfma_f32_16x16x32_bf16 v[180:183], v[52:55], v[184:187], v[180:183]
  v_exp_f32 v17, v175
  v_cvt_pk_bf16_f32 v216, v48, v49
  v_cvt_pk_bf16_f32 v217, v50, v51
  v_cvt_pk_bf16_f32 v218, v104, v105
  v_cvt_pk_bf16_f32 v219, v106, v107
  buffer_store_dwordx4 v[216:219], v6, s[36:39], s70 offen offset:3072 sc1
  v_mfma_f32_16x16x32_bf16 v[180:183], v[60:63], v[240:243], v[180:183]
  v_cvt_pk_bf16_f32 v24, v28, v29
  v_cvt_pk_bf16_f32 v25, v30, v31
  v_accvgpr_read_b32 v238, a236
  v_rcp_f32 v236, v238
  v_accvgpr_read_b32 v56, a96
  v_accvgpr_read_b32 v57, a97
  v_accvgpr_read_b32 v58, a98
  v_accvgpr_read_b32 v59, a99
  v_mfma_f32_16x16x32_bf16 v[188:191], v[68:71], v[72:75], v[252:255]
  v_cvt_pk_bf16_f32 v26, v14, v15
  v_cvt_pk_bf16_f32 v27, v16, v17
  v_accvgpr_read_b32 v112, a100
  v_accvgpr_read_b32 v113, a101
  v_accvgpr_read_b32 v114, a102
  v_accvgpr_read_b32 v115, a103
  v_mul_f32 v56, v56, v236
  v_mfma_f32_16x16x32_bf16 v[188:191], v[76:79], v[128:131], v[188:191]
  v_mul_f32 v57, v57, v236
  v_mul_f32 v58, v58, v236
  v_mul_f32 v59, v59, v236
  v_mul_f32 v112, v112, v236
  v_mul_f32 v113, v113, v236
  v_mfma_f32_16x16x32_bf16 v[188:191], v[84:87], v[184:187], v[188:191]
  v_mul_f32 v114, v114, v236
  v_mul_f32 v115, v115, v236
  v_cvt_pk_bf16_f32 v168, v56, v57
  v_cvt_pk_bf16_f32 v169, v58, v59
  v_cvt_pk_bf16_f32 v170, v112, v113
  v_mfma_f32_16x16x32_bf16 v[188:191], v[92:95], v[240:243], v[188:191]
  v_cvt_pk_bf16_f32 v171, v114, v115
  s_mov_b32 s70, 393216
  buffer_store_dwordx4 v[168:171], v6, s[36:39], s70 offen offset:0 sc1
  v_accvgpr_read_b32 v56, a104
  v_accvgpr_read_b32 v57, a105
  v_accvgpr_read_b32 v58, a106
  v_mfma_f32_16x16x32_bf16 a[128:131], v[100:103], v[24:27], a[128:131]
  v_max3_f32 v11, v180, v181, v182
  v_accvgpr_read_b32 v59, a107
  v_accvgpr_read_b32 v112, a108
  v_accvgpr_read_b32 v113, a109
  v_accvgpr_read_b32 v114, a110
  v_accvgpr_read_b32 v115, a111
  v_mfma_f32_16x16x32_bf16 a[132:135], v[108:111], v[24:27], a[132:135]
  v_exp_f32 v28, v180
  v_mul_f32 v56, v56, v236
  v_mul_f32 v57, v57, v236
  v_mul_f32 v58, v58, v236
  v_mul_f32 v59, v59, v236
  v_mul_f32 v112, v112, v236
  v_mfma_f32_16x16x32_bf16 a[136:139], v[116:119], v[24:27], a[136:139]
  v_exp_f32 v29, v181
  v_mul_f32 v113, v113, v236
  v_mul_f32 v114, v114, v236
  v_mul_f32 v115, v115, v236
  v_cvt_pk_bf16_f32 v224, v56, v57
  v_cvt_pk_bf16_f32 v225, v58, v59
  v_mfma_f32_16x16x32_bf16 a[140:143], v[124:127], v[24:27], a[140:143]
  v_max3_f32 v12, v188, v189, v190
  v_max3_f32 v11, v11, v183, v191
  v_cvt_pk_bf16_f32 v226, v112, v113
  v_cvt_pk_bf16_f32 v227, v114, v115
  buffer_store_dwordx4 v[224:227], v6, s[36:39], s70 offen offset:1024 sc1
  v_accvgpr_read_b32 v56, a112
  v_accvgpr_read_b32 v57, a113
  v_mfma_f32_16x16x32_bf16 a[144:147], v[132:135], v[24:27], a[144:147]
  v_max_f32 v11, v11, v12
  v_cmp_lt_f32 vcc, s58, v11
  v_accvgpr_read_b32 v58, a114
  v_accvgpr_read_b32 v59, a115
  v_accvgpr_read_b32 v112, a116
  v_accvgpr_read_b32 v113, a117
  v_accvgpr_read_b32 v114, a118
  v_mfma_f32_16x16x32_bf16 a[148:151], v[140:143], v[24:27], a[148:151]
  v_exp_f32 v30, v182
  v_accvgpr_read_b32 v115, a119
  v_mul_f32 v56, v56, v236
  v_mul_f32 v57, v57, v236
  v_mul_f32 v58, v58, v236
  v_mul_f32 v59, v59, v236
  v_mfma_f32_16x16x32_bf16 a[152:155], v[148:151], v[24:27], a[152:155]
  s_cbranch_vccnz attn_kernel_slowL5
attn_kernel_backL5:
  v_mul_f32 v112, v112, v236
  v_mul_f32 v113, v113, v236
  v_mul_f32 v114, v114, v236
  v_mul_f32 v115, v115, v236
  v_cvt_pk_bf16_f32 v168, v56, v57
  v_mfma_f32_16x16x32_bf16 a[156:159], v[156:159], v[24:27], a[156:159]
  v_exp_f32 v31, v183
  v_cvt_pk_bf16_f32 v169, v58, v59
  v_cvt_pk_bf16_f32 v170, v112, v113
  v_cvt_pk_bf16_f32 v171, v114, v115
  buffer_store_dwordx4 v[168:171], v6, s[36:39], s70 offen offset:2048 sc1
  v_accvgpr_read_b32 v56, a120
  v_mfma_f32_16x16x32_bf16 a[240:243], a[252:255], v[24:27], a[240:243]
  v_exp_f32 v14, v188
  v_accvgpr_read_b32 v57, a121
  v_accvgpr_read_b32 v58, a122
  v_accvgpr_read_b32 v59, a123
  v_accvgpr_read_b32 v112, a124
  v_accvgpr_read_b32 v113, a125
  v_mfma_f32_16x16x32_bf16 v[196:199], v[36:39], v[80:83], v[20:23]
  v_exp_f32 v15, v189
  v_accvgpr_read_b32 v114, a126
  v_accvgpr_read_b32 v115, a127
  v_mul_f32 v56, v56, v236
  v_mul_f32 v57, v57, v236
  v_mul_f32 v58, v58, v236
  v_mfma_f32_16x16x32_bf16 v[196:199], v[44:47], v[136:139], v[196:199]
  v_exp_f32 v16, v190
  v_mul_f32 v59, v59, v236
  v_mul_f32 v112, v112, v236
  v_mul_f32 v113, v113, v236
  v_mul_f32 v114, v114, v236
  v_mul_f32 v115, v115, v236
  v_mfma_f32_16x16x32_bf16 v[196:199], v[52:55], v[192:195], v[196:199]
  v_exp_f32 v17, v191
  v_cvt_pk_bf16_f32 v224, v56, v57
  v_cvt_pk_bf16_f32 v225, v58, v59
  v_cvt_pk_bf16_f32 v226, v112, v113
  v_cvt_pk_bf16_f32 v227, v114, v115
  buffer_store_dwordx4 v[224:227], v6, s[36:39], s70 offen offset:3072 sc1
  v_mfma_f32_16x16x32_bf16 v[196:199], v[60:63], v[248:251], v[196:199]
  v_cvt_pk_bf16_f32 v24, v28, v29
  v_cvt_pk_bf16_f32 v25, v30, v31
  v_accvgpr_read_b32 v246, a240
  v_rcp_f32 v244, v246
  v_accvgpr_read_b32 v64, a128
  v_accvgpr_read_b32 v65, a129
  v_accvgpr_read_b32 v66, a130
  v_accvgpr_read_b32 v67, a131
  v_mfma_f32_16x16x32_bf16 v[204:207], v[68:71], v[80:83], v[20:23]
  v_cvt_pk_bf16_f32 v26, v14, v15
  v_cvt_pk_bf16_f32 v27, v16, v17
  v_accvgpr_read_b32 v120, a132
  v_accvgpr_read_b32 v121, a133
  v_accvgpr_read_b32 v122, a134
  v_accvgpr_read_b32 v123, a135
  v_mul_f32 v64, v64, v244
  v_mfma_f32_16x16x32_bf16 v[204:207], v[76:79], v[136:139], v[204:207]
  v_mul_f32 v65, v65, v244
  v_mul_f32 v66, v66, v244
  v_mul_f32 v67, v67, v244
  v_mul_f32 v120, v120, v244
  v_mul_f32 v121, v121, v244
  v_mfma_f32_16x16x32_bf16 v[204:207], v[84:87], v[192:195], v[204:207]
  v_mul_f32 v122, v122, v244
  v_mul_f32 v123, v123, v244
  v_cvt_pk_bf16_f32 v176, v64, v65
  v_cvt_pk_bf16_f32 v177, v66, v67
  v_cvt_pk_bf16_f32 v178, v120, v121
  v_mfma_f32_16x16x32_bf16 v[204:207], v[92:95], v[248:251], v[204:207]
  v_cvt_pk_bf16_f32 v179, v122, v123
  s_mov_b32 s70, 524288
  buffer_store_dwordx4 v[176:179], v6, s[36:39], s70 offen offset:0 sc1
  v_accvgpr_read_b32 v64, a136
  v_accvgpr_read_b32 v65, a137
  v_accvgpr_read_b32 v66, a138
  v_mfma_f32_16x16x32_bf16 a[160:163], v[100:103], v[24:27], a[160:163]
  v_max3_f32 v11, v196, v197, v198
  v_accvgpr_read_b32 v67, a139
  v_accvgpr_read_b32 v120, a140
  v_accvgpr_read_b32 v121, a141
  v_accvgpr_read_b32 v122, a142
  v_accvgpr_read_b32 v123, a143
  v_mfma_f32_16x16x32_bf16 a[164:167], v[108:111], v[24:27], a[164:167]
  v_exp_f32 v28, v196
  v_mul_f32 v64, v64, v244
  v_mul_f32 v65, v65, v244
  v_mul_f32 v66, v66, v244
  v_mul_f32 v67, v67, v244
  v_mul_f32 v120, v120, v244
  v_mfma_f32_16x16x32_bf16 a[168:171], v[116:119], v[24:27], a[168:171]
  v_exp_f32 v29, v197
  v_mul_f32 v121, v121, v244
  v_mul_f32 v122, v122, v244
  v_mul_f32 v123, v123, v244
  v_cvt_pk_bf16_f32 v232, v64, v65
  v_cvt_pk_bf16_f32 v233, v66, v67
  v_mfma_f32_16x16x32_bf16 a[172:175], v[124:127], v[24:27], a[172:175]
  v_max3_f32 v12, v204, v205, v206
  v_max3_f32 v11, v11, v199, v207
  v_exp_f32 v14, v204
  v_exp_f32 v15, v205
  v_exp_f32 v16, v206
  v_exp_f32 v17, v207
  v_cvt_pk_bf16_f32 v234, v120, v121
  v_cvt_pk_bf16_f32 v235, v122, v123
  buffer_store_dwordx4 v[232:235], v6, s[36:39], s70 offen offset:1024 sc1
  v_accvgpr_read_b32 v64, a144
  v_accvgpr_read_b32 v65, a145
  v_mfma_f32_16x16x32_bf16 a[176:179], v[132:135], v[24:27], a[176:179]
  v_max_f32 v11, v11, v12
  v_cmp_lt_f32 vcc, s58, v11
  v_accvgpr_read_b32 v66, a146
  v_accvgpr_read_b32 v67, a147
  v_accvgpr_read_b32 v120, a148
  v_accvgpr_read_b32 v121, a149
  v_accvgpr_read_b32 v122, a150
  v_mfma_f32_16x16x32_bf16 a[180:183], v[140:143], v[24:27], a[180:183]
  v_exp_f32 v30, v198
  v_accvgpr_read_b32 v123, a151
  v_mul_f32 v64, v64, v244
  v_mul_f32 v65, v65, v244
  v_mul_f32 v66, v66, v244
  v_mul_f32 v67, v67, v244
  v_mfma_f32_16x16x32_bf16 a[184:187], v[148:151], v[24:27], a[184:187]
  s_cbranch_vccnz attn_kernel_slowL6
attn_kernel_backL6:
  v_mul_f32 v120, v120, v244
  v_mul_f32 v121, v121, v244
  v_mul_f32 v122, v122, v244
  v_mul_f32 v123, v123, v244
  v_cvt_pk_bf16_f32 v176, v64, v65
  v_mfma_f32_16x16x32_bf16 a[188:191], v[156:159], v[24:27], a[188:191]
  v_exp_f32 v31, v199
  v_cvt_pk_bf16_f32 v177, v66, v67
  v_cvt_pk_bf16_f32 v178, v120, v121
  v_cvt_pk_bf16_f32 v179, v122, v123
  buffer_store_dwordx4 v[176:179], v6, s[36:39], s70 offen offset:2048 sc1
  v_accvgpr_read_b32 v64, a152
  v_mfma_f32_16x16x32_bf16 a[244:247], a[252:255], v[24:27], a[244:247]
  v_cvt_pk_bf16_f32 v24, v28, v29
  v_cvt_pk_bf16_f32 v25, v30, v31
  v_cvt_pk_bf16_f32 v26, v14, v15
  v_cvt_pk_bf16_f32 v27, v16, v17
  v_accvgpr_read_b32 v65, a153
  v_accvgpr_read_b32 v66, a154
  v_accvgpr_read_b32 v67, a155
  v_accvgpr_read_b32 v120, a156
  v_accvgpr_read_b32 v121, a157
  v_mfma_f32_16x16x32_bf16 a[192:195], v[100:103], v[24:27], a[192:195]
  v_accvgpr_read_b32 v122, a158
  v_accvgpr_read_b32 v123, a159
  v_mul_f32 v64, v64, v244
  v_mul_f32 v65, v65, v244
  v_mul_f32 v66, v66, v244
  v_mfma_f32_16x16x32_bf16 a[196:199], v[108:111], v[24:27], a[196:199]
  v_mul_f32 v67, v67, v244
  v_mul_f32 v120, v120, v244
  v_mul_f32 v121, v121, v244
  v_mul_f32 v122, v122, v244
  v_mul_f32 v123, v123, v244
  v_mfma_f32_16x16x32_bf16 a[200:203], v[116:119], v[24:27], a[200:203]
  v_cvt_pk_bf16_f32 v232, v64, v65
  v_cvt_pk_bf16_f32 v233, v66, v67
  v_cvt_pk_bf16_f32 v234, v120, v121
  v_cvt_pk_bf16_f32 v235, v122, v123
  buffer_store_dwordx4 v[232:235], v6, s[36:39], s70 offen offset:3072 sc1
  v_mfma_f32_16x16x32_bf16 a[204:207], v[124:127], v[24:27], a[204:207]
  v_mfma_f32_16x16x32_bf16 a[208:211], v[132:135], v[24:27], a[208:211]
  v_mfma_f32_16x16x32_bf16 a[212:215], v[140:143], v[24:27], a[212:215]
  v_mfma_f32_16x16x32_bf16 a[216:219], v[148:151], v[24:27], a[216:219]
  v_mfma_f32_16x16x32_bf16 a[220:223], v[156:159], v[24:27], a[220:223]
  v_mfma_f32_16x16x32_bf16 a[248:251], a[252:255], v[24:27], a[248:251]
  s_add_u32 s72, s20, 50331648
  s_addc_u32 s73, s21, 0
  s_mov_b32 s74, 32768
  s_mov_b32 s75, 0x00020000
  s_lshl_b32 s70, s2, 7
  v_and_b32 v2, 31, v1
  v_lshlrev_b32 v2, 2, v2
  v_mov_b32 v10, 0
  buffer_store_dword v10, v2, s[72:75], s70 offen
  v_lshlrev_b32 v2, 4, v1
  s_nop 7
  v_accvgpr_read_b32 v22, a244
  s_mov_b32 s52, 655360
  v_rcp_f32 v22, v22
  v_accvgpr_read_b32 v96, a160
  v_accvgpr_read_b32 v97, a161
  v_accvgpr_read_b32 v98, a162
  v_accvgpr_read_b32 v99, a163
  v_accvgpr_read_b32 v100, a164
  v_accvgpr_read_b32 v101, a165
  v_accvgpr_read_b32 v102, a166
  v_accvgpr_read_b32 v103, a167
  v_pk_mul_f32 v[96:97], v[96:97], v[22:23] op_sel_hi:[1,0]
  v_pk_mul_f32 v[98:99], v[98:99], v[22:23] op_sel_hi:[1,0]
  v_pk_mul_f32 v[100:101], v[100:101], v[22:23] op_sel_hi:[1,0]
  v_pk_mul_f32 v[102:103], v[102:103], v[22:23] op_sel_hi:[1,0]
  v_cvt_pk_bf16_f32 v104, v96, v97
  v_cvt_pk_bf16_f32 v105, v98, v99
  v_cvt_pk_bf16_f32 v106, v100, v101
  v_cvt_pk_bf16_f32 v107, v102, v103
  buffer_store_dwordx4 v[104:107], v2, s[36:39], s52 offen offset:0 sc1
  v_accvgpr_read_b32 v112, a168
  v_accvgpr_read_b32 v113, a169
  v_accvgpr_read_b32 v114, a170
  v_accvgpr_read_b32 v115, a171
  v_accvgpr_read_b32 v116, a172
  v_accvgpr_read_b32 v117, a173
  v_accvgpr_read_b32 v118, a174
  v_accvgpr_read_b32 v119, a175
  v_pk_mul_f32 v[112:113], v[112:113], v[22:23] op_sel_hi:[1,0]
  v_pk_mul_f32 v[114:115], v[114:115], v[22:23] op_sel_hi:[1,0]
  v_pk_mul_f32 v[116:117], v[116:117], v[22:23] op_sel_hi:[1,0]
  v_pk_mul_f32 v[118:119], v[118:119], v[22:23] op_sel_hi:[1,0]
  v_cvt_pk_bf16_f32 v120, v112, v113
  v_cvt_pk_bf16_f32 v121, v114, v115
  v_cvt_pk_bf16_f32 v122, v116, v117
  v_cvt_pk_bf16_f32 v123, v118, v119
  buffer_store_dwordx4 v[120:123], v2, s[36:39], s52 offen offset:1024 sc1
  v_accvgpr_read_b32 v128, a176
  v_accvgpr_read_b32 v129, a177
  v_accvgpr_read_b32 v130, a178
  v_accvgpr_read_b32 v131, a179
  v_accvgpr_read_b32 v132, a180
  v_accvgpr_read_b32 v133, a181
  v_accvgpr_read_b32 v134, a182
  v_accvgpr_read_b32 v135, a183
  v_pk_mul_f32 v[128:129], v[128:129], v[22:23] op_sel_hi:[1,0]
  v_pk_mul_f32 v[130:131], v[130:131], v[22:23] op_sel_hi:[1,0]
  v_pk_mul_f32 v[132:133], v[132:133], v[22:23] op_sel_hi:[1,0]
  v_pk_mul_f32 v[134:135], v[134:135], v[22:23] op_sel_hi:[1,0]
  v_cvt_pk_bf16_f32 v136, v128, v129
  v_cvt_pk_bf16_f32 v137, v130, v131
  v_cvt_pk_bf16_f32 v138, v132, v133
  v_cvt_pk_bf16_f32 v139, v134, v135
  buffer_store_dwordx4 v[136:139], v2, s[36:39], s52 offen offset:2048 sc1
  v_accvgpr_read_b32 v144, a184
  v_accvgpr_read_b32 v145, a185
  v_accvgpr_read_b32 v146, a186
  v_accvgpr_read_b32 v147, a187
  v_accvgpr_read_b32 v148, a188
  v_accvgpr_read_b32 v149, a189
  v_accvgpr_read_b32 v150, a190
  v_accvgpr_read_b32 v151, a191
  v_pk_mul_f32 v[144:145], v[144:145], v[22:23] op_sel_hi:[1,0]
  v_pk_mul_f32 v[146:147], v[146:147], v[22:23] op_sel_hi:[1,0]
  v_pk_mul_f32 v[148:149], v[148:149], v[22:23] op_sel_hi:[1,0]
  v_pk_mul_f32 v[150:151], v[150:151], v[22:23] op_sel_hi:[1,0]
  v_cvt_pk_bf16_f32 v152, v144, v145
  v_cvt_pk_bf16_f32 v153, v146, v147
  v_cvt_pk_bf16_f32 v154, v148, v149
  v_cvt_pk_bf16_f32 v155, v150, v151
  buffer_store_dwordx4 v[152:155], v2, s[36:39], s52 offen offset:3072 sc1
  v_accvgpr_read_b32 v20, a248
  s_mov_b32 s52, 786432
  v_rcp_f32 v20, v20
  v_accvgpr_read_b32 v32, a192
  v_accvgpr_read_b32 v33, a193
  v_accvgpr_read_b32 v34, a194
  v_accvgpr_read_b32 v35, a195
  v_accvgpr_read_b32 v36, a196
  v_accvgpr_read_b32 v37, a197
  v_accvgpr_read_b32 v38, a198
  v_accvgpr_read_b32 v39, a199
  v_pk_mul_f32 v[32:33], v[32:33], v[20:21] op_sel_hi:[1,0]
  v_pk_mul_f32 v[34:35], v[34:35], v[20:21] op_sel_hi:[1,0]
  v_pk_mul_f32 v[36:37], v[36:37], v[20:21] op_sel_hi:[1,0]
  v_pk_mul_f32 v[38:39], v[38:39], v[20:21] op_sel_hi:[1,0]
  v_cvt_pk_bf16_f32 v40, v32, v33
  v_cvt_pk_bf16_f32 v41, v34, v35
  v_cvt_pk_bf16_f32 v42, v36, v37
  v_cvt_pk_bf16_f32 v43, v38, v39
  buffer_store_dwordx4 v[40:43], v2, s[36:39], s52 offen offset:0 sc1
  v_accvgpr_read_b32 v48, a200
  v_accvgpr_read_b32 v49, a201
  v_accvgpr_read_b32 v50, a202
  v_accvgpr_read_b32 v51, a203
  v_accvgpr_read_b32 v52, a204
  v_accvgpr_read_b32 v53, a205
  v_accvgpr_read_b32 v54, a206
  v_accvgpr_read_b32 v55, a207
  v_pk_mul_f32 v[48:49], v[48:49], v[20:21] op_sel_hi:[1,0]
  v_pk_mul_f32 v[50:51], v[50:51], v[20:21] op_sel_hi:[1,0]
  v_pk_mul_f32 v[52:53], v[52:53], v[20:21] op_sel_hi:[1,0]
  v_pk_mul_f32 v[54:55], v[54:55], v[20:21] op_sel_hi:[1,0]
  v_cvt_pk_bf16_f32 v56, v48, v49
  v_cvt_pk_bf16_f32 v57, v50, v51
  v_cvt_pk_bf16_f32 v58, v52, v53
  v_cvt_pk_bf16_f32 v59, v54, v55
  buffer_store_dwordx4 v[56:59], v2, s[36:39], s52 offen offset:1024 sc1
  v_accvgpr_read_b32 v64, a208
  v_accvgpr_read_b32 v65, a209
  v_accvgpr_read_b32 v66, a210
  v_accvgpr_read_b32 v67, a211
  v_accvgpr_read_b32 v68, a212
  v_accvgpr_read_b32 v69, a213
  v_accvgpr_read_b32 v70, a214
  v_accvgpr_read_b32 v71, a215
  v_pk_mul_f32 v[64:65], v[64:65], v[20:21] op_sel_hi:[1,0]
  v_pk_mul_f32 v[66:67], v[66:67], v[20:21] op_sel_hi:[1,0]
  v_pk_mul_f32 v[68:69], v[68:69], v[20:21] op_sel_hi:[1,0]
  v_pk_mul_f32 v[70:71], v[70:71], v[20:21] op_sel_hi:[1,0]
  v_cvt_pk_bf16_f32 v72, v64, v65
  v_cvt_pk_bf16_f32 v73, v66, v67
  v_cvt_pk_bf16_f32 v74, v68, v69
  v_cvt_pk_bf16_f32 v75, v70, v71
  buffer_store_dwordx4 v[72:75], v2, s[36:39], s52 offen offset:2048 sc1
  v_accvgpr_read_b32 v80, a216
  v_accvgpr_read_b32 v81, a217
  v_accvgpr_read_b32 v82, a218
  v_accvgpr_read_b32 v83, a219
  v_accvgpr_read_b32 v84, a220
  v_accvgpr_read_b32 v85, a221
  v_accvgpr_read_b32 v86, a222
  v_accvgpr_read_b32 v87, a223
  v_pk_mul_f32 v[80:81], v[80:81], v[20:21] op_sel_hi:[1,0]
  v_pk_mul_f32 v[82:83], v[82:83], v[20:21] op_sel_hi:[1,0]
  v_pk_mul_f32 v[84:85], v[84:85], v[20:21] op_sel_hi:[1,0]
  v_pk_mul_f32 v[86:87], v[86:87], v[20:21] op_sel_hi:[1,0]
  v_cvt_pk_bf16_f32 v88, v80, v81
  v_cvt_pk_bf16_f32 v89, v82, v83
  v_cvt_pk_bf16_f32 v90, v84, v85
  v_cvt_pk_bf16_f32 v91, v86, v87
  buffer_store_dwordx4 v[88:91], v2, s[36:39], s52 offen offset:3072 sc1
attn_kernel_done:
  s_endpgm
attn_kernel_slow0:
  v_mov_b32 v12, v11
  s_nop 1
  v_permlane32_swap_b32 v12, v11
  v_max_f32 v11, v12, v11
  v_mov_b32 v12, v11
  s_nop 1
  v_permlane16_swap_b32 v12, v11
  v_max_f32 v11, v12, v11
  v_max_f32 v11, 0, v11
  v_exp_f32 v19, -v11
  v_sub_f32 v164, v164, v11
  v_sub_f32 v165, v165, v11
  v_sub_f32 v166, v166, v11
  v_sub_f32 v167, v167, v11
  v_sub_f32 v172, v172, v11
  v_sub_f32 v173, v173, v11
  v_sub_f32 v174, v174, v11
  v_sub_f32 v175, v175, v11
  v_exp_f32 v28, v164
  v_exp_f32 v29, v165
  v_exp_f32 v30, v166
  v_exp_f32 v31, v167
  v_exp_f32 v14, v172
  v_exp_f32 v15, v173
  v_exp_f32 v16, v174
  v_exp_f32 v17, v175
  v_sub_f32 v212, v212, v11
  v_sub_f32 v213, v213, v11
  v_sub_f32 v214, v214, v11
  v_sub_f32 v215, v215, v11
  v_accvgpr_read_b32 v12, a0
  v_mul_f32 v12, v12, v19
  v_accvgpr_write_b32 a0, v12
  v_accvgpr_read_b32 v12, a1
  v_mul_f32 v12, v12, v19
  v_accvgpr_write_b32 a1, v12
  v_accvgpr_read_b32 v12, a2
  v_mul_f32 v12, v12, v19
  v_accvgpr_write_b32 a2, v12
  v_accvgpr_read_b32 v12, a3
  v_mul_f32 v12, v12, v19
  v_accvgpr_write_b32 a3, v12
  v_accvgpr_read_b32 v12, a4
  v_mul_f32 v12, v12, v19
  v_accvgpr_write_b32 a4, v12
  v_accvgpr_read_b32 v12, a5
  v_mul_f32 v12, v12, v19
  v_accvgpr_write_b32 a5, v12
  v_accvgpr_read_b32 v12, a6
  v_mul_f32 v12, v12, v19
  v_accvgpr_write_b32 a6, v12
  v_accvgpr_read_b32 v12, a7
  v_mul_f32 v12, v12, v19
  v_accvgpr_write_b32 a7, v12
  v_accvgpr_read_b32 v12, a8
  v_mul_f32 v12, v12, v19
  v_accvgpr_write_b32 a8, v12
  v_accvgpr_read_b32 v12, a9
  v_mul_f32 v12, v12, v19
  v_accvgpr_write_b32 a9, v12
  v_accvgpr_read_b32 v12, a10
  v_mul_f32 v12, v12, v19
  v_accvgpr_write_b32 a10, v12
  v_accvgpr_read_b32 v12, a11
  v_mul_f32 v12, v12, v19
  v_accvgpr_write_b32 a11, v12
  v_accvgpr_read_b32 v12, a12
  v_mul_f32 v12, v12, v19
  v_accvgpr_write_b32 a12, v12
  v_accvgpr_read_b32 v12, a13
  v_mul_f32 v12, v12, v19
  v_accvgpr_write_b32 a13, v12
  v_accvgpr_read_b32 v12, a14
  v_mul_f32 v12, v12, v19
  v_accvgpr_write_b32 a14, v12
  v_accvgpr_read_b32 v12, a15
  v_mul_f32 v12, v12, v19
  v_accvgpr_write_b32 a15, v12
  v_accvgpr_read_b32 v12, a16
  v_mul_f32 v12, v12, v19
  v_accvgpr_write_b32 a16, v12
  v_accvgpr_read_b32 v12, a17
  v_mul_f32 v12, v12, v19
  v_accvgpr_write_b32 a17, v12
  v_accvgpr_read_b32 v12, a18
  v_mul_f32 v12, v12, v19
  v_accvgpr_write_b32 a18, v12
  v_accvgpr_read_b32 v12, a19
  v_mul_f32 v12, v12, v19
  v_accvgpr_write_b32 a19, v12
  v_accvgpr_read_b32 v12, a20
  v_mul_f32 v12, v12, v19
  v_accvgpr_write_b32 a20, v12
  v_accvgpr_read_b32 v12, a21
  v_mul_f32 v12, v12, v19
  v_accvgpr_write_b32 a21, v12
  v_accvgpr_read_b32 v12, a22
  v_mul_f32 v12, v12, v19
  v_accvgpr_write_b32 a22, v12
  v_accvgpr_read_b32 v12, a23
  v_mul_f32 v12, v12, v19
  v_accvgpr_write_b32 a23, v12
  v_accvgpr_read_b32 v12, a24
  v_mul_f32 v12, v12, v19
  v_accvgpr_write_b32 a24, v12
  v_accvgpr_read_b32 v12, a25
  v_mul_f32 v12, v12, v19
  v_accvgpr_write_b32 a25, v12
  v_accvgpr_read_b32 v12, a26
  v_mul_f32 v12, v12, v19
  v_accvgpr_write_b32 a26, v12
  v_accvgpr_read_b32 v12, a27
  v_mul_f32 v12, v12, v19
  v_accvgpr_write_b32 a27, v12
  v_accvgpr_read_b32 v12, a28
  v_mul_f32 v12, v12, v19
  v_accvgpr_write_b32 a28, v12
  v_accvgpr_read_b32 v12, a29
  v_mul_f32 v12, v12, v19
  v_accvgpr_write_b32 a29, v12
  v_accvgpr_read_b32 v12, a30
  v_mul_f32 v12, v12, v19
  v_accvgpr_write_b32 a30, v12
  v_accvgpr_read_b32 v12, a31
  v_mul_f32 v12, v12, v19
  v_accvgpr_write_b32 a31, v12
  v_accvgpr_read_b32 v12, a224
  v_mul_f32 v12, v12, v19
  v_accvgpr_write_b32 a224, v12
  v_accvgpr_read_b32 v12, a225
  v_mul_f32 v12, v12, v19
  v_accvgpr_write_b32 a225, v12
  v_accvgpr_read_b32 v12, a226
  v_mul_f32 v12, v12, v19
  v_accvgpr_write_b32 a226, v12
  v_accvgpr_read_b32 v12, a227
  v_mul_f32 v12, v12, v19
  v_accvgpr_write_b32 a227, v12
  s_nop 1
  s_branch attn_kernel_back0
attn_kernel_slow1:
  v_mov_b32 v12, v11
  s_nop 1
  v_permlane32_swap_b32 v12, v11
  v_max_f32 v11, v12, v11
  v_mov_b32 v12, v11
  s_nop 1
  v_permlane16_swap_b32 v12, v11
  v_max_f32 v11, v12, v11
  v_max_f32 v11, 0, v11
  v_exp_f32 v19, -v11
  v_sub_f32 v180, v180, v11
  v_sub_f32 v181, v181, v11
  v_sub_f32 v182, v182, v11
  v_sub_f32 v183, v183, v11
  v_sub_f32 v188, v188, v11
  v_sub_f32 v189, v189, v11
  v_sub_f32 v190, v190, v11
  v_sub_f32 v191, v191, v11
  v_exp_f32 v28, v180
  v_exp_f32 v29, v181
  v_exp_f32 v30, v182
  v_exp_f32 v31, v183
  v_exp_f32 v14, v188
  v_exp_f32 v15, v189
  v_exp_f32 v16, v190
  v_exp_f32 v17, v191
  v_sub_f32 v220, v220, v11
  v_sub_f32 v221, v221, v11
  v_sub_f32 v222, v222, v11
  v_sub_f32 v223, v223, v11
  v_accvgpr_read_b32 v12, a32
  v_mul_f32 v12, v12, v19
  v_accvgpr_write_b32 a32, v12
  v_accvgpr_read_b32 v12, a33
  v_mul_f32 v12, v12, v19
  v_accvgpr_write_b32 a33, v12
  v_accvgpr_read_b32 v12, a34
  v_mul_f32 v12, v12, v19
  v_accvgpr_write_b32 a34, v12
  v_accvgpr_read_b32 v12, a35
  v_mul_f32 v12, v12, v19
  v_accvgpr_write_b32 a35, v12
  v_accvgpr_read_b32 v12, a36
  v_mul_f32 v12, v12, v19
  v_accvgpr_write_b32 a36, v12
  v_accvgpr_read_b32 v12, a37
  v_mul_f32 v12, v12, v19
  v_accvgpr_write_b32 a37, v12
  v_accvgpr_read_b32 v12, a38
  v_mul_f32 v12, v12, v19
  v_accvgpr_write_b32 a38, v12
  v_accvgpr_read_b32 v12, a39
  v_mul_f32 v12, v12, v19
  v_accvgpr_write_b32 a39, v12
  v_accvgpr_read_b32 v12, a40
  v_mul_f32 v12, v12, v19
  v_accvgpr_write_b32 a40, v12
  v_accvgpr_read_b32 v12, a41
  v_mul_f32 v12, v12, v19
  v_accvgpr_write_b32 a41, v12
  v_accvgpr_read_b32 v12, a42
  v_mul_f32 v12, v12, v19
  v_accvgpr_write_b32 a42, v12
  v_accvgpr_read_b32 v12, a43
  v_mul_f32 v12, v12, v19
  v_accvgpr_write_b32 a43, v12
  v_accvgpr_read_b32 v12, a44
  v_mul_f32 v12, v12, v19
  v_accvgpr_write_b32 a44, v12
  v_accvgpr_read_b32 v12, a45
  v_mul_f32 v12, v12, v19
  v_accvgpr_write_b32 a45, v12
  v_accvgpr_read_b32 v12, a46
  v_mul_f32 v12, v12, v19
  v_accvgpr_write_b32 a46, v12
  v_accvgpr_read_b32 v12, a47
  v_mul_f32 v12, v12, v19
  v_accvgpr_write_b32 a47, v12
  v_accvgpr_read_b32 v12, a48
  v_mul_f32 v12, v12, v19
  v_accvgpr_write_b32 a48, v12
  v_accvgpr_read_b32 v12, a49
  v_mul_f32 v12, v12, v19
  v_accvgpr_write_b32 a49, v12
  v_accvgpr_read_b32 v12, a50
  v_mul_f32 v12, v12, v19
  v_accvgpr_write_b32 a50, v12
  v_accvgpr_read_b32 v12, a51
  v_mul_f32 v12, v12, v19
  v_accvgpr_write_b32 a51, v12
  v_accvgpr_read_b32 v12, a52
  v_mul_f32 v12, v12, v19
  v_accvgpr_write_b32 a52, v12
  v_accvgpr_read_b32 v12, a53
  v_mul_f32 v12, v12, v19
  v_accvgpr_write_b32 a53, v12
  v_accvgpr_read_b32 v12, a54
  v_mul_f32 v12, v12, v19
  v_accvgpr_write_b32 a54, v12
  v_accvgpr_read_b32 v12, a55
  v_mul_f32 v12, v12, v19
  v_accvgpr_write_b32 a55, v12
  v_accvgpr_read_b32 v12, a56
  v_mul_f32 v12, v12, v19
  v_accvgpr_write_b32 a56, v12
  v_accvgpr_read_b32 v12, a57
  v_mul_f32 v12, v12, v19
  v_accvgpr_write_b32 a57, v12
  v_accvgpr_read_b32 v12, a58
  v_mul_f32 v12, v12, v19
  v_accvgpr_write_b32 a58, v12
  v_accvgpr_read_b32 v12, a59
  v_mul_f32 v12, v12, v19
  v_accvgpr_write_b32 a59, v12
  v_accvgpr_read_b32 v12, a60
  v_mul_f32 v12, v12, v19
  v_accvgpr_write_b32 a60, v12
  v_accvgpr_read_b32 v12, a61
  v_mul_f32 v12, v12, v19
  v_accvgpr_write_b32 a61, v12
  v_accvgpr_read_b32 v12, a62
  v_mul_f32 v12, v12, v19
  v_accvgpr_write_b32 a62, v12
  v_accvgpr_read_b32 v12, a63
  v_mul_f32 v12, v12, v19
  v_accvgpr_write_b32 a63, v12
  v_accvgpr_read_b32 v12, a228
  v_mul_f32 v12, v12, v19
  v_accvgpr_write_b32 a228, v12
  v_accvgpr_read_b32 v12, a229
  v_mul_f32 v12, v12, v19
  v_accvgpr_write_b32 a229, v12
  v_accvgpr_read_b32 v12, a230
  v_mul_f32 v12, v12, v19
  v_accvgpr_write_b32 a230, v12
  v_accvgpr_read_b32 v12, a231
  v_mul_f32 v12, v12, v19
  v_accvgpr_write_b32 a231, v12
  s_nop 1
  s_branch attn_kernel_back1
attn_kernel_slow2:
  v_mov_b32 v12, v11
  s_nop 1
  v_permlane32_swap_b32 v12, v11
  v_max_f32 v11, v12, v11
  v_mov_b32 v12, v11
  s_nop 1
  v_permlane16_swap_b32 v12, v11
  v_max_f32 v11, v12, v11
  v_max_f32 v11, 0, v11
  v_exp_f32 v19, -v11
  v_sub_f32 v164, v164, v11
  v_sub_f32 v165, v165, v11
  v_sub_f32 v166, v166, v11
  v_sub_f32 v167, v167, v11
  v_sub_f32 v172, v172, v11
  v_sub_f32 v173, v173, v11
  v_sub_f32 v174, v174, v11
  v_sub_f32 v175, v175, v11
  v_exp_f32 v28, v164
  v_exp_f32 v29, v165
  v_exp_f32 v30, v166
  v_exp_f32 v31, v167
  v_exp_f32 v14, v172
  v_exp_f32 v15, v173
  v_exp_f32 v16, v174
  v_exp_f32 v17, v175
  v_sub_f32 v228, v228, v11
  v_sub_f32 v229, v229, v11
  v_sub_f32 v230, v230, v11
  v_sub_f32 v231, v231, v11
  v_accvgpr_read_b32 v12, a64
  v_mul_f32 v12, v12, v19
  v_accvgpr_write_b32 a64, v12
  v_accvgpr_read_b32 v12, a65
  v_mul_f32 v12, v12, v19
  v_accvgpr_write_b32 a65, v12
  v_accvgpr_read_b32 v12, a66
  v_mul_f32 v12, v12, v19
  v_accvgpr_write_b32 a66, v12
  v_accvgpr_read_b32 v12, a67
  v_mul_f32 v12, v12, v19
  v_accvgpr_write_b32 a67, v12
  v_accvgpr_read_b32 v12, a68
  v_mul_f32 v12, v12, v19
  v_accvgpr_write_b32 a68, v12
  v_accvgpr_read_b32 v12, a69
  v_mul_f32 v12, v12, v19
  v_accvgpr_write_b32 a69, v12
  v_accvgpr_read_b32 v12, a70
  v_mul_f32 v12, v12, v19
  v_accvgpr_write_b32 a70, v12
  v_accvgpr_read_b32 v12, a71
  v_mul_f32 v12, v12, v19
  v_accvgpr_write_b32 a71, v12
  v_accvgpr_read_b32 v12, a72
  v_mul_f32 v12, v12, v19
  v_accvgpr_write_b32 a72, v12
  v_accvgpr_read_b32 v12, a73
  v_mul_f32 v12, v12, v19
  v_accvgpr_write_b32 a73, v12
  v_accvgpr_read_b32 v12, a74
  v_mul_f32 v12, v12, v19
  v_accvgpr_write_b32 a74, v12
  v_accvgpr_read_b32 v12, a75
  v_mul_f32 v12, v12, v19
  v_accvgpr_write_b32 a75, v12
  v_accvgpr_read_b32 v12, a76
  v_mul_f32 v12, v12, v19
  v_accvgpr_write_b32 a76, v12
  v_accvgpr_read_b32 v12, a77
  v_mul_f32 v12, v12, v19
  v_accvgpr_write_b32 a77, v12
  v_accvgpr_read_b32 v12, a78
  v_mul_f32 v12, v12, v19
  v_accvgpr_write_b32 a78, v12
  v_accvgpr_read_b32 v12, a79
  v_mul_f32 v12, v12, v19
  v_accvgpr_write_b32 a79, v12
  v_accvgpr_read_b32 v12, a80
  v_mul_f32 v12, v12, v19
  v_accvgpr_write_b32 a80, v12
  v_accvgpr_read_b32 v12, a81
  v_mul_f32 v12, v12, v19
  v_accvgpr_write_b32 a81, v12
  v_accvgpr_read_b32 v12, a82
  v_mul_f32 v12, v12, v19
  v_accvgpr_write_b32 a82, v12
  v_accvgpr_read_b32 v12, a83
  v_mul_f32 v12, v12, v19
  v_accvgpr_write_b32 a83, v12
  v_accvgpr_read_b32 v12, a84
  v_mul_f32 v12, v12, v19
  v_accvgpr_write_b32 a84, v12
  v_accvgpr_read_b32 v12, a85
  v_mul_f32 v12, v12, v19
  v_accvgpr_write_b32 a85, v12
  v_accvgpr_read_b32 v12, a86
  v_mul_f32 v12, v12, v19
  v_accvgpr_write_b32 a86, v12
  v_accvgpr_read_b32 v12, a87
  v_mul_f32 v12, v12, v19
  v_accvgpr_write_b32 a87, v12
  v_accvgpr_read_b32 v12, a88
  v_mul_f32 v12, v12, v19
  v_accvgpr_write_b32 a88, v12
  v_accvgpr_read_b32 v12, a89
  v_mul_f32 v12, v12, v19
  v_accvgpr_write_b32 a89, v12
  v_accvgpr_read_b32 v12, a90
  v_mul_f32 v12, v12, v19
  v_accvgpr_write_b32 a90, v12
  v_accvgpr_read_b32 v12, a91
  v_mul_f32 v12, v12, v19
  v_accvgpr_write_b32 a91, v12
  v_accvgpr_read_b32 v12, a92
  v_mul_f32 v12, v12, v19
  v_accvgpr_write_b32 a92, v12
  v_accvgpr_read_b32 v12, a93
  v_mul_f32 v12, v12, v19
  v_accvgpr_write_b32 a93, v12
  v_accvgpr_read_b32 v12, a94
  v_mul_f32 v12, v12, v19
  v_accvgpr_write_b32 a94, v12
  v_accvgpr_read_b32 v12, a95
  v_mul_f32 v12, v12, v19
  v_accvgpr_write_b32 a95, v12
  v_accvgpr_read_b32 v12, a232
  v_mul_f32 v12, v12, v19
  v_accvgpr_write_b32 a232, v12
  v_accvgpr_read_b32 v12, a233
  v_mul_f32 v12, v12, v19
  v_accvgpr_write_b32 a233, v12
  v_accvgpr_read_b32 v12, a234
  v_mul_f32 v12, v12, v19
  v_accvgpr_write_b32 a234, v12
  v_accvgpr_read_b32 v12, a235
  v_mul_f32 v12, v12, v19
  v_accvgpr_write_b32 a235, v12
  s_nop 1
  s_branch attn_kernel_back2
attn_kernel_slow3:
  v_mov_b32 v12, v11
  s_nop 1
  v_permlane32_swap_b32 v12, v11
  v_max_f32 v11, v12, v11
  v_mov_b32 v12, v11
  s_nop 1
  v_permlane16_swap_b32 v12, v11
  v_max_f32 v11, v12, v11
  v_max_f32 v11, 0, v11
  v_exp_f32 v19, -v11
  v_sub_f32 v180, v180, v11
  v_sub_f32 v181, v181, v11
  v_sub_f32 v182, v182, v11
  v_sub_f32 v183, v183, v11
  v_sub_f32 v188, v188, v11
  v_sub_f32 v189, v189, v11
  v_sub_f32 v190, v190, v11
  v_sub_f32 v191, v191, v11
  v_exp_f32 v28, v180
  v_exp_f32 v29, v181
  v_exp_f32 v30, v182
  v_exp_f32 v31, v183
  v_exp_f32 v14, v188
  v_exp_f32 v15, v189
  v_exp_f32 v16, v190
  v_exp_f32 v17, v191
  v_sub_f32 v236, v236, v11
  v_sub_f32 v237, v237, v11
  v_sub_f32 v238, v238, v11
  v_sub_f32 v239, v239, v11
  v_accvgpr_read_b32 v12, a96
  v_mul_f32 v12, v12, v19
  v_accvgpr_write_b32 a96, v12
  v_accvgpr_read_b32 v12, a97
  v_mul_f32 v12, v12, v19
  v_accvgpr_write_b32 a97, v12
  v_accvgpr_read_b32 v12, a98
  v_mul_f32 v12, v12, v19
  v_accvgpr_write_b32 a98, v12
  v_accvgpr_read_b32 v12, a99
  v_mul_f32 v12, v12, v19
  v_accvgpr_write_b32 a99, v12
  v_accvgpr_read_b32 v12, a100
  v_mul_f32 v12, v12, v19
  v_accvgpr_write_b32 a100, v12
  v_accvgpr_read_b32 v12, a101
  v_mul_f32 v12, v12, v19
  v_accvgpr_write_b32 a101, v12
  v_accvgpr_read_b32 v12, a102
  v_mul_f32 v12, v12, v19
  v_accvgpr_write_b32 a102, v12
  v_accvgpr_read_b32 v12, a103
  v_mul_f32 v12, v12, v19
  v_accvgpr_write_b32 a103, v12
  v_accvgpr_read_b32 v12, a104
  v_mul_f32 v12, v12, v19
  v_accvgpr_write_b32 a104, v12
  v_accvgpr_read_b32 v12, a105
  v_mul_f32 v12, v12, v19
  v_accvgpr_write_b32 a105, v12
  v_accvgpr_read_b32 v12, a106
  v_mul_f32 v12, v12, v19
  v_accvgpr_write_b32 a106, v12
  v_accvgpr_read_b32 v12, a107
  v_mul_f32 v12, v12, v19
  v_accvgpr_write_b32 a107, v12
  v_accvgpr_read_b32 v12, a108
  v_mul_f32 v12, v12, v19
  v_accvgpr_write_b32 a108, v12
  v_accvgpr_read_b32 v12, a109
  v_mul_f32 v12, v12, v19
  v_accvgpr_write_b32 a109, v12
  v_accvgpr_read_b32 v12, a110
  v_mul_f32 v12, v12, v19
  v_accvgpr_write_b32 a110, v12
  v_accvgpr_read_b32 v12, a111
  v_mul_f32 v12, v12, v19
  v_accvgpr_write_b32 a111, v12
  v_accvgpr_read_b32 v12, a112
  v_mul_f32 v12, v12, v19
  v_accvgpr_write_b32 a112, v12
  v_accvgpr_read_b32 v12, a113
  v_mul_f32 v12, v12, v19
  v_accvgpr_write_b32 a113, v12
  v_accvgpr_read_b32 v12, a114
  v_mul_f32 v12, v12, v19
  v_accvgpr_write_b32 a114, v12
  v_accvgpr_read_b32 v12, a115
  v_mul_f32 v12, v12, v19
  v_accvgpr_write_b32 a115, v12
  v_accvgpr_read_b32 v12, a116
  v_mul_f32 v12, v12, v19
  v_accvgpr_write_b32 a116, v12
  v_accvgpr_read_b32 v12, a117
  v_mul_f32 v12, v12, v19
  v_accvgpr_write_b32 a117, v12
  v_accvgpr_read_b32 v12, a118
  v_mul_f32 v12, v12, v19
  v_accvgpr_write_b32 a118, v12
  v_accvgpr_read_b32 v12, a119
  v_mul_f32 v12, v12, v19
  v_accvgpr_write_b32 a119, v12
  v_accvgpr_read_b32 v12, a120
  v_mul_f32 v12, v12, v19
  v_accvgpr_write_b32 a120, v12
  v_accvgpr_read_b32 v12, a121
  v_mul_f32 v12, v12, v19
  v_accvgpr_write_b32 a121, v12
  v_accvgpr_read_b32 v12, a122
  v_mul_f32 v12, v12, v19
  v_accvgpr_write_b32 a122, v12
  v_accvgpr_read_b32 v12, a123
  v_mul_f32 v12, v12, v19
  v_accvgpr_write_b32 a123, v12
  v_accvgpr_read_b32 v12, a124
  v_mul_f32 v12, v12, v19
  v_accvgpr_write_b32 a124, v12
  v_accvgpr_read_b32 v12, a125
  v_mul_f32 v12, v12, v19
  v_accvgpr_write_b32 a125, v12
  v_accvgpr_read_b32 v12, a126
  v_mul_f32 v12, v12, v19
  v_accvgpr_write_b32 a126, v12
  v_accvgpr_read_b32 v12, a127
  v_mul_f32 v12, v12, v19
  v_accvgpr_write_b32 a127, v12
  v_accvgpr_read_b32 v12, a236
  v_mul_f32 v12, v12, v19
  v_accvgpr_write_b32 a236, v12
  v_accvgpr_read_b32 v12, a237
  v_mul_f32 v12, v12, v19
  v_accvgpr_write_b32 a237, v12
  v_accvgpr_read_b32 v12, a238
  v_mul_f32 v12, v12, v19
  v_accvgpr_write_b32 a238, v12
  v_accvgpr_read_b32 v12, a239
  v_mul_f32 v12, v12, v19
  v_accvgpr_write_b32 a239, v12
  s_nop 1
  s_branch attn_kernel_back3
attn_kernel_slow4:
  v_mov_b32 v12, v11
  s_nop 1
  v_permlane32_swap_b32 v12, v11
  v_max_f32 v11, v12, v11
  v_mov_b32 v12, v11
  s_nop 1
  v_permlane16_swap_b32 v12, v11
  v_max_f32 v11, v12, v11
  v_max_f32 v11, 0, v11
  v_exp_f32 v19, -v11
  v_sub_f32 v164, v164, v11
  v_sub_f32 v165, v165, v11
  v_sub_f32 v166, v166, v11
  v_sub_f32 v167, v167, v11
  v_sub_f32 v172, v172, v11
  v_sub_f32 v173, v173, v11
  v_sub_f32 v174, v174, v11
  v_sub_f32 v175, v175, v11
  v_exp_f32 v28, v164
  v_exp_f32 v29, v165
  v_exp_f32 v30, v166
  v_exp_f32 v31, v167
  v_exp_f32 v14, v172
  v_exp_f32 v15, v173
  v_exp_f32 v16, v174
  v_exp_f32 v17, v175
  v_sub_f32 v244, v244, v11
  v_sub_f32 v245, v245, v11
  v_sub_f32 v246, v246, v11
  v_sub_f32 v247, v247, v11
  v_accvgpr_read_b32 v12, a128
  v_mul_f32 v12, v12, v19
  v_accvgpr_write_b32 a128, v12
  v_accvgpr_read_b32 v12, a129
  v_mul_f32 v12, v12, v19
  v_accvgpr_write_b32 a129, v12
  v_accvgpr_read_b32 v12, a130
  v_mul_f32 v12, v12, v19
  v_accvgpr_write_b32 a130, v12
  v_accvgpr_read_b32 v12, a131
  v_mul_f32 v12, v12, v19
  v_accvgpr_write_b32 a131, v12
  v_accvgpr_read_b32 v12, a132
  v_mul_f32 v12, v12, v19
  v_accvgpr_write_b32 a132, v12
  v_accvgpr_read_b32 v12, a133
  v_mul_f32 v12, v12, v19
  v_accvgpr_write_b32 a133, v12
  v_accvgpr_read_b32 v12, a134
  v_mul_f32 v12, v12, v19
  v_accvgpr_write_b32 a134, v12
  v_accvgpr_read_b32 v12, a135
  v_mul_f32 v12, v12, v19
  v_accvgpr_write_b32 a135, v12
  v_accvgpr_read_b32 v12, a136
  v_mul_f32 v12, v12, v19
  v_accvgpr_write_b32 a136, v12
  v_accvgpr_read_b32 v12, a137
  v_mul_f32 v12, v12, v19
  v_accvgpr_write_b32 a137, v12
  v_accvgpr_read_b32 v12, a138
  v_mul_f32 v12, v12, v19
  v_accvgpr_write_b32 a138, v12
  v_accvgpr_read_b32 v12, a139
  v_mul_f32 v12, v12, v19
  v_accvgpr_write_b32 a139, v12
  v_accvgpr_read_b32 v12, a140
  v_mul_f32 v12, v12, v19
  v_accvgpr_write_b32 a140, v12
  v_accvgpr_read_b32 v12, a141
  v_mul_f32 v12, v12, v19
  v_accvgpr_write_b32 a141, v12
  v_accvgpr_read_b32 v12, a142
  v_mul_f32 v12, v12, v19
  v_accvgpr_write_b32 a142, v12
  v_accvgpr_read_b32 v12, a143
  v_mul_f32 v12, v12, v19
  v_accvgpr_write_b32 a143, v12
  v_accvgpr_read_b32 v12, a144
  v_mul_f32 v12, v12, v19
  v_accvgpr_write_b32 a144, v12
  v_accvgpr_read_b32 v12, a145
  v_mul_f32 v12, v12, v19
  v_accvgpr_write_b32 a145, v12
  v_accvgpr_read_b32 v12, a146
  v_mul_f32 v12, v12, v19
  v_accvgpr_write_b32 a146, v12
  v_accvgpr_read_b32 v12, a147
  v_mul_f32 v12, v12, v19
  v_accvgpr_write_b32 a147, v12
  v_accvgpr_read_b32 v12, a148
  v_mul_f32 v12, v12, v19
  v_accvgpr_write_b32 a148, v12
  v_accvgpr_read_b32 v12, a149
  v_mul_f32 v12, v12, v19
  v_accvgpr_write_b32 a149, v12
  v_accvgpr_read_b32 v12, a150
  v_mul_f32 v12, v12, v19
  v_accvgpr_write_b32 a150, v12
  v_accvgpr_read_b32 v12, a151
  v_mul_f32 v12, v12, v19
  v_accvgpr_write_b32 a151, v12
  v_accvgpr_read_b32 v12, a152
  v_mul_f32 v12, v12, v19
  v_accvgpr_write_b32 a152, v12
  v_accvgpr_read_b32 v12, a153
  v_mul_f32 v12, v12, v19
  v_accvgpr_write_b32 a153, v12
  v_accvgpr_read_b32 v12, a154
  v_mul_f32 v12, v12, v19
  v_accvgpr_write_b32 a154, v12
  v_accvgpr_read_b32 v12, a155
  v_mul_f32 v12, v12, v19
  v_accvgpr_write_b32 a155, v12
  v_accvgpr_read_b32 v12, a156
  v_mul_f32 v12, v12, v19
  v_accvgpr_write_b32 a156, v12
  v_accvgpr_read_b32 v12, a157
  v_mul_f32 v12, v12, v19
  v_accvgpr_write_b32 a157, v12
  v_accvgpr_read_b32 v12, a158
  v_mul_f32 v12, v12, v19
  v_accvgpr_write_b32 a158, v12
  v_accvgpr_read_b32 v12, a159
  v_mul_f32 v12, v12, v19
  v_accvgpr_write_b32 a159, v12
  v_accvgpr_read_b32 v12, a240
  v_mul_f32 v12, v12, v19
  v_accvgpr_write_b32 a240, v12
  v_accvgpr_read_b32 v12, a241
  v_mul_f32 v12, v12, v19
  v_accvgpr_write_b32 a241, v12
  v_accvgpr_read_b32 v12, a242
  v_mul_f32 v12, v12, v19
  v_accvgpr_write_b32 a242, v12
  v_accvgpr_read_b32 v12, a243
  v_mul_f32 v12, v12, v19
  v_accvgpr_write_b32 a243, v12
  s_nop 1
  s_branch attn_kernel_back4
attn_kernel_slow5:
  v_mov_b32 v12, v11
  s_nop 1
  v_permlane32_swap_b32 v12, v11
  v_max_f32 v11, v12, v11
  v_mov_b32 v12, v11
  s_nop 1
  v_permlane16_swap_b32 v12, v11
  v_max_f32 v11, v12, v11
  v_max_f32 v11, 0, v11
  v_exp_f32 v19, -v11
  v_sub_f32 v180, v180, v11
  v_sub_f32 v181, v181, v11
  v_sub_f32 v182, v182, v11
  v_sub_f32 v183, v183, v11
  v_sub_f32 v188, v188, v11
  v_sub_f32 v189, v189, v11
  v_sub_f32 v190, v190, v11
  v_sub_f32 v191, v191, v11
  v_exp_f32 v28, v180
  v_exp_f32 v29, v181
  v_exp_f32 v30, v182
  v_exp_f32 v31, v183
  v_exp_f32 v14, v188
  v_exp_f32 v15, v189
  v_exp_f32 v16, v190
  v_exp_f32 v17, v191
  v_sub_f32 v252, v252, v11
  v_sub_f32 v253, v253, v11
  v_sub_f32 v254, v254, v11
  v_sub_f32 v255, v255, v11
  v_accvgpr_read_b32 v12, a160
  v_mul_f32 v12, v12, v19
  v_accvgpr_write_b32 a160, v12
  v_accvgpr_read_b32 v12, a161
  v_mul_f32 v12, v12, v19
  v_accvgpr_write_b32 a161, v12
  v_accvgpr_read_b32 v12, a162
  v_mul_f32 v12, v12, v19
  v_accvgpr_write_b32 a162, v12
  v_accvgpr_read_b32 v12, a163
  v_mul_f32 v12, v12, v19
  v_accvgpr_write_b32 a163, v12
  v_accvgpr_read_b32 v12, a164
  v_mul_f32 v12, v12, v19
  v_accvgpr_write_b32 a164, v12
  v_accvgpr_read_b32 v12, a165
  v_mul_f32 v12, v12, v19
  v_accvgpr_write_b32 a165, v12
  v_accvgpr_read_b32 v12, a166
  v_mul_f32 v12, v12, v19
  v_accvgpr_write_b32 a166, v12
  v_accvgpr_read_b32 v12, a167
  v_mul_f32 v12, v12, v19
  v_accvgpr_write_b32 a167, v12
  v_accvgpr_read_b32 v12, a168
  v_mul_f32 v12, v12, v19
  v_accvgpr_write_b32 a168, v12
  v_accvgpr_read_b32 v12, a169
  v_mul_f32 v12, v12, v19
  v_accvgpr_write_b32 a169, v12
  v_accvgpr_read_b32 v12, a170
  v_mul_f32 v12, v12, v19
  v_accvgpr_write_b32 a170, v12
  v_accvgpr_read_b32 v12, a171
  v_mul_f32 v12, v12, v19
  v_accvgpr_write_b32 a171, v12
  v_accvgpr_read_b32 v12, a172
  v_mul_f32 v12, v12, v19
  v_accvgpr_write_b32 a172, v12
  v_accvgpr_read_b32 v12, a173
  v_mul_f32 v12, v12, v19
  v_accvgpr_write_b32 a173, v12
  v_accvgpr_read_b32 v12, a174
  v_mul_f32 v12, v12, v19
  v_accvgpr_write_b32 a174, v12
  v_accvgpr_read_b32 v12, a175
  v_mul_f32 v12, v12, v19
  v_accvgpr_write_b32 a175, v12
  v_accvgpr_read_b32 v12, a176
  v_mul_f32 v12, v12, v19
  v_accvgpr_write_b32 a176, v12
  v_accvgpr_read_b32 v12, a177
  v_mul_f32 v12, v12, v19
  v_accvgpr_write_b32 a177, v12
  v_accvgpr_read_b32 v12, a178
  v_mul_f32 v12, v12, v19
  v_accvgpr_write_b32 a178, v12
  v_accvgpr_read_b32 v12, a179
  v_mul_f32 v12, v12, v19
  v_accvgpr_write_b32 a179, v12
  v_accvgpr_read_b32 v12, a180
  v_mul_f32 v12, v12, v19
  v_accvgpr_write_b32 a180, v12
  v_accvgpr_read_b32 v12, a181
  v_mul_f32 v12, v12, v19
  v_accvgpr_write_b32 a181, v12
  v_accvgpr_read_b32 v12, a182
  v_mul_f32 v12, v12, v19
  v_accvgpr_write_b32 a182, v12
  v_accvgpr_read_b32 v12, a183
  v_mul_f32 v12, v12, v19
  v_accvgpr_write_b32 a183, v12
  v_accvgpr_read_b32 v12, a184
  v_mul_f32 v12, v12, v19
  v_accvgpr_write_b32 a184, v12
  v_accvgpr_read_b32 v12, a185
  v_mul_f32 v12, v12, v19
  v_accvgpr_write_b32 a185, v12
  v_accvgpr_read_b32 v12, a186
  v_mul_f32 v12, v12, v19
  v_accvgpr_write_b32 a186, v12
  v_accvgpr_read_b32 v12, a187
  v_mul_f32 v12, v12, v19
  v_accvgpr_write_b32 a187, v12
  v_accvgpr_read_b32 v12, a188
  v_mul_f32 v12, v12, v19
  v_accvgpr_write_b32 a188, v12
  v_accvgpr_read_b32 v12, a189
  v_mul_f32 v12, v12, v19
  v_accvgpr_write_b32 a189, v12
  v_accvgpr_read_b32 v12, a190
  v_mul_f32 v12, v12, v19
  v_accvgpr_write_b32 a190, v12
  v_accvgpr_read_b32 v12, a191
  v_mul_f32 v12, v12, v19
  v_accvgpr_write_b32 a191, v12
  v_accvgpr_read_b32 v12, a244
  v_mul_f32 v12, v12, v19
  v_accvgpr_write_b32 a244, v12
  v_accvgpr_read_b32 v12, a245
  v_mul_f32 v12, v12, v19
  v_accvgpr_write_b32 a245, v12
  v_accvgpr_read_b32 v12, a246
  v_mul_f32 v12, v12, v19
  v_accvgpr_write_b32 a246, v12
  v_accvgpr_read_b32 v12, a247
  v_mul_f32 v12, v12, v19
  v_accvgpr_write_b32 a247, v12
  s_nop 1
  s_branch attn_kernel_back5
attn_kernel_slow6:
  v_mov_b32 v12, v11
  s_nop 1
  v_permlane32_swap_b32 v12, v11
  v_max_f32 v11, v12, v11
  v_mov_b32 v12, v11
  s_nop 1
  v_permlane16_swap_b32 v12, v11
  v_max_f32 v11, v12, v11
  v_max_f32 v11, 0, v11
  v_exp_f32 v19, -v11
  v_sub_f32 v196, v196, v11
  v_sub_f32 v197, v197, v11
  v_sub_f32 v198, v198, v11
  v_sub_f32 v199, v199, v11
  v_sub_f32 v204, v204, v11
  v_sub_f32 v205, v205, v11
  v_sub_f32 v206, v206, v11
  v_sub_f32 v207, v207, v11
  v_exp_f32 v28, v196
  v_exp_f32 v29, v197
  v_exp_f32 v30, v198
  v_exp_f32 v31, v199
  v_exp_f32 v14, v204
  v_exp_f32 v15, v205
  v_exp_f32 v16, v206
  v_exp_f32 v17, v207
  v_sub_f32 v20, v20, v11
  v_sub_f32 v21, v21, v11
  v_sub_f32 v22, v22, v11
  v_sub_f32 v23, v23, v11
  v_accvgpr_read_b32 v12, a192
  v_mul_f32 v12, v12, v19
  v_accvgpr_write_b32 a192, v12
  v_accvgpr_read_b32 v12, a193
  v_mul_f32 v12, v12, v19
  v_accvgpr_write_b32 a193, v12
  v_accvgpr_read_b32 v12, a194
  v_mul_f32 v12, v12, v19
  v_accvgpr_write_b32 a194, v12
  v_accvgpr_read_b32 v12, a195
  v_mul_f32 v12, v12, v19
  v_accvgpr_write_b32 a195, v12
  v_accvgpr_read_b32 v12, a196
  v_mul_f32 v12, v12, v19
  v_accvgpr_write_b32 a196, v12
  v_accvgpr_read_b32 v12, a197
  v_mul_f32 v12, v12, v19
  v_accvgpr_write_b32 a197, v12
  v_accvgpr_read_b32 v12, a198
  v_mul_f32 v12, v12, v19
  v_accvgpr_write_b32 a198, v12
  v_accvgpr_read_b32 v12, a199
  v_mul_f32 v12, v12, v19
  v_accvgpr_write_b32 a199, v12
  v_accvgpr_read_b32 v12, a200
  v_mul_f32 v12, v12, v19
  v_accvgpr_write_b32 a200, v12
  v_accvgpr_read_b32 v12, a201
  v_mul_f32 v12, v12, v19
  v_accvgpr_write_b32 a201, v12
  v_accvgpr_read_b32 v12, a202
  v_mul_f32 v12, v12, v19
  v_accvgpr_write_b32 a202, v12
  v_accvgpr_read_b32 v12, a203
  v_mul_f32 v12, v12, v19
  v_accvgpr_write_b32 a203, v12
  v_accvgpr_read_b32 v12, a204
  v_mul_f32 v12, v12, v19
  v_accvgpr_write_b32 a204, v12
  v_accvgpr_read_b32 v12, a205
  v_mul_f32 v12, v12, v19
  v_accvgpr_write_b32 a205, v12
  v_accvgpr_read_b32 v12, a206
  v_mul_f32 v12, v12, v19
  v_accvgpr_write_b32 a206, v12
  v_accvgpr_read_b32 v12, a207
  v_mul_f32 v12, v12, v19
  v_accvgpr_write_b32 a207, v12
  v_accvgpr_read_b32 v12, a208
  v_mul_f32 v12, v12, v19
  v_accvgpr_write_b32 a208, v12
  v_accvgpr_read_b32 v12, a209
  v_mul_f32 v12, v12, v19
  v_accvgpr_write_b32 a209, v12
  v_accvgpr_read_b32 v12, a210
  v_mul_f32 v12, v12, v19
  v_accvgpr_write_b32 a210, v12
  v_accvgpr_read_b32 v12, a211
  v_mul_f32 v12, v12, v19
  v_accvgpr_write_b32 a211, v12
  v_accvgpr_read_b32 v12, a212
  v_mul_f32 v12, v12, v19
  v_accvgpr_write_b32 a212, v12
  v_accvgpr_read_b32 v12, a213
  v_mul_f32 v12, v12, v19
  v_accvgpr_write_b32 a213, v12
  v_accvgpr_read_b32 v12, a214
  v_mul_f32 v12, v12, v19
  v_accvgpr_write_b32 a214, v12
  v_accvgpr_read_b32 v12, a215
  v_mul_f32 v12, v12, v19
  v_accvgpr_write_b32 a215, v12
  v_accvgpr_read_b32 v12, a216
  v_mul_f32 v12, v12, v19
  v_accvgpr_write_b32 a216, v12
  v_accvgpr_read_b32 v12, a217
  v_mul_f32 v12, v12, v19
  v_accvgpr_write_b32 a217, v12
  v_accvgpr_read_b32 v12, a218
  v_mul_f32 v12, v12, v19
  v_accvgpr_write_b32 a218, v12
  v_accvgpr_read_b32 v12, a219
  v_mul_f32 v12, v12, v19
  v_accvgpr_write_b32 a219, v12
  v_accvgpr_read_b32 v12, a220
  v_mul_f32 v12, v12, v19
  v_accvgpr_write_b32 a220, v12
  v_accvgpr_read_b32 v12, a221
  v_mul_f32 v12, v12, v19
  v_accvgpr_write_b32 a221, v12
  v_accvgpr_read_b32 v12, a222
  v_mul_f32 v12, v12, v19
  v_accvgpr_write_b32 a222, v12
  v_accvgpr_read_b32 v12, a223
  v_mul_f32 v12, v12, v19
  v_accvgpr_write_b32 a223, v12
  v_accvgpr_read_b32 v12, a248
  v_mul_f32 v12, v12, v19
  v_accvgpr_write_b32 a248, v12
  v_accvgpr_read_b32 v12, a249
  v_mul_f32 v12, v12, v19
  v_accvgpr_write_b32 a249, v12
  v_accvgpr_read_b32 v12, a250
  v_mul_f32 v12, v12, v19
  v_accvgpr_write_b32 a250, v12
  v_accvgpr_read_b32 v12, a251
  v_mul_f32 v12, v12, v19
  v_accvgpr_write_b32 a251, v12
  s_nop 1
  s_branch attn_kernel_back6
attn_kernel_slowL0:
  v_mov_b32 v12, v11
  s_nop 1
  v_permlane32_swap_b32 v12, v11
  v_max_f32 v11, v12, v11
  v_mov_b32 v12, v11
  s_nop 1
  v_permlane16_swap_b32 v12, v11
  v_max_f32 v11, v12, v11
  v_max_f32 v11, 0, v11
  v_exp_f32 v19, -v11
  v_sub_f32 v164, v164, v11
  v_sub_f32 v165, v165, v11
  v_sub_f32 v166, v166, v11
  v_sub_f32 v167, v167, v11
  v_sub_f32 v172, v172, v11
  v_sub_f32 v173, v173, v11
  v_sub_f32 v174, v174, v11
  v_sub_f32 v175, v175, v11
  v_exp_f32 v28, v164
  v_exp_f32 v29, v165
  v_exp_f32 v30, v166
  v_exp_f32 v31, v167
  v_exp_f32 v14, v172
  v_exp_f32 v15, v173
  v_exp_f32 v16, v174
  v_exp_f32 v17, v175
  v_sub_f32 v212, v212, v11
  v_sub_f32 v213, v213, v11
  v_sub_f32 v214, v214, v11
  v_sub_f32 v215, v215, v11
  v_accvgpr_read_b32 v12, a0
  v_mul_f32 v12, v12, v19
  v_accvgpr_write_b32 a0, v12
  v_accvgpr_read_b32 v12, a1
  v_mul_f32 v12, v12, v19
  v_accvgpr_write_b32 a1, v12
  v_accvgpr_read_b32 v12, a2
  v_mul_f32 v12, v12, v19
  v_accvgpr_write_b32 a2, v12
  v_accvgpr_read_b32 v12, a3
  v_mul_f32 v12, v12, v19
  v_accvgpr_write_b32 a3, v12
  v_accvgpr_read_b32 v12, a4
  v_mul_f32 v12, v12, v19
  v_accvgpr_write_b32 a4, v12
  v_accvgpr_read_b32 v12, a5
  v_mul_f32 v12, v12, v19
  v_accvgpr_write_b32 a5, v12
  v_accvgpr_read_b32 v12, a6
  v_mul_f32 v12, v12, v19
  v_accvgpr_write_b32 a6, v12
  v_accvgpr_read_b32 v12, a7
  v_mul_f32 v12, v12, v19
  v_accvgpr_write_b32 a7, v12
  v_accvgpr_read_b32 v12, a8
  v_mul_f32 v12, v12, v19
  v_accvgpr_write_b32 a8, v12
  v_accvgpr_read_b32 v12, a9
  v_mul_f32 v12, v12, v19
  v_accvgpr_write_b32 a9, v12
  v_accvgpr_read_b32 v12, a10
  v_mul_f32 v12, v12, v19
  v_accvgpr_write_b32 a10, v12
  v_accvgpr_read_b32 v12, a11
  v_mul_f32 v12, v12, v19
  v_accvgpr_write_b32 a11, v12
  v_accvgpr_read_b32 v12, a12
  v_mul_f32 v12, v12, v19
  v_accvgpr_write_b32 a12, v12
  v_accvgpr_read_b32 v12, a13
  v_mul_f32 v12, v12, v19
  v_accvgpr_write_b32 a13, v12
  v_accvgpr_read_b32 v12, a14
  v_mul_f32 v12, v12, v19
  v_accvgpr_write_b32 a14, v12
  v_accvgpr_read_b32 v12, a15
  v_mul_f32 v12, v12, v19
  v_accvgpr_write_b32 a15, v12
  v_accvgpr_read_b32 v12, a16
  v_mul_f32 v12, v12, v19
  v_accvgpr_write_b32 a16, v12
  v_accvgpr_read_b32 v12, a17
  v_mul_f32 v12, v12, v19
  v_accvgpr_write_b32 a17, v12
  v_accvgpr_read_b32 v12, a18
  v_mul_f32 v12, v12, v19
  v_accvgpr_write_b32 a18, v12
  v_accvgpr_read_b32 v12, a19
  v_mul_f32 v12, v12, v19
  v_accvgpr_write_b32 a19, v12
  v_accvgpr_read_b32 v12, a20
  v_mul_f32 v12, v12, v19
  v_accvgpr_write_b32 a20, v12
  v_accvgpr_read_b32 v12, a21
  v_mul_f32 v12, v12, v19
  v_accvgpr_write_b32 a21, v12
  v_accvgpr_read_b32 v12, a22
  v_mul_f32 v12, v12, v19
  v_accvgpr_write_b32 a22, v12
  v_accvgpr_read_b32 v12, a23
  v_mul_f32 v12, v12, v19
  v_accvgpr_write_b32 a23, v12
  v_accvgpr_read_b32 v12, a24
  v_mul_f32 v12, v12, v19
  v_accvgpr_write_b32 a24, v12
  v_accvgpr_read_b32 v12, a25
  v_mul_f32 v12, v12, v19
  v_accvgpr_write_b32 a25, v12
  v_accvgpr_read_b32 v12, a26
  v_mul_f32 v12, v12, v19
  v_accvgpr_write_b32 a26, v12
  v_accvgpr_read_b32 v12, a27
  v_mul_f32 v12, v12, v19
  v_accvgpr_write_b32 a27, v12
  v_accvgpr_read_b32 v12, a28
  v_mul_f32 v12, v12, v19
  v_accvgpr_write_b32 a28, v12
  v_accvgpr_read_b32 v12, a29
  v_mul_f32 v12, v12, v19
  v_accvgpr_write_b32 a29, v12
  v_accvgpr_read_b32 v12, a30
  v_mul_f32 v12, v12, v19
  v_accvgpr_write_b32 a30, v12
  v_accvgpr_read_b32 v12, a31
  v_mul_f32 v12, v12, v19
  v_accvgpr_write_b32 a31, v12
  v_accvgpr_read_b32 v12, a224
  v_mul_f32 v12, v12, v19
  v_accvgpr_write_b32 a224, v12
  v_accvgpr_read_b32 v12, a225
  v_mul_f32 v12, v12, v19
  v_accvgpr_write_b32 a225, v12
  v_accvgpr_read_b32 v12, a226
  v_mul_f32 v12, v12, v19
  v_accvgpr_write_b32 a226, v12
  v_accvgpr_read_b32 v12, a227
  v_mul_f32 v12, v12, v19
  v_accvgpr_write_b32 a227, v12
  s_nop 1
  s_branch attn_kernel_backL0
attn_kernel_slowL1:
  v_mov_b32 v12, v11
  s_nop 1
  v_permlane32_swap_b32 v12, v11
  v_max_f32 v11, v12, v11
  v_mov_b32 v12, v11
  s_nop 1
  v_permlane16_swap_b32 v12, v11
  v_max_f32 v11, v12, v11
  v_max_f32 v11, 0, v11
  v_exp_f32 v19, -v11
  v_sub_f32 v180, v180, v11
  v_sub_f32 v181, v181, v11
  v_sub_f32 v182, v182, v11
  v_sub_f32 v183, v183, v11
  v_sub_f32 v188, v188, v11
  v_sub_f32 v189, v189, v11
  v_sub_f32 v190, v190, v11
  v_sub_f32 v191, v191, v11
  v_exp_f32 v28, v180
  v_exp_f32 v29, v181
  v_exp_f32 v30, v182
  v_exp_f32 v31, v183
  v_exp_f32 v14, v188
  v_exp_f32 v15, v189
  v_exp_f32 v16, v190
  v_exp_f32 v17, v191
  v_sub_f32 v220, v220, v11
  v_sub_f32 v221, v221, v11
  v_sub_f32 v222, v222, v11
  v_sub_f32 v223, v223, v11
  v_accvgpr_read_b32 v12, a32
  v_mul_f32 v12, v12, v19
  v_accvgpr_write_b32 a32, v12
  v_accvgpr_read_b32 v12, a33
  v_mul_f32 v12, v12, v19
  v_accvgpr_write_b32 a33, v12
  v_accvgpr_read_b32 v12, a34
  v_mul_f32 v12, v12, v19
  v_accvgpr_write_b32 a34, v12
  v_accvgpr_read_b32 v12, a35
  v_mul_f32 v12, v12, v19
  v_accvgpr_write_b32 a35, v12
  v_accvgpr_read_b32 v12, a36
  v_mul_f32 v12, v12, v19
  v_accvgpr_write_b32 a36, v12
  v_accvgpr_read_b32 v12, a37
  v_mul_f32 v12, v12, v19
  v_accvgpr_write_b32 a37, v12
  v_accvgpr_read_b32 v12, a38
  v_mul_f32 v12, v12, v19
  v_accvgpr_write_b32 a38, v12
  v_accvgpr_read_b32 v12, a39
  v_mul_f32 v12, v12, v19
  v_accvgpr_write_b32 a39, v12
  v_accvgpr_read_b32 v12, a40
  v_mul_f32 v12, v12, v19
  v_accvgpr_write_b32 a40, v12
  v_accvgpr_read_b32 v12, a41
  v_mul_f32 v12, v12, v19
  v_accvgpr_write_b32 a41, v12
  v_accvgpr_read_b32 v12, a42
  v_mul_f32 v12, v12, v19
  v_accvgpr_write_b32 a42, v12
  v_accvgpr_read_b32 v12, a43
  v_mul_f32 v12, v12, v19
  v_accvgpr_write_b32 a43, v12
  v_accvgpr_read_b32 v12, a44
  v_mul_f32 v12, v12, v19
  v_accvgpr_write_b32 a44, v12
  v_accvgpr_read_b32 v12, a45
  v_mul_f32 v12, v12, v19
  v_accvgpr_write_b32 a45, v12
  v_accvgpr_read_b32 v12, a46
  v_mul_f32 v12, v12, v19
  v_accvgpr_write_b32 a46, v12
  v_accvgpr_read_b32 v12, a47
  v_mul_f32 v12, v12, v19
  v_accvgpr_write_b32 a47, v12
  v_accvgpr_read_b32 v12, a48
  v_mul_f32 v12, v12, v19
  v_accvgpr_write_b32 a48, v12
  v_accvgpr_read_b32 v12, a49
  v_mul_f32 v12, v12, v19
  v_accvgpr_write_b32 a49, v12
  v_accvgpr_read_b32 v12, a50
  v_mul_f32 v12, v12, v19
  v_accvgpr_write_b32 a50, v12
  v_accvgpr_read_b32 v12, a51
  v_mul_f32 v12, v12, v19
  v_accvgpr_write_b32 a51, v12
  v_accvgpr_read_b32 v12, a52
  v_mul_f32 v12, v12, v19
  v_accvgpr_write_b32 a52, v12
  v_accvgpr_read_b32 v12, a53
  v_mul_f32 v12, v12, v19
  v_accvgpr_write_b32 a53, v12
  v_accvgpr_read_b32 v12, a54
  v_mul_f32 v12, v12, v19
  v_accvgpr_write_b32 a54, v12
  v_accvgpr_read_b32 v12, a55
  v_mul_f32 v12, v12, v19
  v_accvgpr_write_b32 a55, v12
  v_accvgpr_read_b32 v12, a56
  v_mul_f32 v12, v12, v19
  v_accvgpr_write_b32 a56, v12
  v_accvgpr_read_b32 v12, a57
  v_mul_f32 v12, v12, v19
  v_accvgpr_write_b32 a57, v12
  v_accvgpr_read_b32 v12, a58
  v_mul_f32 v12, v12, v19
  v_accvgpr_write_b32 a58, v12
  v_accvgpr_read_b32 v12, a59
  v_mul_f32 v12, v12, v19
  v_accvgpr_write_b32 a59, v12
  v_accvgpr_read_b32 v12, a60
  v_mul_f32 v12, v12, v19
  v_accvgpr_write_b32 a60, v12
  v_accvgpr_read_b32 v12, a61
  v_mul_f32 v12, v12, v19
  v_accvgpr_write_b32 a61, v12
  v_accvgpr_read_b32 v12, a62
  v_mul_f32 v12, v12, v19
  v_accvgpr_write_b32 a62, v12
  v_accvgpr_read_b32 v12, a63
  v_mul_f32 v12, v12, v19
  v_accvgpr_write_b32 a63, v12
  v_accvgpr_read_b32 v12, a228
  v_mul_f32 v12, v12, v19
  v_accvgpr_write_b32 a228, v12
  v_accvgpr_read_b32 v12, a229
  v_mul_f32 v12, v12, v19
  v_accvgpr_write_b32 a229, v12
  v_accvgpr_read_b32 v12, a230
  v_mul_f32 v12, v12, v19
  v_accvgpr_write_b32 a230, v12
  v_accvgpr_read_b32 v12, a231
  v_mul_f32 v12, v12, v19
  v_accvgpr_write_b32 a231, v12
  s_nop 1
  s_branch attn_kernel_backL1
attn_kernel_slowL2:
  v_mov_b32 v12, v11
  s_nop 1
  v_permlane32_swap_b32 v12, v11
  v_max_f32 v11, v12, v11
  v_mov_b32 v12, v11
  s_nop 1
  v_permlane16_swap_b32 v12, v11
  v_max_f32 v11, v12, v11
  v_max_f32 v11, 0, v11
  v_exp_f32 v19, -v11
  v_sub_f32 v164, v164, v11
  v_sub_f32 v165, v165, v11
  v_sub_f32 v166, v166, v11
  v_sub_f32 v167, v167, v11
  v_sub_f32 v172, v172, v11
  v_sub_f32 v173, v173, v11
  v_sub_f32 v174, v174, v11
  v_sub_f32 v175, v175, v11
  v_exp_f32 v28, v164
  v_exp_f32 v29, v165
  v_exp_f32 v30, v166
  v_exp_f32 v31, v167
  v_exp_f32 v14, v172
  v_exp_f32 v15, v173
  v_exp_f32 v16, v174
  v_exp_f32 v17, v175
  v_sub_f32 v228, v228, v11
  v_sub_f32 v229, v229, v11
  v_sub_f32 v230, v230, v11
  v_sub_f32 v231, v231, v11
  v_accvgpr_read_b32 v12, a64
  v_mul_f32 v12, v12, v19
  v_accvgpr_write_b32 a64, v12
  v_accvgpr_read_b32 v12, a65
  v_mul_f32 v12, v12, v19
  v_accvgpr_write_b32 a65, v12
  v_accvgpr_read_b32 v12, a66
  v_mul_f32 v12, v12, v19
  v_accvgpr_write_b32 a66, v12
  v_accvgpr_read_b32 v12, a67
  v_mul_f32 v12, v12, v19
  v_accvgpr_write_b32 a67, v12
  v_accvgpr_read_b32 v12, a68
  v_mul_f32 v12, v12, v19
  v_accvgpr_write_b32 a68, v12
  v_accvgpr_read_b32 v12, a69
  v_mul_f32 v12, v12, v19
  v_accvgpr_write_b32 a69, v12
  v_accvgpr_read_b32 v12, a70
  v_mul_f32 v12, v12, v19
  v_accvgpr_write_b32 a70, v12
  v_accvgpr_read_b32 v12, a71
  v_mul_f32 v12, v12, v19
  v_accvgpr_write_b32 a71, v12
  v_accvgpr_read_b32 v12, a72
  v_mul_f32 v12, v12, v19
  v_accvgpr_write_b32 a72, v12
  v_accvgpr_read_b32 v12, a73
  v_mul_f32 v12, v12, v19
  v_accvgpr_write_b32 a73, v12
  v_accvgpr_read_b32 v12, a74
  v_mul_f32 v12, v12, v19
  v_accvgpr_write_b32 a74, v12
  v_accvgpr_read_b32 v12, a75
  v_mul_f32 v12, v12, v19
  v_accvgpr_write_b32 a75, v12
  v_accvgpr_read_b32 v12, a76
  v_mul_f32 v12, v12, v19
  v_accvgpr_write_b32 a76, v12
  v_accvgpr_read_b32 v12, a77
  v_mul_f32 v12, v12, v19
  v_accvgpr_write_b32 a77, v12
  v_accvgpr_read_b32 v12, a78
  v_mul_f32 v12, v12, v19
  v_accvgpr_write_b32 a78, v12
  v_accvgpr_read_b32 v12, a79
  v_mul_f32 v12, v12, v19
  v_accvgpr_write_b32 a79, v12
  v_accvgpr_read_b32 v12, a80
  v_mul_f32 v12, v12, v19
  v_accvgpr_write_b32 a80, v12
  v_accvgpr_read_b32 v12, a81
  v_mul_f32 v12, v12, v19
  v_accvgpr_write_b32 a81, v12
  v_accvgpr_read_b32 v12, a82
  v_mul_f32 v12, v12, v19
  v_accvgpr_write_b32 a82, v12
  v_accvgpr_read_b32 v12, a83
  v_mul_f32 v12, v12, v19
  v_accvgpr_write_b32 a83, v12
  v_accvgpr_read_b32 v12, a84
  v_mul_f32 v12, v12, v19
  v_accvgpr_write_b32 a84, v12
  v_accvgpr_read_b32 v12, a85
  v_mul_f32 v12, v12, v19
  v_accvgpr_write_b32 a85, v12
  v_accvgpr_read_b32 v12, a86
  v_mul_f32 v12, v12, v19
  v_accvgpr_write_b32 a86, v12
  v_accvgpr_read_b32 v12, a87
  v_mul_f32 v12, v12, v19
  v_accvgpr_write_b32 a87, v12
  v_accvgpr_read_b32 v12, a88
  v_mul_f32 v12, v12, v19
  v_accvgpr_write_b32 a88, v12
  v_accvgpr_read_b32 v12, a89
  v_mul_f32 v12, v12, v19
  v_accvgpr_write_b32 a89, v12
  v_accvgpr_read_b32 v12, a90
  v_mul_f32 v12, v12, v19
  v_accvgpr_write_b32 a90, v12
  v_accvgpr_read_b32 v12, a91
  v_mul_f32 v12, v12, v19
  v_accvgpr_write_b32 a91, v12
  v_accvgpr_read_b32 v12, a92
  v_mul_f32 v12, v12, v19
  v_accvgpr_write_b32 a92, v12
  v_accvgpr_read_b32 v12, a93
  v_mul_f32 v12, v12, v19
  v_accvgpr_write_b32 a93, v12
  v_accvgpr_read_b32 v12, a94
  v_mul_f32 v12, v12, v19
  v_accvgpr_write_b32 a94, v12
  v_accvgpr_read_b32 v12, a95
  v_mul_f32 v12, v12, v19
  v_accvgpr_write_b32 a95, v12
  v_accvgpr_read_b32 v12, a232
  v_mul_f32 v12, v12, v19
  v_accvgpr_write_b32 a232, v12
  v_accvgpr_read_b32 v12, a233
  v_mul_f32 v12, v12, v19
  v_accvgpr_write_b32 a233, v12
  v_accvgpr_read_b32 v12, a234
  v_mul_f32 v12, v12, v19
  v_accvgpr_write_b32 a234, v12
  v_accvgpr_read_b32 v12, a235
  v_mul_f32 v12, v12, v19
  v_accvgpr_write_b32 a235, v12
  s_nop 1
  s_branch attn_kernel_backL2
attn_kernel_slowL3:
  v_mov_b32 v12, v11
  s_nop 1
  v_permlane32_swap_b32 v12, v11
  v_max_f32 v11, v12, v11
  v_mov_b32 v12, v11
  s_nop 1
  v_permlane16_swap_b32 v12, v11
  v_max_f32 v11, v12, v11
  v_max_f32 v11, 0, v11
  v_exp_f32 v19, -v11
  v_sub_f32 v180, v180, v11
  v_sub_f32 v181, v181, v11
  v_sub_f32 v182, v182, v11
  v_sub_f32 v183, v183, v11
  v_sub_f32 v188, v188, v11
  v_sub_f32 v189, v189, v11
  v_sub_f32 v190, v190, v11
  v_sub_f32 v191, v191, v11
  v_exp_f32 v28, v180
  v_exp_f32 v29, v181
  v_exp_f32 v30, v182
  v_exp_f32 v31, v183
  v_exp_f32 v14, v188
  v_exp_f32 v15, v189
  v_exp_f32 v16, v190
  v_exp_f32 v17, v191
  v_sub_f32 v236, v236, v11
  v_sub_f32 v237, v237, v11
  v_sub_f32 v238, v238, v11
  v_sub_f32 v239, v239, v11
  v_accvgpr_read_b32 v12, a96
  v_mul_f32 v12, v12, v19
  v_accvgpr_write_b32 a96, v12
  v_accvgpr_read_b32 v12, a97
  v_mul_f32 v12, v12, v19
  v_accvgpr_write_b32 a97, v12
  v_accvgpr_read_b32 v12, a98
  v_mul_f32 v12, v12, v19
  v_accvgpr_write_b32 a98, v12
  v_accvgpr_read_b32 v12, a99
  v_mul_f32 v12, v12, v19
  v_accvgpr_write_b32 a99, v12
  v_accvgpr_read_b32 v12, a100
  v_mul_f32 v12, v12, v19
  v_accvgpr_write_b32 a100, v12
  v_accvgpr_read_b32 v12, a101
  v_mul_f32 v12, v12, v19
  v_accvgpr_write_b32 a101, v12
  v_accvgpr_read_b32 v12, a102
  v_mul_f32 v12, v12, v19
  v_accvgpr_write_b32 a102, v12
  v_accvgpr_read_b32 v12, a103
  v_mul_f32 v12, v12, v19
  v_accvgpr_write_b32 a103, v12
  v_accvgpr_read_b32 v12, a104
  v_mul_f32 v12, v12, v19
  v_accvgpr_write_b32 a104, v12
  v_accvgpr_read_b32 v12, a105
  v_mul_f32 v12, v12, v19
  v_accvgpr_write_b32 a105, v12
  v_accvgpr_read_b32 v12, a106
  v_mul_f32 v12, v12, v19
  v_accvgpr_write_b32 a106, v12
  v_accvgpr_read_b32 v12, a107
  v_mul_f32 v12, v12, v19
  v_accvgpr_write_b32 a107, v12
  v_accvgpr_read_b32 v12, a108
  v_mul_f32 v12, v12, v19
  v_accvgpr_write_b32 a108, v12
  v_accvgpr_read_b32 v12, a109
  v_mul_f32 v12, v12, v19
  v_accvgpr_write_b32 a109, v12
  v_accvgpr_read_b32 v12, a110
  v_mul_f32 v12, v12, v19
  v_accvgpr_write_b32 a110, v12
  v_accvgpr_read_b32 v12, a111
  v_mul_f32 v12, v12, v19
  v_accvgpr_write_b32 a111, v12
  v_accvgpr_read_b32 v12, a112
  v_mul_f32 v12, v12, v19
  v_accvgpr_write_b32 a112, v12
  v_accvgpr_read_b32 v12, a113
  v_mul_f32 v12, v12, v19
  v_accvgpr_write_b32 a113, v12
  v_accvgpr_read_b32 v12, a114
  v_mul_f32 v12, v12, v19
  v_accvgpr_write_b32 a114, v12
  v_accvgpr_read_b32 v12, a115
  v_mul_f32 v12, v12, v19
  v_accvgpr_write_b32 a115, v12
  v_accvgpr_read_b32 v12, a116
  v_mul_f32 v12, v12, v19
  v_accvgpr_write_b32 a116, v12
  v_accvgpr_read_b32 v12, a117
  v_mul_f32 v12, v12, v19
  v_accvgpr_write_b32 a117, v12
  v_accvgpr_read_b32 v12, a118
  v_mul_f32 v12, v12, v19
  v_accvgpr_write_b32 a118, v12
  v_accvgpr_read_b32 v12, a119
  v_mul_f32 v12, v12, v19
  v_accvgpr_write_b32 a119, v12
  v_accvgpr_read_b32 v12, a120
  v_mul_f32 v12, v12, v19
  v_accvgpr_write_b32 a120, v12
  v_accvgpr_read_b32 v12, a121
  v_mul_f32 v12, v12, v19
  v_accvgpr_write_b32 a121, v12
  v_accvgpr_read_b32 v12, a122
  v_mul_f32 v12, v12, v19
  v_accvgpr_write_b32 a122, v12
  v_accvgpr_read_b32 v12, a123
  v_mul_f32 v12, v12, v19
  v_accvgpr_write_b32 a123, v12
  v_accvgpr_read_b32 v12, a124
  v_mul_f32 v12, v12, v19
  v_accvgpr_write_b32 a124, v12
  v_accvgpr_read_b32 v12, a125
  v_mul_f32 v12, v12, v19
  v_accvgpr_write_b32 a125, v12
  v_accvgpr_read_b32 v12, a126
  v_mul_f32 v12, v12, v19
  v_accvgpr_write_b32 a126, v12
  v_accvgpr_read_b32 v12, a127
  v_mul_f32 v12, v12, v19
  v_accvgpr_write_b32 a127, v12
  v_accvgpr_read_b32 v12, a236
  v_mul_f32 v12, v12, v19
  v_accvgpr_write_b32 a236, v12
  v_accvgpr_read_b32 v12, a237
  v_mul_f32 v12, v12, v19
  v_accvgpr_write_b32 a237, v12
  v_accvgpr_read_b32 v12, a238
  v_mul_f32 v12, v12, v19
  v_accvgpr_write_b32 a238, v12
  v_accvgpr_read_b32 v12, a239
  v_mul_f32 v12, v12, v19
  v_accvgpr_write_b32 a239, v12
  s_nop 1
  s_branch attn_kernel_backL3
attn_kernel_slowL4:
  v_mov_b32 v12, v11
  s_nop 1
  v_permlane32_swap_b32 v12, v11
  v_max_f32 v11, v12, v11
  v_mov_b32 v12, v11
  s_nop 1
  v_permlane16_swap_b32 v12, v11
  v_max_f32 v11, v12, v11
  v_max_f32 v11, 0, v11
  v_exp_f32 v19, -v11
  v_sub_f32 v164, v164, v11
  v_sub_f32 v165, v165, v11
  v_sub_f32 v166, v166, v11
  v_sub_f32 v167, v167, v11
  v_sub_f32 v172, v172, v11
  v_sub_f32 v173, v173, v11
  v_sub_f32 v174, v174, v11
  v_sub_f32 v175, v175, v11
  v_exp_f32 v28, v164
  v_exp_f32 v29, v165
  v_exp_f32 v30, v166
  v_exp_f32 v31, v167
  v_exp_f32 v14, v172
  v_exp_f32 v15, v173
  v_exp_f32 v16, v174
  v_exp_f32 v17, v175
  v_sub_f32 v244, v244, v11
  v_sub_f32 v245, v245, v11
  v_sub_f32 v246, v246, v11
  v_sub_f32 v247, v247, v11
  v_accvgpr_read_b32 v12, a128
  v_mul_f32 v12, v12, v19
  v_accvgpr_write_b32 a128, v12
  v_accvgpr_read_b32 v12, a129
  v_mul_f32 v12, v12, v19
  v_accvgpr_write_b32 a129, v12
  v_accvgpr_read_b32 v12, a130
  v_mul_f32 v12, v12, v19
  v_accvgpr_write_b32 a130, v12
  v_accvgpr_read_b32 v12, a131
  v_mul_f32 v12, v12, v19
  v_accvgpr_write_b32 a131, v12
  v_accvgpr_read_b32 v12, a132
  v_mul_f32 v12, v12, v19
  v_accvgpr_write_b32 a132, v12
  v_accvgpr_read_b32 v12, a133
  v_mul_f32 v12, v12, v19
  v_accvgpr_write_b32 a133, v12
  v_accvgpr_read_b32 v12, a134
  v_mul_f32 v12, v12, v19
  v_accvgpr_write_b32 a134, v12
  v_accvgpr_read_b32 v12, a135
  v_mul_f32 v12, v12, v19
  v_accvgpr_write_b32 a135, v12
  v_accvgpr_read_b32 v12, a136
  v_mul_f32 v12, v12, v19
  v_accvgpr_write_b32 a136, v12
  v_accvgpr_read_b32 v12, a137
  v_mul_f32 v12, v12, v19
  v_accvgpr_write_b32 a137, v12
  v_accvgpr_read_b32 v12, a138
  v_mul_f32 v12, v12, v19
  v_accvgpr_write_b32 a138, v12
  v_accvgpr_read_b32 v12, a139
  v_mul_f32 v12, v12, v19
  v_accvgpr_write_b32 a139, v12
  v_accvgpr_read_b32 v12, a140
  v_mul_f32 v12, v12, v19
  v_accvgpr_write_b32 a140, v12
  v_accvgpr_read_b32 v12, a141
  v_mul_f32 v12, v12, v19
  v_accvgpr_write_b32 a141, v12
  v_accvgpr_read_b32 v12, a142
  v_mul_f32 v12, v12, v19
  v_accvgpr_write_b32 a142, v12
  v_accvgpr_read_b32 v12, a143
  v_mul_f32 v12, v12, v19
  v_accvgpr_write_b32 a143, v12
  v_accvgpr_read_b32 v12, a144
  v_mul_f32 v12, v12, v19
  v_accvgpr_write_b32 a144, v12
  v_accvgpr_read_b32 v12, a145
  v_mul_f32 v12, v12, v19
  v_accvgpr_write_b32 a145, v12
  v_accvgpr_read_b32 v12, a146
  v_mul_f32 v12, v12, v19
  v_accvgpr_write_b32 a146, v12
  v_accvgpr_read_b32 v12, a147
  v_mul_f32 v12, v12, v19
  v_accvgpr_write_b32 a147, v12
  v_accvgpr_read_b32 v12, a148
  v_mul_f32 v12, v12, v19
  v_accvgpr_write_b32 a148, v12
  v_accvgpr_read_b32 v12, a149
  v_mul_f32 v12, v12, v19
  v_accvgpr_write_b32 a149, v12
  v_accvgpr_read_b32 v12, a150
  v_mul_f32 v12, v12, v19
  v_accvgpr_write_b32 a150, v12
  v_accvgpr_read_b32 v12, a151
  v_mul_f32 v12, v12, v19
  v_accvgpr_write_b32 a151, v12
  v_accvgpr_read_b32 v12, a152
  v_mul_f32 v12, v12, v19
  v_accvgpr_write_b32 a152, v12
  v_accvgpr_read_b32 v12, a153
  v_mul_f32 v12, v12, v19
  v_accvgpr_write_b32 a153, v12
  v_accvgpr_read_b32 v12, a154
  v_mul_f32 v12, v12, v19
  v_accvgpr_write_b32 a154, v12
  v_accvgpr_read_b32 v12, a155
  v_mul_f32 v12, v12, v19
  v_accvgpr_write_b32 a155, v12
  v_accvgpr_read_b32 v12, a156
  v_mul_f32 v12, v12, v19
  v_accvgpr_write_b32 a156, v12
  v_accvgpr_read_b32 v12, a157
  v_mul_f32 v12, v12, v19
  v_accvgpr_write_b32 a157, v12
  v_accvgpr_read_b32 v12, a158
  v_mul_f32 v12, v12, v19
  v_accvgpr_write_b32 a158, v12
  v_accvgpr_read_b32 v12, a159
  v_mul_f32 v12, v12, v19
  v_accvgpr_write_b32 a159, v12
  v_accvgpr_read_b32 v12, a240
  v_mul_f32 v12, v12, v19
  v_accvgpr_write_b32 a240, v12
  v_accvgpr_read_b32 v12, a241
  v_mul_f32 v12, v12, v19
  v_accvgpr_write_b32 a241, v12
  v_accvgpr_read_b32 v12, a242
  v_mul_f32 v12, v12, v19
  v_accvgpr_write_b32 a242, v12
  v_accvgpr_read_b32 v12, a243
  v_mul_f32 v12, v12, v19
  v_accvgpr_write_b32 a243, v12
  s_nop 1
  s_branch attn_kernel_backL4
attn_kernel_slowL5:
  v_mov_b32 v12, v11
  s_nop 1
  v_permlane32_swap_b32 v12, v11
  v_max_f32 v11, v12, v11
  v_mov_b32 v12, v11
  s_nop 1
  v_permlane16_swap_b32 v12, v11
  v_max_f32 v11, v12, v11
  v_max_f32 v11, 0, v11
  v_exp_f32 v19, -v11
  v_sub_f32 v180, v180, v11
  v_sub_f32 v181, v181, v11
  v_sub_f32 v182, v182, v11
  v_sub_f32 v183, v183, v11
  v_sub_f32 v188, v188, v11
  v_sub_f32 v189, v189, v11
  v_sub_f32 v190, v190, v11
  v_sub_f32 v191, v191, v11
  v_exp_f32 v28, v180
  v_exp_f32 v29, v181
  v_exp_f32 v30, v182
  v_exp_f32 v31, v183
  v_exp_f32 v14, v188
  v_exp_f32 v15, v189
  v_exp_f32 v16, v190
  v_exp_f32 v17, v191
  v_sub_f32 v252, v252, v11
  v_sub_f32 v253, v253, v11
  v_sub_f32 v254, v254, v11
  v_sub_f32 v255, v255, v11
  v_accvgpr_read_b32 v12, a160
  v_mul_f32 v12, v12, v19
  v_accvgpr_write_b32 a160, v12
  v_accvgpr_read_b32 v12, a161
  v_mul_f32 v12, v12, v19
  v_accvgpr_write_b32 a161, v12
  v_accvgpr_read_b32 v12, a162
  v_mul_f32 v12, v12, v19
  v_accvgpr_write_b32 a162, v12
  v_accvgpr_read_b32 v12, a163
  v_mul_f32 v12, v12, v19
  v_accvgpr_write_b32 a163, v12
  v_accvgpr_read_b32 v12, a164
  v_mul_f32 v12, v12, v19
  v_accvgpr_write_b32 a164, v12
  v_accvgpr_read_b32 v12, a165
  v_mul_f32 v12, v12, v19
  v_accvgpr_write_b32 a165, v12
  v_accvgpr_read_b32 v12, a166
  v_mul_f32 v12, v12, v19
  v_accvgpr_write_b32 a166, v12
  v_accvgpr_read_b32 v12, a167
  v_mul_f32 v12, v12, v19
  v_accvgpr_write_b32 a167, v12
  v_accvgpr_read_b32 v12, a168
  v_mul_f32 v12, v12, v19
  v_accvgpr_write_b32 a168, v12
  v_accvgpr_read_b32 v12, a169
  v_mul_f32 v12, v12, v19
  v_accvgpr_write_b32 a169, v12
  v_accvgpr_read_b32 v12, a170
  v_mul_f32 v12, v12, v19
  v_accvgpr_write_b32 a170, v12
  v_accvgpr_read_b32 v12, a171
  v_mul_f32 v12, v12, v19
  v_accvgpr_write_b32 a171, v12
  v_accvgpr_read_b32 v12, a172
  v_mul_f32 v12, v12, v19
  v_accvgpr_write_b32 a172, v12
  v_accvgpr_read_b32 v12, a173
  v_mul_f32 v12, v12, v19
  v_accvgpr_write_b32 a173, v12
  v_accvgpr_read_b32 v12, a174
  v_mul_f32 v12, v12, v19
  v_accvgpr_write_b32 a174, v12
  v_accvgpr_read_b32 v12, a175
  v_mul_f32 v12, v12, v19
  v_accvgpr_write_b32 a175, v12
  v_accvgpr_read_b32 v12, a176
  v_mul_f32 v12, v12, v19
  v_accvgpr_write_b32 a176, v12
  v_accvgpr_read_b32 v12, a177
  v_mul_f32 v12, v12, v19
  v_accvgpr_write_b32 a177, v12
  v_accvgpr_read_b32 v12, a178
  v_mul_f32 v12, v12, v19
  v_accvgpr_write_b32 a178, v12
  v_accvgpr_read_b32 v12, a179
  v_mul_f32 v12, v12, v19
  v_accvgpr_write_b32 a179, v12
  v_accvgpr_read_b32 v12, a180
  v_mul_f32 v12, v12, v19
  v_accvgpr_write_b32 a180, v12
  v_accvgpr_read_b32 v12, a181
  v_mul_f32 v12, v12, v19
  v_accvgpr_write_b32 a181, v12
  v_accvgpr_read_b32 v12, a182
  v_mul_f32 v12, v12, v19
  v_accvgpr_write_b32 a182, v12
  v_accvgpr_read_b32 v12, a183
  v_mul_f32 v12, v12, v19
  v_accvgpr_write_b32 a183, v12
  v_accvgpr_read_b32 v12, a184
  v_mul_f32 v12, v12, v19
  v_accvgpr_write_b32 a184, v12
  v_accvgpr_read_b32 v12, a185
  v_mul_f32 v12, v12, v19
  v_accvgpr_write_b32 a185, v12
  v_accvgpr_read_b32 v12, a186
  v_mul_f32 v12, v12, v19
  v_accvgpr_write_b32 a186, v12
  v_accvgpr_read_b32 v12, a187
  v_mul_f32 v12, v12, v19
  v_accvgpr_write_b32 a187, v12
  v_accvgpr_read_b32 v12, a188
  v_mul_f32 v12, v12, v19
  v_accvgpr_write_b32 a188, v12
  v_accvgpr_read_b32 v12, a189
  v_mul_f32 v12, v12, v19
  v_accvgpr_write_b32 a189, v12
  v_accvgpr_read_b32 v12, a190
  v_mul_f32 v12, v12, v19
  v_accvgpr_write_b32 a190, v12
  v_accvgpr_read_b32 v12, a191
  v_mul_f32 v12, v12, v19
  v_accvgpr_write_b32 a191, v12
  v_accvgpr_read_b32 v12, a244
  v_mul_f32 v12, v12, v19
  v_accvgpr_write_b32 a244, v12
  v_accvgpr_read_b32 v12, a245
  v_mul_f32 v12, v12, v19
  v_accvgpr_write_b32 a245, v12
  v_accvgpr_read_b32 v12, a246
  v_mul_f32 v12, v12, v19
  v_accvgpr_write_b32 a246, v12
  v_accvgpr_read_b32 v12, a247
  v_mul_f32 v12, v12, v19
  v_accvgpr_write_b32 a247, v12
  s_nop 1
  s_branch attn_kernel_backL5
attn_kernel_slowL6:
  v_mov_b32 v12, v11
  s_nop 1
  v_permlane32_swap_b32 v12, v11
  v_max_f32 v11, v12, v11
  v_mov_b32 v12, v11
  s_nop 1
  v_permlane16_swap_b32 v12, v11
  v_max_f32 v11, v12, v11
  v_max_f32 v11, 0, v11
  v_exp_f32 v19, -v11
  v_sub_f32 v196, v196, v11
  v_sub_f32 v197, v197, v11
  v_sub_f32 v198, v198, v11
  v_sub_f32 v199, v199, v11
  v_sub_f32 v204, v204, v11
  v_sub_f32 v205, v205, v11
  v_sub_f32 v206, v206, v11
  v_sub_f32 v207, v207, v11
  v_exp_f32 v28, v196
  v_exp_f32 v29, v197
  v_exp_f32 v30, v198
  v_exp_f32 v31, v199
  v_exp_f32 v14, v204
  v_exp_f32 v15, v205
  v_exp_f32 v16, v206
  v_exp_f32 v17, v207
  v_sub_f32 v20, v20, v11
  v_sub_f32 v21, v21, v11
  v_sub_f32 v22, v22, v11
  v_sub_f32 v23, v23, v11
  v_accvgpr_read_b32 v12, a192
  v_mul_f32 v12, v12, v19
  v_accvgpr_write_b32 a192, v12
  v_accvgpr_read_b32 v12, a193
  v_mul_f32 v12, v12, v19
  v_accvgpr_write_b32 a193, v12
  v_accvgpr_read_b32 v12, a194
  v_mul_f32 v12, v12, v19
  v_accvgpr_write_b32 a194, v12
  v_accvgpr_read_b32 v12, a195
  v_mul_f32 v12, v12, v19
  v_accvgpr_write_b32 a195, v12
  v_accvgpr_read_b32 v12, a196
  v_mul_f32 v12, v12, v19
  v_accvgpr_write_b32 a196, v12
  v_accvgpr_read_b32 v12, a197
  v_mul_f32 v12, v12, v19
  v_accvgpr_write_b32 a197, v12
  v_accvgpr_read_b32 v12, a198
  v_mul_f32 v12, v12, v19
  v_accvgpr_write_b32 a198, v12
  v_accvgpr_read_b32 v12, a199
  v_mul_f32 v12, v12, v19
  v_accvgpr_write_b32 a199, v12
  v_accvgpr_read_b32 v12, a200
  v_mul_f32 v12, v12, v19
  v_accvgpr_write_b32 a200, v12
  v_accvgpr_read_b32 v12, a201
  v_mul_f32 v12, v12, v19
  v_accvgpr_write_b32 a201, v12
  v_accvgpr_read_b32 v12, a202
  v_mul_f32 v12, v12, v19
  v_accvgpr_write_b32 a202, v12
  v_accvgpr_read_b32 v12, a203
  v_mul_f32 v12, v12, v19
  v_accvgpr_write_b32 a203, v12
  v_accvgpr_read_b32 v12, a204
  v_mul_f32 v12, v12, v19
  v_accvgpr_write_b32 a204, v12
  v_accvgpr_read_b32 v12, a205
  v_mul_f32 v12, v12, v19
  v_accvgpr_write_b32 a205, v12
  v_accvgpr_read_b32 v12, a206
  v_mul_f32 v12, v12, v19
  v_accvgpr_write_b32 a206, v12
  v_accvgpr_read_b32 v12, a207
  v_mul_f32 v12, v12, v19
  v_accvgpr_write_b32 a207, v12
  v_accvgpr_read_b32 v12, a208
  v_mul_f32 v12, v12, v19
  v_accvgpr_write_b32 a208, v12
  v_accvgpr_read_b32 v12, a209
  v_mul_f32 v12, v12, v19
  v_accvgpr_write_b32 a209, v12
  v_accvgpr_read_b32 v12, a210
  v_mul_f32 v12, v12, v19
  v_accvgpr_write_b32 a210, v12
  v_accvgpr_read_b32 v12, a211
  v_mul_f32 v12, v12, v19
  v_accvgpr_write_b32 a211, v12
  v_accvgpr_read_b32 v12, a212
  v_mul_f32 v12, v12, v19
  v_accvgpr_write_b32 a212, v12
  v_accvgpr_read_b32 v12, a213
  v_mul_f32 v12, v12, v19
  v_accvgpr_write_b32 a213, v12
  v_accvgpr_read_b32 v12, a214
  v_mul_f32 v12, v12, v19
  v_accvgpr_write_b32 a214, v12
  v_accvgpr_read_b32 v12, a215
  v_mul_f32 v12, v12, v19
  v_accvgpr_write_b32 a215, v12
  v_accvgpr_read_b32 v12, a216
  v_mul_f32 v12, v12, v19
  v_accvgpr_write_b32 a216, v12
  v_accvgpr_read_b32 v12, a217
  v_mul_f32 v12, v12, v19
  v_accvgpr_write_b32 a217, v12
  v_accvgpr_read_b32 v12, a218
  v_mul_f32 v12, v12, v19
  v_accvgpr_write_b32 a218, v12
  v_accvgpr_read_b32 v12, a219
  v_mul_f32 v12, v12, v19
  v_accvgpr_write_b32 a219, v12
  v_accvgpr_read_b32 v12, a220
  v_mul_f32 v12, v12, v19
  v_accvgpr_write_b32 a220, v12
  v_accvgpr_read_b32 v12, a221
  v_mul_f32 v12, v12, v19
  v_accvgpr_write_b32 a221, v12
  v_accvgpr_read_b32 v12, a222
  v_mul_f32 v12, v12, v19
  v_accvgpr_write_b32 a222, v12
  v_accvgpr_read_b32 v12, a223
  v_mul_f32 v12, v12, v19
  v_accvgpr_write_b32 a223, v12
  v_accvgpr_read_b32 v12, a248
  v_mul_f32 v12, v12, v19
  v_accvgpr_write_b32 a248, v12
  v_accvgpr_read_b32 v12, a249
  v_mul_f32 v12, v12, v19
  v_accvgpr_write_b32 a249, v12
  v_accvgpr_read_b32 v12, a250
  v_mul_f32 v12, v12, v19
  v_accvgpr_write_b32 a250, v12
  v_accvgpr_read_b32 v12, a251
  v_mul_f32 v12, v12, v19
  v_accvgpr_write_b32 a251, v12
  s_nop 1
  s_branch attn_kernel_backL6
.globl oproj_kernel
.p2align 8
.type oproj_kernel,@function
oproj_kernel:
  s_cmp_ge_u32 s2, 256
  s_cbranch_scc1 oproj_kernel_done
  s_load_dwordx2 s[4:5], s[0:1], 32
  s_load_dwordx2 s[6:7], s[0:1], 72
  s_load_dwordx2 s[8:9], s[0:1], 80
  s_load_dwordx2 s[10:11], s[0:1], 96
  s_and_b32 s20, s2, 7
  s_lshr_b32 s21, s2, 3
  s_and_b32 s22, s20, 1
  s_mul_i32 s23, s22, 31
  s_cmp_eq_u32 s23, 31
  s_cselect_b32 s23, s21, 0
  s_cmp_eq_u32 s23, 31
  s_cbranch_scc1 oproj_kernel_done
  s_mul_i32 s22, s20, 63
  s_add_u32 s22, s22, 1
  s_lshr_b32 s22, s22, 1
  s_add_u32 s22, s22, s21
  s_cmp_ge_u32 s22, 126
  s_cselect_b32 s24, 1, 0
  s_mul_i32 s20, s24, 126
  s_sub_u32 s20, s22, s20
  s_mul_i32 s25, s20, 781
  s_lshr_b32 s25, s25, 15
  s_mul_i32 s21, s25, 42
  s_sub_u32 s20, s20, s21
  s_mul_i32 s26, s20, 171
  s_lshr_b32 s26, s26, 9
  s_mul_i32 s21, s26, 3
  s_sub_u32 s27, s20, s21
  s_mul_i32 s23, s24, 42
  s_add_u32 s23, s23, s20
  s_mul_i32 s22, s23, 3
  s_add_u32 s22, s22, s25
  v_and_b32 v1, 63, v0
  v_lshrrev_b32 v16, 6, v0
  v_lshlrev_b32 v2, 4, v1
  v_readfirstlane_b32 s28, v16
  s_lshl_b32 s29, s26, 3
  s_add_u32 s51, s25, 1
  s_cmp_ge_u32 s51, 3
  s_cselect_b32 s52, 3, 0
  s_sub_u32 s51, s51, s52
  s_add_u32 s52, s25, 2
  s_cmp_ge_u32 s52, 3
  s_cselect_b32 s53, 3, 0
  s_sub_u32 s52, s52, s53
  s_lshl_b32 s30, s28, 1
  s_add_u32 s29, s29, s30
  s_mul_i32 s30, s24, 112
  s_add_u32 s30, s30, s29
  s_mul_i32 s30, s30, 131072
  v_lshrrev_b32 v16, 3, v1
  v_mul_u32_u24 v16, 1152, v16
  v_bfe_u32 v17, v1, 4, 2
  v_lshlrev_b32 v17, 1, v17
  v_and_b32 v18, 7, v1
  v_xor_b32 v17, v17, v18
  v_lshl_add_u32 v11, v17, 4, v16
  v_add_u32 v12, 8192, v11
  v_add_u32 v13, 16384, v11
  v_add_u32 v14, 24576, v11
  s_mul_i32 s46, s25, 1622016
  s_mul_i32 s47, s28, 36864
  s_add_u32 s46, s46, s47
  s_mul_i32 s47, s27, 384
  s_add_u32 s46, s46, s47
  s_lshl_b32 s47, s51, 7
  s_add_u32 s60, s46, s47
  s_lshl_b32 s47, s52, 7
  s_add_u32 s61, s46, s47
  s_lshl_b32 s47, s25, 7
  s_add_u32 s62, s46, s47
  s_lshl_b32 s45, s28, 12
  s_mul_i32 s48, s25, 45056
  s_add_u32 s49, s27, s26
  s_mul_i32 s50, s49, 171
  s_lshr_b32 s50, s50, 9
  s_mul_i32 s50, s50, 3
  s_sub_u32 s49, s49, s50
  s_mov_b32 s49, 0
  s_mul_i32 s12, s49, 147456
  s_lshl_b32 s15, s49, 12
  s_add_u32 s49, s49, 1
  s_cmp_eq_u32 s49, 3
  s_cselect_b32 s49, 0, s49
  s_mul_i32 s13, s49, 147456
  s_lshl_b32 s16, s49, 12
  s_add_u32 s49, s49, 1
  s_cmp_eq_u32 s49, 3
  s_cselect_b32 s49, 0, s49
  s_mul_i32 s14, s49, 147456
  s_lshl_b32 s17, s49, 12
  s_add_u32 s15, s15, s48
  s_add_u32 s16, s16, s48
  s_add_u32 s17, s17, s48
  s_waitcnt lgkmcnt(0)
  s_cmp_eq_u32 s24, 0
  s_cselect_b32 s32, s4, s6
  s_cselect_b32 s33, s5, s7
  s_mov_b32 s34, 4718592
  s_mov_b32 s35, 0x00020000
  s_add_u32 s36, s10, s30
  s_addc_u32 s37, s11, 0
  s_mov_b32 s38, 131072
  s_mov_b32 s39, 0x00020000
  s_add_u32 s56, s36, 131072
  s_addc_u32 s57, s37, 0
  s_mov_b32 s58, 131072
  s_mov_b32 s59, 0x00020000
  s_add_u32 s44, s60, s12
  s_add_u32 m0, s45, 0
  s_add_u32 s44, s44, 0
  buffer_load_dwordx4 v11, s[32:35], s44 offen offset:0 lds
  buffer_load_dwordx4 v12, s[32:35], s44 offen offset:1024 lds
  buffer_load_dwordx4 v13, s[32:35], s44 offen offset:2048 lds
  buffer_load_dwordx4 v14, s[32:35], s44 offen offset:3072 lds
  s_add_u32 s47, s15, 0
  buffer_load_dwordx4 a[0:3], v2, s[36:39], s47 offen offset:0
  buffer_load_dwordx4 a[4:7], v2, s[56:59], s47 offen offset:0
  buffer_load_dwordx4 a[8:11], v2, s[36:39], s47 offen offset:1024
  buffer_load_dwordx4 a[12:15], v2, s[56:59], s47 offen offset:1024
  buffer_load_dwordx4 a[16:19], v2, s[36:39], s47 offen offset:2048
  buffer_load_dwordx4 a[20:23], v2, s[56:59], s47 offen offset:2048
  buffer_load_dwordx4 a[24:27], v2, s[36:39], s47 offen offset:3072
  buffer_load_dwordx4 a[28:31], v2, s[56:59], s47 offen offset:3072
  v_lshrrev_b32 v16, 2, v1
  v_bfe_u32 v17, v16, 1, 2
  v_lshlrev_b32 v16, 7, v16
  v_lshl_add_u32 v16, v17, 5, v16
  v_and_b32 v17, 3, v1
  v_lshl_add_u32 v3, v17, 3, v16
  v_xor_b32 v4, 32, v3
  v_xor_b32 v5, 64, v3
  v_xor_b32 v6, 96, v3
  v_add_u32 v7, 0x10000, v3
  v_add_u32 v8, 0x10000, v4
  v_add_u32 v9, 0x10000, v5
  v_add_u32 v10, 0x10000, v6
  s_add_u32 s44, s60, s13
  s_add_u32 m0, s45, 16384
  s_add_u32 s44, s44, 0
  buffer_load_dwordx4 v11, s[32:35], s44 offen offset:0 lds
  buffer_load_dwordx4 v12, s[32:35], s44 offen offset:1024 lds
  buffer_load_dwordx4 v13, s[32:35], s44 offen offset:2048 lds
  buffer_load_dwordx4 v14, s[32:35], s44 offen offset:3072 lds
  s_add_u32 s47, s16, 0
  buffer_load_dwordx4 a[32:35], v2, s[36:39], s47 offen offset:0
  buffer_load_dwordx4 a[36:39], v2, s[56:59], s47 offen offset:0
  buffer_load_dwordx4 a[40:43], v2, s[36:39], s47 offen offset:1024
  buffer_load_dwordx4 a[44:47], v2, s[56:59], s47 offen offset:1024
  buffer_load_dwordx4 a[48:51], v2, s[36:39], s47 offen offset:2048
  buffer_load_dwordx4 a[52:55], v2, s[56:59], s47 offen offset:2048
  buffer_load_dwordx4 a[56:59], v2, s[36:39], s47 offen offset:3072
  buffer_load_dwordx4 a[60:63], v2, s[56:59], s47 offen offset:3072
  s_mov_b32 s40, s8
  s_mov_b32 s41, s9
  s_mov_b32 s42, 4128768
  s_mov_b32 s43, 0x00020000
  s_lshl_b32 s50, s29, 4
  v_and_b32 v16, 15, v1
  v_add_u32 v16, s50, v16
  v_mul_u32_u24 v16, 2304, v16
  v_lshrrev_b32 v17, 4, v1
  v_lshlrev_b32 v17, 3, v17
  s_mul_i32 s53, s24, 1152
  s_mul_i32 s54, s27, 384
  s_add_u32 s53, s53, s54
  s_lshl_b32 s54, s25, 7
  s_add_u32 s53, s53, s54
  v_add3_u32 v15, v16, v17, s53
  s_add_u32 s68, s10, 33554432
  s_addc_u32 s69, s11, 0
  s_mov_b32 s70, 0x1100000
  s_mov_b32 s71, 0x00020000
  s_add_u32 s72, s10, 50331648
  s_addc_u32 s73, s11, 0
  s_mov_b32 s74, 65536
  s_mov_b32 s75, 0x00020000
  s_mul_i32 s50, s23, 98304
  s_lshl_b32 s53, s28, 12
  s_add_u32 s50, s50, s53
  s_lshl_b32 s53, s51, 15
  s_add_u32 s63, s53, s50
  s_lshl_b32 s54, s52, 15
  s_add_u32 s64, s54, s50
  s_add_u32 s64, s64, 16384
  s_lshl_b32 s55, s25, 15
  s_add_u32 s65, s55, s50
  s_mul_i32 s50, s23, 3
  s_add_u32 s51, s51, s50
  s_add_u32 s52, s52, s50
  s_lshl_b32 s51, s51, 7
  s_lshl_b32 s52, s52, 7
  s_lshl_b32 s50, s22, 7
  v_mov_b32 v20, s52
  v_mov_b32 v21, s51
  v_and_b32 v16, 1, v1
  v_cmp_eq_u32 vcc, 0, v16
  s_nop 1
  v_cndmask_b32 v20, v21, v20, vcc
  v_mov_b32 v22, s50
  v_mov_b32 v23, 1
  s_getpc_b64 s[96:97]
oproj_kernel_pc:
  s_sub_u32 s96, s96, oproj_kernel_pc-oproj_kernel
  s_subb_u32 s97, s97, 0
  s_lshr_b32 s50, s2, 3
  s_lshl_b32 s50, s50, 2
  s_add_u32 s50, s50, s28
  s_lshl_b32 s50, s50, 8
  v_lshl_add_u32 v16, v1, 2, s50
  s_mov_b32 s50, code_end-oproj_kernel-4
  v_min_u32 v16, s50, v16
  global_load_dword v0, v16, s[96:97]
  s_waitcnt vmcnt(21)
  s_barrier
  ds_read_b64_tr_b16 v[96:97], v3 offset:0
  ds_read_b64_tr_b16 v[98:99], v3 offset:2048
  ds_read_b64_tr_b16 v[100:101], v4 offset:0
  ds_read_b64_tr_b16 v[102:103], v4 offset:2048
  ds_read_b64_tr_b16 v[104:105], v5 offset:0
  ds_read_b64_tr_b16 v[106:107], v5 offset:2048
  ds_read_b64_tr_b16 v[108:109], v6 offset:0
  ds_read_b64_tr_b16 v[110:111], v6 offset:2048
  ds_read_b64_tr_b16 v[112:113], v3 offset:4096
  ds_read_b64_tr_b16 v[114:115], v3 offset:6144
  ds_read_b64_tr_b16 v[116:117], v4 offset:4096
  ds_read_b64_tr_b16 v[118:119], v4 offset:6144
  ds_read_b64_tr_b16 v[120:121], v5 offset:4096
  ds_read_b64_tr_b16 v[122:123], v5 offset:6144
  ds_read_b64_tr_b16 v[124:125], v6 offset:4096
  ds_read_b64_tr_b16 v[126:127], v6 offset:6144
  s_waitcnt vmcnt(20) lgkmcnt(14)
  v_mfma_f32_16x16x32_bf16 v[32:35], v[96:99], a[0:3], 0
  s_waitcnt vmcnt(19)
  s_add_u32 s44, s60, s14
  s_add_u32 m0, s45, 32768
  s_add_u32 s44, s44, 0
  ds_read_b64_tr_b16 v[128:129], v3 offset:8192
  buffer_load_dwordx4 v11, s[32:35], s44 offen offset:0 lds
  v_mfma_f32_16x16x32_bf16 v[36:39], v[96:99], a[4:7], 0
  s_waitcnt lgkmcnt(13)
  ds_read_b64_tr_b16 v[130:131], v3 offset:10240
  v_mfma_f32_16x16x32_bf16 v[40:43], v[100:103], a[0:3], 0
  ds_read_b64_tr_b16 v[132:133], v4 offset:8192
  v_mfma_f32_16x16x32_bf16 v[44:47], v[100:103], a[4:7], 0
  s_waitcnt lgkmcnt(13)
  ds_read_b64_tr_b16 v[134:135], v4 offset:10240
  buffer_load_dwordx4 v12, s[32:35], s44 offen offset:1024 lds
  v_mfma_f32_16x16x32_bf16 v[48:51], v[104:107], a[0:3], 0
  ds_read_b64_tr_b16 v[136:137], v5 offset:8192
  v_mfma_f32_16x16x32_bf16 v[52:55], v[104:107], a[4:7], 0
  s_waitcnt lgkmcnt(13)
  ds_read_b64_tr_b16 v[138:139], v5 offset:10240
  v_mfma_f32_16x16x32_bf16 v[56:59], v[108:111], a[0:3], 0
  ds_read_b64_tr_b16 v[140:141], v6 offset:8192
  buffer_load_dwordx4 v13, s[32:35], s44 offen offset:2048 lds
  v_mfma_f32_16x16x32_bf16 v[60:63], v[108:111], a[4:7], 0
  s_waitcnt vmcnt(21) lgkmcnt(13)
  ds_read_b64_tr_b16 v[142:143], v6 offset:10240
  v_mfma_f32_16x16x32_bf16 v[32:35], v[112:115], a[8:11], v[32:35]
  s_waitcnt vmcnt(20)
  ds_read_b64_tr_b16 v[144:145], v3 offset:12288
  v_mfma_f32_16x16x32_bf16 v[36:39], v[112:115], a[12:15], v[36:39]
  s_waitcnt lgkmcnt(13)
  ds_read_b64_tr_b16 v[146:147], v3 offset:14336
  buffer_load_dwordx4 v14, s[32:35], s44 offen offset:3072 lds
  v_mfma_f32_16x16x32_bf16 v[40:43], v[116:119], a[8:11], v[40:43]
  ds_read_b64_tr_b16 v[148:149], v4 offset:12288
  v_mfma_f32_16x16x32_bf16 v[44:47], v[116:119], a[12:15], v[44:47]
  s_waitcnt lgkmcnt(13)
  ds_read_b64_tr_b16 v[150:151], v4 offset:14336
  v_mfma_f32_16x16x32_bf16 v[48:51], v[120:123], a[8:11], v[48:51]
  s_add_u32 s47, s17, 0
  ds_read_b64_tr_b16 v[152:153], v5 offset:12288
  buffer_load_dwordx4 a[64:67], v2, s[36:39], s47 offen offset:0
  v_mfma_f32_16x16x32_bf16 v[52:55], v[120:123], a[12:15], v[52:55]
  s_waitcnt lgkmcnt(13)
  ds_read_b64_tr_b16 v[154:155], v5 offset:14336
  v_mfma_f32_16x16x32_bf16 v[56:59], v[124:127], a[8:11], v[56:59]
  ds_read_b64_tr_b16 v[156:157], v6 offset:12288
  v_mfma_f32_16x16x32_bf16 v[60:63], v[124:127], a[12:15], v[60:63]
  s_waitcnt vmcnt(21) lgkmcnt(13)
  ds_read_b64_tr_b16 v[158:159], v6 offset:14336
  buffer_load_dwordx4 a[68:71], v2, s[56:59], s47 offen offset:0
  v_mfma_f32_16x16x32_bf16 v[32:35], v[128:131], a[16:19], v[32:35]
  s_waitcnt vmcnt(15)
  s_barrier
  ds_read_b64_tr_b16 v[96:97], v3 offset:16384
  v_mfma_f32_16x16x32_bf16 v[36:39], v[128:131], a[20:23], v[36:39]
  s_waitcnt lgkmcnt(13)
  ds_read_b64_tr_b16 v[98:99], v3 offset:18432
  v_mfma_f32_16x16x32_bf16 v[40:43], v[132:135], a[16:19], v[40:43]
  ds_read_b64_tr_b16 v[100:101], v4 offset:16384
  buffer_load_dwordx4 a[72:75], v2, s[36:39], s47 offen offset:1024
  v_mfma_f32_16x16x32_bf16 v[44:47], v[132:135], a[20:23], v[44:47]
  s_waitcnt lgkmcnt(13)
  ds_read_b64_tr_b16 v[102:103], v4 offset:18432
  v_mfma_f32_16x16x32_bf16 v[48:51], v[136:139], a[16:19], v[48:51]
  ds_read_b64_tr_b16 v[104:105], v5 offset:16384
  v_mfma_f32_16x16x32_bf16 v[52:55], v[136:139], a[20:23], v[52:55]
  s_waitcnt lgkmcnt(13)
  ds_read_b64_tr_b16 v[106:107], v5 offset:18432
  buffer_load_dwordx4 a[76:79], v2, s[56:59], s47 offen offset:1024
  v_mfma_f32_16x16x32_bf16 v[56:59], v[140:143], a[16:19], v[56:59]
  ds_read_b64_tr_b16 v[108:109], v6 offset:16384
  v_mfma_f32_16x16x32_bf16 v[60:63], v[140:143], a[20:23], v[60:63]
  s_waitcnt lgkmcnt(13)
  ds_read_b64_tr_b16 v[110:111], v6 offset:18432
  v_mfma_f32_16x16x32_bf16 v[32:35], v[144:147], a[24:27], v[32:35]
  ds_read_b64_tr_b16 v[112:113], v3 offset:20480
  buffer_load_dwordx4 a[80:83], v2, s[36:39], s47 offen offset:2048
  v_mfma_f32_16x16x32_bf16 v[36:39], v[144:147], a[28:31], v[36:39]
  s_waitcnt lgkmcnt(13)
  ds_read_b64_tr_b16 v[114:115], v3 offset:22528
  v_mfma_f32_16x16x32_bf16 v[40:43], v[148:151], a[24:27], v[40:43]
  ds_read_b64_tr_b16 v[116:117], v4 offset:20480
  v_mfma_f32_16x16x32_bf16 v[44:47], v[148:151], a[28:31], v[44:47]
  s_waitcnt lgkmcnt(13)
  ds_read_b64_tr_b16 v[118:119], v4 offset:22528
  buffer_load_dwordx4 a[84:87], v2, s[56:59], s47 offen offset:2048
  v_mfma_f32_16x16x32_bf16 v[48:51], v[152:155], a[24:27], v[48:51]
  ds_read_b64_tr_b16 v[120:121], v5 offset:20480
  v_mfma_f32_16x16x32_bf16 v[52:55], v[152:155], a[28:31], v[52:55]
  s_waitcnt lgkmcnt(13)
  ds_read_b64_tr_b16 v[122:123], v5 offset:22528
  v_mfma_f32_16x16x32_bf16 v[56:59], v[156:159], a[24:27], v[56:59]
  ds_read_b64_tr_b16 v[124:125], v6 offset:20480
  buffer_load_dwordx4 a[88:91], v2, s[36:39], s47 offen offset:3072
  v_mfma_f32_16x16x32_bf16 v[60:63], v[156:159], a[28:31], v[60:63]
  s_waitcnt vmcnt(19) lgkmcnt(13)
  ds_read_b64_tr_b16 v[126:127], v6 offset:22528
  v_mfma_f32_16x16x32_bf16 v[32:35], v[96:99], a[32:35], v[32:35]
  s_waitcnt vmcnt(18)
  ds_read_b64_tr_b16 v[128:129], v3 offset:24576
  v_mfma_f32_16x16x32_bf16 v[36:39], v[96:99], a[36:39], v[36:39]
  s_waitcnt lgkmcnt(13)
  ds_read_b64_tr_b16 v[130:131], v3 offset:26624
  buffer_load_dwordx4 a[92:95], v2, s[56:59], s47 offen offset:3072
  v_mfma_f32_16x16x32_bf16 v[40:43], v[100:103], a[32:35], v[40:43]
  ds_read_b64_tr_b16 v[132:133], v4 offset:24576
  v_mfma_f32_16x16x32_bf16 v[44:47], v[100:103], a[36:39], v[44:47]
  s_waitcnt lgkmcnt(13)
  ds_read_b64_tr_b16 v[134:135], v4 offset:26624
  v_mfma_f32_16x16x32_bf16 v[48:51], v[104:107], a[32:35], v[48:51]
  s_add_u32 s44, s61, s12
  s_add_u32 m0, s45, 49152
  s_add_u32 s44, s44, 0
  ds_read_b64_tr_b16 v[136:137], v5 offset:24576
  buffer_load_dwordx4 v11, s[32:35], s44 offen offset:0 lds
  v_mfma_f32_16x16x32_bf16 v[52:55], v[104:107], a[36:39], v[52:55]
  s_waitcnt lgkmcnt(13)
  ds_read_b64_tr_b16 v[138:139], v5 offset:26624
  v_mfma_f32_16x16x32_bf16 v[56:59], v[108:111], a[32:35], v[56:59]
  ds_read_b64_tr_b16 v[140:141], v6 offset:24576
  v_mfma_f32_16x16x32_bf16 v[60:63], v[108:111], a[36:39], v[60:63]
  s_waitcnt vmcnt(19) lgkmcnt(13)
  ds_read_b64_tr_b16 v[142:143], v6 offset:26624
  buffer_load_dwordx4 v12, s[32:35], s44 offen offset:1024 lds
  v_mfma_f32_16x16x32_bf16 v[32:35], v[112:115], a[40:43], v[32:35]
  s_waitcnt vmcnt(19)
  ds_read_b64_tr_b16 v[144:145], v3 offset:28672
  v_mfma_f32_16x16x32_bf16 v[36:39], v[112:115], a[44:47], v[36:39]
  s_waitcnt lgkmcnt(13)
  ds_read_b64_tr_b16 v[146:147], v3 offset:30720
  v_mfma_f32_16x16x32_bf16 v[40:43], v[116:119], a[40:43], v[40:43]
  ds_read_b64_tr_b16 v[148:149], v4 offset:28672
  buffer_load_dwordx4 v13, s[32:35], s44 offen offset:2048 lds
  v_mfma_f32_16x16x32_bf16 v[44:47], v[116:119], a[44:47], v[44:47]
  s_waitcnt lgkmcnt(13)
  ds_read_b64_tr_b16 v[150:151], v4 offset:30720
  v_mfma_f32_16x16x32_bf16 v[48:51], v[120:123], a[40:43], v[48:51]
  ds_read_b64_tr_b16 v[152:153], v5 offset:28672
  v_mfma_f32_16x16x32_bf16 v[52:55], v[120:123], a[44:47], v[52:55]
  s_waitcnt lgkmcnt(13)
  ds_read_b64_tr_b16 v[154:155], v5 offset:30720
  buffer_load_dwordx4 v14, s[32:35], s44 offen offset:3072 lds
  v_mfma_f32_16x16x32_bf16 v[56:59], v[124:127], a[40:43], v[56:59]
  ds_read_b64_tr_b16 v[156:157], v6 offset:28672
  v_mfma_f32_16x16x32_bf16 v[60:63], v[124:127], a[44:47], v[60:63]
  s_waitcnt vmcnt(20) lgkmcnt(13)
  ds_read_b64_tr_b16 v[158:159], v6 offset:30720
  v_mfma_f32_16x16x32_bf16 v[32:35], v[128:131], a[48:51], v[32:35]
  s_waitcnt vmcnt(12)
  s_barrier
  s_add_u32 s44, s60, s12
  s_add_u32 m0, s45, 65536
  s_add_u32 s44, s44, 442368
  ds_read_b64_tr_b16 v[96:97], v3 offset:32768
  buffer_load_dwordx4 v11, s[32:35], s44 offen offset:0 lds
  v_mfma_f32_16x16x32_bf16 v[36:39], v[128:131], a[52:55], v[36:39]
  s_waitcnt lgkmcnt(13)
  ds_read_b64_tr_b16 v[98:99], v3 offset:34816
  v_mfma_f32_16x16x32_bf16 v[40:43], v[132:135], a[48:51], v[40:43]
  ds_read_b64_tr_b16 v[100:101], v4 offset:32768
  v_mfma_f32_16x16x32_bf16 v[44:47], v[132:135], a[52:55], v[44:47]
  s_waitcnt lgkmcnt(13)
  ds_read_b64_tr_b16 v[102:103], v4 offset:34816
  buffer_load_dwordx4 v12, s[32:35], s44 offen offset:1024 lds
  v_mfma_f32_16x16x32_bf16 v[48:51], v[136:139], a[48:51], v[48:51]
  ds_read_b64_tr_b16 v[104:105], v5 offset:32768
  v_mfma_f32_16x16x32_bf16 v[52:55], v[136:139], a[52:55], v[52:55]
  s_waitcnt lgkmcnt(13)
  ds_read_b64_tr_b16 v[106:107], v5 offset:34816
  v_mfma_f32_16x16x32_bf16 v[56:59], v[140:143], a[48:51], v[56:59]
  ds_read_b64_tr_b16 v[108:109], v6 offset:32768
  buffer_load_dwordx4 v13, s[32:35], s44 offen offset:2048 lds
  v_mfma_f32_16x16x32_bf16 v[60:63], v[140:143], a[52:55], v[60:63]
  s_waitcnt lgkmcnt(13)
  ds_read_b64_tr_b16 v[110:111], v6 offset:34816
  v_mfma_f32_16x16x32_bf16 v[32:35], v[144:147], a[56:59], v[32:35]
  ds_read_b64_tr_b16 v[112:113], v3 offset:36864
  v_mfma_f32_16x16x32_bf16 v[36:39], v[144:147], a[60:63], v[36:39]
  s_waitcnt lgkmcnt(13)
  ds_read_b64_tr_b16 v[114:115], v3 offset:38912
  buffer_load_dwordx4 v14, s[32:35], s44 offen offset:3072 lds
  v_mfma_f32_16x16x32_bf16 v[40:43], v[148:151], a[56:59], v[40:43]
  ds_read_b64_tr_b16 v[116:117], v4 offset:36864
  v_mfma_f32_16x16x32_bf16 v[44:47], v[148:151], a[60:63], v[44:47]
  s_waitcnt lgkmcnt(13)
  ds_read_b64_tr_b16 v[118:119], v4 offset:38912
  v_mfma_f32_16x16x32_bf16 v[48:51], v[152:155], a[56:59], v[48:51]
  s_add_u32 s47, s15, 12288
  ds_read_b64_tr_b16 v[120:121], v5 offset:36864
  buffer_load_dwordx4 a[96:99], v2, s[36:39], s47 offen offset:0
  v_mfma_f32_16x16x32_bf16 v[52:55], v[152:155], a[60:63], v[52:55]
  s_waitcnt lgkmcnt(13)
  ds_read_b64_tr_b16 v[122:123], v5 offset:38912
  v_mfma_f32_16x16x32_bf16 v[56:59], v[156:159], a[56:59], v[56:59]
  ds_read_b64_tr_b16 v[124:125], v6 offset:36864
  v_mfma_f32_16x16x32_bf16 v[60:63], v[156:159], a[60:63], v[60:63]
  s_waitcnt vmcnt(16) lgkmcnt(13)
  ds_read_b64_tr_b16 v[126:127], v6 offset:38912
  buffer_load_dwordx4 a[100:103], v2, s[56:59], s47 offen offset:0
  v_mfma_f32_16x16x32_bf16 v[32:35], v[96:99], a[64:67], v[32:35]
  s_waitcnt vmcnt(16)
  ds_read_b64_tr_b16 v[128:129], v3 offset:40960
  v_mfma_f32_16x16x32_bf16 v[36:39], v[96:99], a[68:71], v[36:39]
  s_waitcnt lgkmcnt(13)
  ds_read_b64_tr_b16 v[130:131], v3 offset:43008
  v_mfma_f32_16x16x32_bf16 v[40:43], v[100:103], a[64:67], v[40:43]
  ds_read_b64_tr_b16 v[132:133], v4 offset:40960
  buffer_load_dwordx4 a[104:107], v2, s[36:39], s47 offen offset:1024
  v_mfma_f32_16x16x32_bf16 v[44:47], v[100:103], a[68:71], v[44:47]
  s_waitcnt lgkmcnt(13)
  ds_read_b64_tr_b16 v[134:135], v4 offset:43008
  v_mfma_f32_16x16x32_bf16 v[48:51], v[104:107], a[64:67], v[48:51]
  ds_read_b64_tr_b16 v[136:137], v5 offset:40960
  v_mfma_f32_16x16x32_bf16 v[52:55], v[104:107], a[68:71], v[52:55]
  s_waitcnt lgkmcnt(13)
  ds_read_b64_tr_b16 v[138:139], v5 offset:43008
  buffer_load_dwordx4 a[108:111], v2, s[56:59], s47 offen offset:1024
  v_mfma_f32_16x16x32_bf16 v[56:59], v[108:111], a[64:67], v[56:59]
  ds_read_b64_tr_b16 v[140:141], v6 offset:40960
  v_mfma_f32_16x16x32_bf16 v[60:63], v[108:111], a[68:71], v[60:63]
  s_waitcnt vmcnt(17) lgkmcnt(13)
  ds_read_b64_tr_b16 v[142:143], v6 offset:43008
  v_mfma_f32_16x16x32_bf16 v[32:35], v[112:115], a[72:75], v[32:35]
  s_waitcnt vmcnt(16)
  ds_read_b64_tr_b16 v[144:145], v3 offset:45056
  buffer_load_dwordx4 a[112:115], v2, s[36:39], s47 offen offset:2048
  v_mfma_f32_16x16x32_bf16 v[36:39], v[112:115], a[76:79], v[36:39]
  s_waitcnt lgkmcnt(13)
  ds_read_b64_tr_b16 v[146:147], v3 offset:47104
  v_mfma_f32_16x16x32_bf16 v[40:43], v[116:119], a[72:75], v[40:43]
  ds_read_b64_tr_b16 v[148:149], v4 offset:45056
  v_mfma_f32_16x16x32_bf16 v[44:47], v[116:119], a[76:79], v[44:47]
  s_waitcnt lgkmcnt(13)
  ds_read_b64_tr_b16 v[150:151], v4 offset:47104
  buffer_load_dwordx4 a[116:119], v2, s[56:59], s47 offen offset:2048
  v_mfma_f32_16x16x32_bf16 v[48:51], v[120:123], a[72:75], v[48:51]
  ds_read_b64_tr_b16 v[152:153], v5 offset:45056
  v_mfma_f32_16x16x32_bf16 v[52:55], v[120:123], a[76:79], v[52:55]
  s_waitcnt lgkmcnt(13)
  ds_read_b64_tr_b16 v[154:155], v5 offset:47104
  v_mfma_f32_16x16x32_bf16 v[56:59], v[124:127], a[72:75], v[56:59]
  ds_read_b64_tr_b16 v[156:157], v6 offset:45056
  buffer_load_dwordx4 a[120:123], v2, s[36:39], s47 offen offset:3072
  v_mfma_f32_16x16x32_bf16 v[60:63], v[124:127], a[76:79], v[60:63]
  s_waitcnt vmcnt(18) lgkmcnt(13)
  ds_read_b64_tr_b16 v[158:159], v6 offset:47104
  v_mfma_f32_16x16x32_bf16 v[32:35], v[128:131], a[80:83], v[32:35]
  s_waitcnt vmcnt(11)
  s_barrier
  ds_read_b64_tr_b16 v[96:97], v3 offset:49152
  v_mfma_f32_16x16x32_bf16 v[36:39], v[128:131], a[84:87], v[36:39]
  s_waitcnt lgkmcnt(13)
  ds_read_b64_tr_b16 v[98:99], v3 offset:51200
  buffer_load_dwordx4 a[124:127], v2, s[56:59], s47 offen offset:3072
  v_mfma_f32_16x16x32_bf16 v[40:43], v[132:135], a[80:83], v[40:43]
  ds_read_b64_tr_b16 v[100:101], v4 offset:49152
  v_mfma_f32_16x16x32_bf16 v[44:47], v[132:135], a[84:87], v[44:47]
  s_waitcnt lgkmcnt(13)
  ds_read_b64_tr_b16 v[102:103], v4 offset:51200
  v_mfma_f32_16x16x32_bf16 v[48:51], v[136:139], a[80:83], v[48:51]
  s_add_u32 s44, s61, s13
  s_add_u32 m0, s45, 81920
  s_add_u32 s44, s44, 0
  ds_read_b64_tr_b16 v[104:105], v5 offset:49152
  buffer_load_dwordx4 v11, s[32:35], s44 offen offset:0 lds
  v_mfma_f32_16x16x32_bf16 v[52:55], v[136:139], a[84:87], v[52:55]
  s_waitcnt lgkmcnt(13)
  ds_read_b64_tr_b16 v[106:107], v5 offset:51200
  v_mfma_f32_16x16x32_bf16 v[56:59], v[140:143], a[80:83], v[56:59]
  ds_read_b64_tr_b16 v[108:109], v6 offset:49152
  v_mfma_f32_16x16x32_bf16 v[60:63], v[140:143], a[84:87], v[60:63]
  s_waitcnt lgkmcnt(13)
  ds_read_b64_tr_b16 v[110:111], v6 offset:51200
  buffer_load_dwordx4 v12, s[32:35], s44 offen offset:1024 lds
  v_mfma_f32_16x16x32_bf16 v[32:35], v[144:147], a[88:91], v[32:35]
  ds_read_b64_tr_b16 v[112:113], v3 offset:53248
  v_mfma_f32_16x16x32_bf16 v[36:39], v[144:147], a[92:95], v[36:39]
  s_waitcnt lgkmcnt(13)
  ds_read_b64_tr_b16 v[114:115], v3 offset:55296
  v_mfma_f32_16x16x32_bf16 v[40:43], v[148:151], a[88:91], v[40:43]
  ds_read_b64_tr_b16 v[116:117], v4 offset:53248
  buffer_load_dwordx4 v13, s[32:35], s44 offen offset:2048 lds
  v_mfma_f32_16x16x32_bf16 v[44:47], v[148:151], a[92:95], v[44:47]
  s_waitcnt lgkmcnt(13)
  ds_read_b64_tr_b16 v[118:119], v4 offset:55296
  v_mfma_f32_16x16x32_bf16 v[48:51], v[152:155], a[88:91], v[48:51]
  ds_read_b64_tr_b16 v[120:121], v5 offset:53248
  v_mfma_f32_16x16x32_bf16 v[52:55], v[152:155], a[92:95], v[52:55]
  s_waitcnt lgkmcnt(13)
  ds_read_b64_tr_b16 v[122:123], v5 offset:55296
  buffer_load_dwordx4 v14, s[32:35], s44 offen offset:3072 lds
  v_mfma_f32_16x16x32_bf16 v[56:59], v[156:159], a[88:91], v[56:59]
  ds_read_b64_tr_b16 v[124:125], v6 offset:53248
  v_mfma_f32_16x16x32_bf16 v[60:63], v[156:159], a[92:95], v[60:63]
  s_waitcnt lgkmcnt(13)
  ds_read_b64_tr_b16 v[126:127], v6 offset:55296
  v_mfma_f32_16x16x32_bf16 v[64:67], v[96:99], a[0:3], 0
  s_add_u32 s44, s60, s13
  s_add_u32 m0, s45, 98304
  s_add_u32 s44, s44, 442368
  ds_read_b64_tr_b16 v[128:129], v3 offset:57344
  buffer_load_dwordx4 v11, s[32:35], s44 offen offset:0 lds
  v_mfma_f32_16x16x32_bf16 v[68:71], v[96:99], a[4:7], 0
  s_waitcnt lgkmcnt(13)
  ds_read_b64_tr_b16 v[130:131], v3 offset:59392
  v_mfma_f32_16x16x32_bf16 v[72:75], v[100:103], a[0:3], 0
  ds_read_b64_tr_b16 v[132:133], v4 offset:57344
  v_mfma_f32_16x16x32_bf16 v[76:79], v[100:103], a[4:7], 0
  s_waitcnt lgkmcnt(13)
  ds_read_b64_tr_b16 v[134:135], v4 offset:59392
  buffer_load_dwordx4 v12, s[32:35], s44 offen offset:1024 lds
  v_mfma_f32_16x16x32_bf16 v[80:83], v[104:107], a[0:3], 0
  ds_read_b64_tr_b16 v[136:137], v5 offset:57344
  v_mfma_f32_16x16x32_bf16 v[84:87], v[104:107], a[4:7], 0
  s_waitcnt lgkmcnt(13)
  ds_read_b64_tr_b16 v[138:139], v5 offset:59392
  v_mfma_f32_16x16x32_bf16 v[88:91], v[108:111], a[0:3], 0
  ds_read_b64_tr_b16 v[140:141], v6 offset:57344
  buffer_load_dwordx4 v13, s[32:35], s44 offen offset:2048 lds
  v_mfma_f32_16x16x32_bf16 v[92:95], v[108:111], a[4:7], 0
  s_waitcnt lgkmcnt(13)
  ds_read_b64_tr_b16 v[142:143], v6 offset:59392
  v_mfma_f32_16x16x32_bf16 v[64:67], v[112:115], a[8:11], v[64:67]
  ds_read_b64_tr_b16 v[144:145], v3 offset:61440
  v_mfma_f32_16x16x32_bf16 v[68:71], v[112:115], a[12:15], v[68:71]
  s_waitcnt lgkmcnt(13)
  ds_read_b64_tr_b16 v[146:147], v3 offset:63488
  buffer_load_dwordx4 v14, s[32:35], s44 offen offset:3072 lds
  v_mfma_f32_16x16x32_bf16 v[72:75], v[116:119], a[8:11], v[72:75]
  ds_read_b64_tr_b16 v[148:149], v4 offset:61440
  v_mfma_f32_16x16x32_bf16 v[76:79], v[116:119], a[12:15], v[76:79]
  s_waitcnt lgkmcnt(13)
  ds_read_b64_tr_b16 v[150:151], v4 offset:63488
  v_mfma_f32_16x16x32_bf16 v[80:83], v[120:123], a[8:11], v[80:83]
  s_add_u32 s47, s16, 12288
  ds_read_b64_tr_b16 v[152:153], v5 offset:61440
  buffer_load_dwordx4 a[128:131], v2, s[36:39], s47 offen offset:0
  v_mfma_f32_16x16x32_bf16 v[84:87], v[120:123], a[12:15], v[84:87]
  s_waitcnt lgkmcnt(13)
  ds_read_b64_tr_b16 v[154:155], v5 offset:63488
  v_mfma_f32_16x16x32_bf16 v[88:91], v[124:127], a[8:11], v[88:91]
  ds_read_b64_tr_b16 v[156:157], v6 offset:61440
  v_mfma_f32_16x16x32_bf16 v[92:95], v[124:127], a[12:15], v[92:95]
  s_waitcnt lgkmcnt(13)
  ds_read_b64_tr_b16 v[158:159], v6 offset:63488
  buffer_load_dwordx4 a[132:135], v2, s[56:59], s47 offen offset:0
  v_mfma_f32_16x16x32_bf16 v[64:67], v[128:131], a[16:19], v[64:67]
  s_waitcnt vmcnt(18)
  s_barrier
  ds_read_b64_tr_b16 v[96:97], v7 offset:0
  v_mfma_f32_16x16x32_bf16 v[68:71], v[128:131], a[20:23], v[68:71]
  s_waitcnt lgkmcnt(13)
  ds_read_b64_tr_b16 v[98:99], v7 offset:2048
  v_mfma_f32_16x16x32_bf16 v[72:75], v[132:135], a[16:19], v[72:75]
  ds_read_b64_tr_b16 v[100:101], v8 offset:0
  buffer_load_dwordx4 a[136:139], v2, s[36:39], s47 offen offset:1024
  v_mfma_f32_16x16x32_bf16 v[76:79], v[132:135], a[20:23], v[76:79]
  s_waitcnt lgkmcnt(13)
  ds_read_b64_tr_b16 v[102:103], v8 offset:2048
  v_mfma_f32_16x16x32_bf16 v[80:83], v[136:139], a[16:19], v[80:83]
  ds_read_b64_tr_b16 v[104:105], v9 offset:0
  v_mfma_f32_16x16x32_bf16 v[84:87], v[136:139], a[20:23], v[84:87]
  s_waitcnt lgkmcnt(13)
  ds_read_b64_tr_b16 v[106:107], v9 offset:2048
  buffer_load_dwordx4 a[140:143], v2, s[56:59], s47 offen offset:1024
  v_mfma_f32_16x16x32_bf16 v[88:91], v[140:143], a[16:19], v[88:91]
  ds_read_b64_tr_b16 v[108:109], v10 offset:0
  v_mfma_f32_16x16x32_bf16 v[92:95], v[140:143], a[20:23], v[92:95]
  s_waitcnt lgkmcnt(13)
  ds_read_b64_tr_b16 v[110:111], v10 offset:2048
  v_mfma_f32_16x16x32_bf16 v[64:67], v[144:147], a[24:27], v[64:67]
  ds_read_b64_tr_b16 v[112:113], v7 offset:4096
  buffer_load_dwordx4 a[144:147], v2, s[36:39], s47 offen offset:2048
  v_mfma_f32_16x16x32_bf16 v[68:71], v[144:147], a[28:31], v[68:71]
  s_waitcnt lgkmcnt(13)
  ds_read_b64_tr_b16 v[114:115], v7 offset:6144
  v_mfma_f32_16x16x32_bf16 v[72:75], v[148:151], a[24:27], v[72:75]
  ds_read_b64_tr_b16 v[116:117], v8 offset:4096
  v_mfma_f32_16x16x32_bf16 v[76:79], v[148:151], a[28:31], v[76:79]
  s_waitcnt lgkmcnt(13)
  ds_read_b64_tr_b16 v[118:119], v8 offset:6144
  buffer_load_dwordx4 a[148:151], v2, s[56:59], s47 offen offset:2048
  v_mfma_f32_16x16x32_bf16 v[80:83], v[152:155], a[24:27], v[80:83]
  ds_read_b64_tr_b16 v[120:121], v9 offset:4096
  v_mfma_f32_16x16x32_bf16 v[84:87], v[152:155], a[28:31], v[84:87]
  s_waitcnt lgkmcnt(13)
  ds_read_b64_tr_b16 v[122:123], v9 offset:6144
  v_mfma_f32_16x16x32_bf16 v[88:91], v[156:159], a[24:27], v[88:91]
  ds_read_b64_tr_b16 v[124:125], v10 offset:4096
  buffer_load_dwordx4 a[152:155], v2, s[36:39], s47 offen offset:3072
  v_mfma_f32_16x16x32_bf16 v[92:95], v[156:159], a[28:31], v[92:95]
  s_waitcnt vmcnt(22) lgkmcnt(13)
  ds_read_b64_tr_b16 v[126:127], v10 offset:6144
  v_mfma_f32_16x16x32_bf16 v[32:35], v[96:99], a[96:99], v[32:35]
  s_waitcnt vmcnt(21)
  ds_read_b64_tr_b16 v[128:129], v7 offset:8192
  v_mfma_f32_16x16x32_bf16 v[36:39], v[96:99], a[100:103], v[36:39]
  s_waitcnt lgkmcnt(13)
  ds_read_b64_tr_b16 v[130:131], v7 offset:10240
  buffer_load_dwordx4 a[156:159], v2, s[56:59], s47 offen offset:3072
  v_mfma_f32_16x16x32_bf16 v[40:43], v[100:103], a[96:99], v[40:43]
  ds_read_b64_tr_b16 v[132:133], v8 offset:8192
  v_mfma_f32_16x16x32_bf16 v[44:47], v[100:103], a[100:103], v[44:47]
  s_waitcnt lgkmcnt(13)
  ds_read_b64_tr_b16 v[134:135], v8 offset:10240
  v_mfma_f32_16x16x32_bf16 v[48:51], v[104:107], a[96:99], v[48:51]
  s_add_u32 s44, s61, s14
  s_add_u32 m0, s45, 114688
  s_add_u32 s44, s44, 0
  ds_read_b64_tr_b16 v[136:137], v9 offset:8192
  buffer_load_dwordx4 v11, s[32:35], s44 offen offset:0 lds
  v_mfma_f32_16x16x32_bf16 v[52:55], v[104:107], a[100:103], v[52:55]
  s_waitcnt lgkmcnt(13)
  ds_read_b64_tr_b16 v[138:139], v9 offset:10240
  v_mfma_f32_16x16x32_bf16 v[56:59], v[108:111], a[96:99], v[56:59]
  ds_read_b64_tr_b16 v[140:141], v10 offset:8192
  v_mfma_f32_16x16x32_bf16 v[60:63], v[108:111], a[100:103], v[60:63]
  s_waitcnt vmcnt(22) lgkmcnt(13)
  ds_read_b64_tr_b16 v[142:143], v10 offset:10240
  buffer_load_dwordx4 v12, s[32:35], s44 offen offset:1024 lds
  v_mfma_f32_16x16x32_bf16 v[32:35], v[112:115], a[104:107], v[32:35]
  s_waitcnt vmcnt(22)
  ds_read_b64_tr_b16 v[144:145], v7 offset:12288
  v_mfma_f32_16x16x32_bf16 v[36:39], v[112:115], a[108:111], v[36:39]
  s_waitcnt lgkmcnt(13)
  ds_read_b64_tr_b16 v[146:147], v7 offset:14336
  v_mfma_f32_16x16x32_bf16 v[40:43], v[116:119], a[104:107], v[40:43]
  ds_read_b64_tr_b16 v[148:149], v8 offset:12288
  buffer_load_dwordx4 v13, s[32:35], s44 offen offset:2048 lds
  v_mfma_f32_16x16x32_bf16 v[44:47], v[116:119], a[108:111], v[44:47]
  s_waitcnt lgkmcnt(13)
  ds_read_b64_tr_b16 v[150:151], v8 offset:14336
  v_mfma_f32_16x16x32_bf16 v[48:51], v[120:123], a[104:107], v[48:51]
  ds_read_b64_tr_b16 v[152:153], v9 offset:12288
  v_mfma_f32_16x16x32_bf16 v[52:55], v[120:123], a[108:111], v[52:55]
  s_waitcnt lgkmcnt(13)
  ds_read_b64_tr_b16 v[154:155], v9 offset:14336
  buffer_load_dwordx4 v14, s[32:35], s44 offen offset:3072 lds
  v_mfma_f32_16x16x32_bf16 v[56:59], v[124:127], a[104:107], v[56:59]
  ds_read_b64_tr_b16 v[156:157], v10 offset:12288
  v_mfma_f32_16x16x32_bf16 v[60:63], v[124:127], a[108:111], v[60:63]
  s_waitcnt vmcnt(23) lgkmcnt(13)
  ds_read_b64_tr_b16 v[158:159], v10 offset:14336
  v_mfma_f32_16x16x32_bf16 v[32:35], v[128:131], a[112:115], v[32:35]
  s_waitcnt vmcnt(16)
  s_barrier
  s_add_u32 s44, s60, s14
  s_add_u32 m0, s45, 0
  s_add_u32 s44, s44, 442368
  ds_read_b64_tr_b16 v[96:97], v7 offset:16384
  buffer_load_dwordx4 v11, s[32:35], s44 offen offset:0 lds
  v_mfma_f32_16x16x32_bf16 v[36:39], v[128:131], a[116:119], v[36:39]
  s_waitcnt lgkmcnt(13)
  ds_read_b64_tr_b16 v[98:99], v7 offset:18432
  v_mfma_f32_16x16x32_bf16 v[40:43], v[132:135], a[112:115], v[40:43]
  ds_read_b64_tr_b16 v[100:101], v8 offset:16384
  v_mfma_f32_16x16x32_bf16 v[44:47], v[132:135], a[116:119], v[44:47]
  s_waitcnt lgkmcnt(13)
  ds_read_b64_tr_b16 v[102:103], v8 offset:18432
  buffer_load_dwordx4 v12, s[32:35], s44 offen offset:1024 lds
  v_mfma_f32_16x16x32_bf16 v[48:51], v[136:139], a[112:115], v[48:51]
  ds_read_b64_tr_b16 v[104:105], v9 offset:16384
  v_mfma_f32_16x16x32_bf16 v[52:55], v[136:139], a[116:119], v[52:55]
  s_waitcnt lgkmcnt(13)
  ds_read_b64_tr_b16 v[106:107], v9 offset:18432
  v_mfma_f32_16x16x32_bf16 v[56:59], v[140:143], a[112:115], v[56:59]
  ds_read_b64_tr_b16 v[108:109], v10 offset:16384
  buffer_load_dwordx4 v13, s[32:35], s44 offen offset:2048 lds
  v_mfma_f32_16x16x32_bf16 v[60:63], v[140:143], a[116:119], v[60:63]
  s_waitcnt lgkmcnt(13)
  ds_read_b64_tr_b16 v[110:111], v10 offset:18432
  v_mfma_f32_16x16x32_bf16 v[32:35], v[144:147], a[120:123], v[32:35]
  ds_read_b64_tr_b16 v[112:113], v7 offset:20480
  v_mfma_f32_16x16x32_bf16 v[36:39], v[144:147], a[124:127], v[36:39]
  s_waitcnt lgkmcnt(13)
  ds_read_b64_tr_b16 v[114:115], v7 offset:22528
  buffer_load_dwordx4 v14, s[32:35], s44 offen offset:3072 lds
  v_mfma_f32_16x16x32_bf16 v[40:43], v[148:151], a[120:123], v[40:43]
  ds_read_b64_tr_b16 v[116:117], v8 offset:20480
  v_mfma_f32_16x16x32_bf16 v[44:47], v[148:151], a[124:127], v[44:47]
  s_waitcnt lgkmcnt(13)
  ds_read_b64_tr_b16 v[118:119], v8 offset:22528
  v_mfma_f32_16x16x32_bf16 v[48:51], v[152:155], a[120:123], v[48:51]
  s_add_u32 s47, s17, 12288
  ds_read_b64_tr_b16 v[120:121], v9 offset:20480
  buffer_load_dwordx4 a[160:163], v2, s[36:39], s47 offen offset:0
  v_mfma_f32_16x16x32_bf16 v[52:55], v[152:155], a[124:127], v[52:55]
  s_waitcnt lgkmcnt(13)
  ds_read_b64_tr_b16 v[122:123], v9 offset:22528
  v_mfma_f32_16x16x32_bf16 v[56:59], v[156:159], a[120:123], v[56:59]
  ds_read_b64_tr_b16 v[124:125], v10 offset:20480
  v_mfma_f32_16x16x32_bf16 v[60:63], v[156:159], a[124:127], v[60:63]
  s_waitcnt lgkmcnt(13)
  ds_read_b64_tr_b16 v[126:127], v10 offset:22528
  buffer_load_dwordx4 a[164:167], v2, s[56:59], s47 offen offset:0
  v_mfma_f32_16x16x32_bf16 v[64:67], v[96:99], a[32:35], v[64:67]
  ds_read_b64_tr_b16 v[128:129], v7 offset:24576
  v_mfma_f32_16x16x32_bf16 v[68:71], v[96:99], a[36:39], v[68:71]
  s_waitcnt lgkmcnt(13)
  ds_read_b64_tr_b16 v[130:131], v7 offset:26624
  v_mfma_f32_16x16x32_bf16 v[72:75], v[100:103], a[32:35], v[72:75]
  ds_read_b64_tr_b16 v[132:133], v8 offset:24576
  buffer_load_dwordx4 a[168:171], v2, s[36:39], s47 offen offset:1024
  v_mfma_f32_16x16x32_bf16 v[76:79], v[100:103], a[36:39], v[76:79]
  s_waitcnt lgkmcnt(13)
  ds_read_b64_tr_b16 v[134:135], v8 offset:26624
  v_mfma_f32_16x16x32_bf16 v[80:83], v[104:107], a[32:35], v[80:83]
  ds_read_b64_tr_b16 v[136:137], v9 offset:24576
  v_mfma_f32_16x16x32_bf16 v[84:87], v[104:107], a[36:39], v[84:87]
  s_waitcnt lgkmcnt(13)
  ds_read_b64_tr_b16 v[138:139], v9 offset:26624
  buffer_load_dwordx4 a[172:175], v2, s[56:59], s47 offen offset:1024
  v_mfma_f32_16x16x32_bf16 v[88:91], v[108:111], a[32:35], v[88:91]
  ds_read_b64_tr_b16 v[140:141], v10 offset:24576
  v_mfma_f32_16x16x32_bf16 v[92:95], v[108:111], a[36:39], v[92:95]
  s_waitcnt lgkmcnt(13)
  ds_read_b64_tr_b16 v[142:143], v10 offset:26624
  v_mfma_f32_16x16x32_bf16 v[64:67], v[112:115], a[40:43], v[64:67]
  ds_read_b64_tr_b16 v[144:145], v7 offset:28672
  buffer_load_dwordx4 a[176:179], v2, s[36:39], s47 offen offset:2048
  v_mfma_f32_16x16x32_bf16 v[68:71], v[112:115], a[44:47], v[68:71]
  s_waitcnt lgkmcnt(13)
  ds_read_b64_tr_b16 v[146:147], v7 offset:30720
  v_mfma_f32_16x16x32_bf16 v[72:75], v[116:119], a[40:43], v[72:75]
  ds_read_b64_tr_b16 v[148:149], v8 offset:28672
  v_mfma_f32_16x16x32_bf16 v[76:79], v[116:119], a[44:47], v[76:79]
  s_waitcnt lgkmcnt(13)
  ds_read_b64_tr_b16 v[150:151], v8 offset:30720
  buffer_load_dwordx4 a[180:183], v2, s[56:59], s47 offen offset:2048
  v_mfma_f32_16x16x32_bf16 v[80:83], v[120:123], a[40:43], v[80:83]
  ds_read_b64_tr_b16 v[152:153], v9 offset:28672
  v_mfma_f32_16x16x32_bf16 v[84:87], v[120:123], a[44:47], v[84:87]
  s_waitcnt lgkmcnt(13)
  ds_read_b64_tr_b16 v[154:155], v9 offset:30720
  v_mfma_f32_16x16x32_bf16 v[88:91], v[124:127], a[40:43], v[88:91]
  ds_read_b64_tr_b16 v[156:157], v10 offset:28672
  buffer_load_dwordx4 a[184:187], v2, s[36:39], s47 offen offset:3072
  v_mfma_f32_16x16x32_bf16 v[92:95], v[124:127], a[44:47], v[92:95]
  s_waitcnt lgkmcnt(13)
  ds_read_b64_tr_b16 v[158:159], v10 offset:30720
  v_mfma_f32_16x16x32_bf16 v[64:67], v[128:131], a[48:51], v[64:67]
  s_waitcnt vmcnt(23)
  s_barrier
  ds_read_b64_tr_b16 v[96:97], v7 offset:32768
  v_mfma_f32_16x16x32_bf16 v[68:71], v[128:131], a[52:55], v[68:71]
  s_waitcnt lgkmcnt(13)
  ds_read_b64_tr_b16 v[98:99], v7 offset:34816
  buffer_load_dwordx4 a[188:191], v2, s[56:59], s47 offen offset:3072
  v_mfma_f32_16x16x32_bf16 v[72:75], v[132:135], a[48:51], v[72:75]
  ds_read_b64_tr_b16 v[100:101], v8 offset:32768
  v_mfma_f32_16x16x32_bf16 v[76:79], v[132:135], a[52:55], v[76:79]
  s_waitcnt lgkmcnt(13)
  ds_read_b64_tr_b16 v[102:103], v8 offset:34816
  v_mfma_f32_16x16x32_bf16 v[80:83], v[136:139], a[48:51], v[80:83]
  s_add_u32 s44, s61, s12
  s_add_u32 m0, s45, 16384
  s_add_u32 s44, s44, 442368
  ds_read_b64_tr_b16 v[104:105], v9 offset:32768
  buffer_load_dwordx4 v11, s[32:35], s44 offen offset:0 lds
  v_mfma_f32_16x16x32_bf16 v[84:87], v[136:139], a[52:55], v[84:87]
  s_waitcnt lgkmcnt(13)
  ds_read_b64_tr_b16 v[106:107], v9 offset:34816
  v_mfma_f32_16x16x32_bf16 v[88:91], v[140:143], a[48:51], v[88:91]
  ds_read_b64_tr_b16 v[108:109], v10 offset:32768
  v_mfma_f32_16x16x32_bf16 v[92:95], v[140:143], a[52:55], v[92:95]
  s_waitcnt lgkmcnt(13)
  ds_read_b64_tr_b16 v[110:111], v10 offset:34816
  buffer_load_dwordx4 v12, s[32:35], s44 offen offset:1024 lds
  v_mfma_f32_16x16x32_bf16 v[64:67], v[144:147], a[56:59], v[64:67]
  ds_read_b64_tr_b16 v[112:113], v7 offset:36864
  v_mfma_f32_16x16x32_bf16 v[68:71], v[144:147], a[60:63], v[68:71]
  s_waitcnt lgkmcnt(13)
  ds_read_b64_tr_b16 v[114:115], v7 offset:38912
  v_mfma_f32_16x16x32_bf16 v[72:75], v[148:151], a[56:59], v[72:75]
  ds_read_b64_tr_b16 v[116:117], v8 offset:36864
  buffer_load_dwordx4 v13, s[32:35], s44 offen offset:2048 lds
  v_mfma_f32_16x16x32_bf16 v[76:79], v[148:151], a[60:63], v[76:79]
  s_waitcnt lgkmcnt(13)
  ds_read_b64_tr_b16 v[118:119], v8 offset:38912
  v_mfma_f32_16x16x32_bf16 v[80:83], v[152:155], a[56:59], v[80:83]
  ds_read_b64_tr_b16 v[120:121], v9 offset:36864
  v_mfma_f32_16x16x32_bf16 v[84:87], v[152:155], a[60:63], v[84:87]
  s_waitcnt lgkmcnt(13)
  ds_read_b64_tr_b16 v[122:123], v9 offset:38912
  buffer_load_dwordx4 v14, s[32:35], s44 offen offset:3072 lds
  v_mfma_f32_16x16x32_bf16 v[88:91], v[156:159], a[56:59], v[88:91]
  ds_read_b64_tr_b16 v[124:125], v10 offset:36864
  v_mfma_f32_16x16x32_bf16 v[92:95], v[156:159], a[60:63], v[92:95]
  s_waitcnt vmcnt(27) lgkmcnt(13)
  ds_read_b64_tr_b16 v[126:127], v10 offset:38912
  v_mfma_f32_16x16x32_bf16 v[32:35], v[96:99], a[128:131], v[32:35]
  s_waitcnt vmcnt(26)
  s_add_u32 s44, s60, s12
  s_add_u32 m0, s45, 32768
  s_add_u32 s44, s44, 884736
  ds_read_b64_tr_b16 v[128:129], v7 offset:40960
  buffer_load_dwordx4 v11, s[32:35], s44 offen offset:0 lds
  v_mfma_f32_16x16x32_bf16 v[36:39], v[96:99], a[132:135], v[36:39]
  s_waitcnt lgkmcnt(13)
  ds_read_b64_tr_b16 v[130:131], v7 offset:43008
  v_mfma_f32_16x16x32_bf16 v[40:43], v[100:103], a[128:131], v[40:43]
  ds_read_b64_tr_b16 v[132:133], v8 offset:40960
  v_mfma_f32_16x16x32_bf16 v[44:47], v[100:103], a[132:135], v[44:47]
  s_waitcnt lgkmcnt(13)
  ds_read_b64_tr_b16 v[134:135], v8 offset:43008
  buffer_load_dwordx4 v12, s[32:35], s44 offen offset:1024 lds
  v_mfma_f32_16x16x32_bf16 v[48:51], v[104:107], a[128:131], v[48:51]
  ds_read_b64_tr_b16 v[136:137], v9 offset:40960
  v_mfma_f32_16x16x32_bf16 v[52:55], v[104:107], a[132:135], v[52:55]
  s_waitcnt lgkmcnt(13)
  ds_read_b64_tr_b16 v[138:139], v9 offset:43008
  v_mfma_f32_16x16x32_bf16 v[56:59], v[108:111], a[128:131], v[56:59]
  ds_read_b64_tr_b16 v[140:141], v10 offset:40960
  buffer_load_dwordx4 v13, s[32:35], s44 offen offset:2048 lds
  v_mfma_f32_16x16x32_bf16 v[60:63], v[108:111], a[132:135], v[60:63]
  s_waitcnt vmcnt(28) lgkmcnt(13)
  ds_read_b64_tr_b16 v[142:143], v10 offset:43008
  v_mfma_f32_16x16x32_bf16 v[32:35], v[112:115], a[136:139], v[32:35]
  s_waitcnt vmcnt(27)
  ds_read_b64_tr_b16 v[144:145], v7 offset:45056
  v_mfma_f32_16x16x32_bf16 v[36:39], v[112:115], a[140:143], v[36:39]
  s_waitcnt lgkmcnt(13)
  ds_read_b64_tr_b16 v[146:147], v7 offset:47104
  buffer_load_dwordx4 v14, s[32:35], s44 offen offset:3072 lds
  v_mfma_f32_16x16x32_bf16 v[40:43], v[116:119], a[136:139], v[40:43]
  ds_read_b64_tr_b16 v[148:149], v8 offset:45056
  v_mfma_f32_16x16x32_bf16 v[44:47], v[116:119], a[140:143], v[44:47]
  s_waitcnt lgkmcnt(13)
  ds_read_b64_tr_b16 v[150:151], v8 offset:47104
  v_mfma_f32_16x16x32_bf16 v[48:51], v[120:123], a[136:139], v[48:51]
  s_add_u32 s47, s15, 24576
  ds_read_b64_tr_b16 v[152:153], v9 offset:45056
  buffer_load_dwordx4 a[192:195], v2, s[36:39], s47 offen offset:0
  v_mfma_f32_16x16x32_bf16 v[52:55], v[120:123], a[140:143], v[52:55]
  s_waitcnt lgkmcnt(13)
  ds_read_b64_tr_b16 v[154:155], v9 offset:47104
  v_mfma_f32_16x16x32_bf16 v[56:59], v[124:127], a[136:139], v[56:59]
  ds_read_b64_tr_b16 v[156:157], v10 offset:45056
  v_mfma_f32_16x16x32_bf16 v[60:63], v[124:127], a[140:143], v[60:63]
  s_waitcnt vmcnt(28) lgkmcnt(13)
  ds_read_b64_tr_b16 v[158:159], v10 offset:47104
  buffer_load_dwordx4 a[196:199], v2, s[56:59], s47 offen offset:0
  v_mfma_f32_16x16x32_bf16 v[32:35], v[128:131], a[144:147], v[32:35]
  s_waitcnt vmcnt(22)
  s_barrier
  ds_read_b64_tr_b16 v[96:97], v7 offset:49152
  v_mfma_f32_16x16x32_bf16 v[36:39], v[128:131], a[148:151], v[36:39]
  s_waitcnt lgkmcnt(13)
  ds_read_b64_tr_b16 v[98:99], v7 offset:51200
  v_mfma_f32_16x16x32_bf16 v[40:43], v[132:135], a[144:147], v[40:43]
  ds_read_b64_tr_b16 v[100:101], v8 offset:49152
  buffer_load_dwordx4 a[200:203], v2, s[36:39], s47 offen offset:1024
  v_mfma_f32_16x16x32_bf16 v[44:47], v[132:135], a[148:151], v[44:47]
  s_waitcnt lgkmcnt(13)
  ds_read_b64_tr_b16 v[102:103], v8 offset:51200
  v_mfma_f32_16x16x32_bf16 v[48:51], v[136:139], a[144:147], v[48:51]
  ds_read_b64_tr_b16 v[104:105], v9 offset:49152
  v_mfma_f32_16x16x32_bf16 v[52:55], v[136:139], a[148:151], v[52:55]
  s_waitcnt lgkmcnt(13)
  ds_read_b64_tr_b16 v[106:107], v9 offset:51200
  buffer_load_dwordx4 a[204:207], v2, s[56:59], s47 offen offset:1024
  v_mfma_f32_16x16x32_bf16 v[56:59], v[140:143], a[144:147], v[56:59]
  ds_read_b64_tr_b16 v[108:109], v10 offset:49152
  v_mfma_f32_16x16x32_bf16 v[60:63], v[140:143], a[148:151], v[60:63]
  s_waitcnt lgkmcnt(13)
  ds_read_b64_tr_b16 v[110:111], v10 offset:51200
  v_mfma_f32_16x16x32_bf16 v[32:35], v[144:147], a[152:155], v[32:35]
  ds_read_b64_tr_b16 v[112:113], v7 offset:53248
  buffer_load_dwordx4 a[208:211], v2, s[36:39], s47 offen offset:2048
  v_mfma_f32_16x16x32_bf16 v[36:39], v[144:147], a[156:159], v[36:39]
  s_waitcnt lgkmcnt(13)
  ds_read_b64_tr_b16 v[114:115], v7 offset:55296
  v_mfma_f32_16x16x32_bf16 v[40:43], v[148:151], a[152:155], v[40:43]
  ds_read_b64_tr_b16 v[116:117], v8 offset:53248
  v_mfma_f32_16x16x32_bf16 v[44:47], v[148:151], a[156:159], v[44:47]
  s_waitcnt lgkmcnt(13)
  ds_read_b64_tr_b16 v[118:119], v8 offset:55296
  buffer_load_dwordx4 a[212:215], v2, s[56:59], s47 offen offset:2048
  v_mfma_f32_16x16x32_bf16 v[48:51], v[152:155], a[152:155], v[48:51]
  ds_read_b64_tr_b16 v[120:121], v9 offset:53248
  v_mfma_f32_16x16x32_bf16 v[52:55], v[152:155], a[156:159], v[52:55]
  s_waitcnt lgkmcnt(13)
  ds_read_b64_tr_b16 v[122:123], v9 offset:55296
  v_mfma_f32_16x16x32_bf16 v[56:59], v[156:159], a[152:155], v[56:59]
  ds_read_b64_tr_b16 v[124:125], v10 offset:53248
  buffer_load_dwordx4 a[216:219], v2, s[36:39], s47 offen offset:3072
  v_mfma_f32_16x16x32_bf16 v[60:63], v[156:159], a[156:159], v[60:63]
  s_waitcnt lgkmcnt(13)
  ds_read_b64_tr_b16 v[126:127], v10 offset:55296
  v_mfma_f32_16x16x32_bf16 v[64:67], v[96:99], a[64:67], v[64:67]
  ds_read_b64_tr_b16 v[128:129], v7 offset:57344
  v_mfma_f32_16x16x32_bf16 v[68:71], v[96:99], a[68:71], v[68:71]
  s_waitcnt lgkmcnt(13)
  ds_read_b64_tr_b16 v[130:131], v7 offset:59392
  buffer_load_dwordx4 a[220:223], v2, s[56:59], s47 offen offset:3072
  v_mfma_f32_16x16x32_bf16 v[72:75], v[100:103], a[64:67], v[72:75]
  ds_read_b64_tr_b16 v[132:133], v8 offset:57344
  v_mfma_f32_16x16x32_bf16 v[76:79], v[100:103], a[68:71], v[76:79]
  s_waitcnt lgkmcnt(13)
  ds_read_b64_tr_b16 v[134:135], v8 offset:59392
  v_mfma_f32_16x16x32_bf16 v[80:83], v[104:107], a[64:67], v[80:83]
  s_add_u32 s44, s61, s13
  s_add_u32 m0, s45, 49152
  s_add_u32 s44, s44, 442368
  ds_read_b64_tr_b16 v[136:137], v9 offset:57344
  buffer_load_dwordx4 v11, s[32:35], s44 offen offset:0 lds
  v_mfma_f32_16x16x32_bf16 v[84:87], v[104:107], a[68:71], v[84:87]
  s_waitcnt lgkmcnt(13)
  ds_read_b64_tr_b16 v[138:139], v9 offset:59392
  v_mfma_f32_16x16x32_bf16 v[88:91], v[108:111], a[64:67], v[88:91]
  ds_read_b64_tr_b16 v[140:141], v10 offset:57344
  v_mfma_f32_16x16x32_bf16 v[92:95], v[108:111], a[68:71], v[92:95]
  s_waitcnt lgkmcnt(13)
  ds_read_b64_tr_b16 v[142:143], v10 offset:59392
  buffer_load_dwordx4 v12, s[32:35], s44 offen offset:1024 lds
  v_mfma_f32_16x16x32_bf16 v[64:67], v[112:115], a[72:75], v[64:67]
  ds_read_b64_tr_b16 v[144:145], v7 offset:61440
  v_mfma_f32_16x16x32_bf16 v[68:71], v[112:115], a[76:79], v[68:71]
  s_waitcnt lgkmcnt(13)
  ds_read_b64_tr_b16 v[146:147], v7 offset:63488
  v_mfma_f32_16x16x32_bf16 v[72:75], v[116:119], a[72:75], v[72:75]
  ds_read_b64_tr_b16 v[148:149], v8 offset:61440
  buffer_load_dwordx4 v13, s[32:35], s44 offen offset:2048 lds
  v_mfma_f32_16x16x32_bf16 v[76:79], v[116:119], a[76:79], v[76:79]
  s_waitcnt lgkmcnt(13)
  ds_read_b64_tr_b16 v[150:151], v8 offset:63488
  v_mfma_f32_16x16x32_bf16 v[80:83], v[120:123], a[72:75], v[80:83]
  ds_read_b64_tr_b16 v[152:153], v9 offset:61440
  v_mfma_f32_16x16x32_bf16 v[84:87], v[120:123], a[76:79], v[84:87]
  s_waitcnt lgkmcnt(13)
  ds_read_b64_tr_b16 v[154:155], v9 offset:63488
  buffer_load_dwordx4 v14, s[32:35], s44 offen offset:3072 lds
  v_mfma_f32_16x16x32_bf16 v[88:91], v[124:127], a[72:75], v[88:91]
  ds_read_b64_tr_b16 v[156:157], v10 offset:61440
  v_mfma_f32_16x16x32_bf16 v[92:95], v[124:127], a[76:79], v[92:95]
  s_waitcnt lgkmcnt(13)
  ds_read_b64_tr_b16 v[158:159], v10 offset:63488
  v_mfma_f32_16x16x32_bf16 v[64:67], v[128:131], a[80:83], v[64:67]
  s_waitcnt vmcnt(28)
  s_barrier
  ds_read_b64_tr_b16 v[96:97], v3 offset:0
  v_mfma_f32_16x16x32_bf16 v[68:71], v[128:131], a[84:87], v[68:71]
  s_waitcnt lgkmcnt(13)
  ds_read_b64_tr_b16 v[98:99], v3 offset:2048
  v_mfma_f32_16x16x32_bf16 v[72:75], v[132:135], a[80:83], v[72:75]
  ds_read_b64_tr_b16 v[100:101], v4 offset:0
  v_mfma_f32_16x16x32_bf16 v[76:79], v[132:135], a[84:87], v[76:79]
  s_waitcnt lgkmcnt(13)
  ds_read_b64_tr_b16 v[102:103], v4 offset:2048
  v_mfma_f32_16x16x32_bf16 v[80:83], v[136:139], a[80:83], v[80:83]
  ds_read_b64_tr_b16 v[104:105], v5 offset:0
  v_mfma_f32_16x16x32_bf16 v[84:87], v[136:139], a[84:87], v[84:87]
  s_waitcnt lgkmcnt(13)
  ds_read_b64_tr_b16 v[106:107], v5 offset:2048
  v_mfma_f32_16x16x32_bf16 v[88:91], v[140:143], a[80:83], v[88:91]
  ds_read_b64_tr_b16 v[108:109], v6 offset:0
  v_mfma_f32_16x16x32_bf16 v[92:95], v[140:143], a[84:87], v[92:95]
  s_waitcnt lgkmcnt(13)
  ds_read_b64_tr_b16 v[110:111], v6 offset:2048
  v_mfma_f32_16x16x32_bf16 v[64:67], v[144:147], a[88:91], v[64:67]
  ds_read_b64_tr_b16 v[112:113], v3 offset:4096
  v_mfma_f32_16x16x32_bf16 v[68:71], v[144:147], a[92:95], v[68:71]
  s_waitcnt lgkmcnt(13)
  ds_read_b64_tr_b16 v[114:115], v3 offset:6144
  v_mfma_f32_16x16x32_bf16 v[72:75], v[148:151], a[88:91], v[72:75]
  ds_read_b64_tr_b16 v[116:117], v4 offset:4096
  v_mfma_f32_16x16x32_bf16 v[76:79], v[148:151], a[92:95], v[76:79]
  s_waitcnt lgkmcnt(13)
  ds_read_b64_tr_b16 v[118:119], v4 offset:6144
  v_mfma_f32_16x16x32_bf16 v[80:83], v[152:155], a[88:91], v[80:83]
  ds_read_b64_tr_b16 v[120:121], v5 offset:4096
  v_mfma_f32_16x16x32_bf16 v[84:87], v[152:155], a[92:95], v[84:87]
  s_waitcnt lgkmcnt(13)
  ds_read_b64_tr_b16 v[122:123], v5 offset:6144
  v_mfma_f32_16x16x32_bf16 v[88:91], v[156:159], a[88:91], v[88:91]
  ds_read_b64_tr_b16 v[124:125], v6 offset:4096
  v_mfma_f32_16x16x32_bf16 v[92:95], v[156:159], a[92:95], v[92:95]
  s_waitcnt vmcnt(27) lgkmcnt(13)
  ds_read_b64_tr_b16 v[126:127], v6 offset:6144
  v_mfma_f32_16x16x32_bf16 v[32:35], v[96:99], a[160:163], v[32:35]
  s_waitcnt vmcnt(26)
  s_add_u32 s44, s60, s13
  s_add_u32 m0, s45, 65536
  s_add_u32 s44, s44, 884736
  ds_read_b64_tr_b16 v[128:129], v3 offset:8192
  buffer_load_dwordx4 v11, s[32:35], s44 offen offset:0 lds
  v_mfma_f32_16x16x32_bf16 v[36:39], v[96:99], a[164:167], v[36:39]
  s_waitcnt lgkmcnt(13)
  ds_read_b64_tr_b16 v[130:131], v3 offset:10240
  v_mfma_f32_16x16x32_bf16 v[40:43], v[100:103], a[160:163], v[40:43]
  ds_read_b64_tr_b16 v[132:133], v4 offset:8192
  v_mfma_f32_16x16x32_bf16 v[44:47], v[100:103], a[164:167], v[44:47]
  s_waitcnt lgkmcnt(13)
  ds_read_b64_tr_b16 v[134:135], v4 offset:10240
  buffer_load_dwordx4 v12, s[32:35], s44 offen offset:1024 lds
  v_mfma_f32_16x16x32_bf16 v[48:51], v[104:107], a[160:163], v[48:51]
  ds_read_b64_tr_b16 v[136:137], v5 offset:8192
  v_mfma_f32_16x16x32_bf16 v[52:55], v[104:107], a[164:167], v[52:55]
  s_waitcnt lgkmcnt(13)
  ds_read_b64_tr_b16 v[138:139], v5 offset:10240
  v_mfma_f32_16x16x32_bf16 v[56:59], v[108:111], a[160:163], v[56:59]
  ds_read_b64_tr_b16 v[140:141], v6 offset:8192
  buffer_load_dwordx4 v13, s[32:35], s44 offen offset:2048 lds
  v_mfma_f32_16x16x32_bf16 v[60:63], v[108:111], a[164:167], v[60:63]
  s_waitcnt vmcnt(28) lgkmcnt(13)
  ds_read_b64_tr_b16 v[142:143], v6 offset:10240
  v_mfma_f32_16x16x32_bf16 v[32:35], v[112:115], a[168:171], v[32:35]
  s_waitcnt vmcnt(27)
  ds_read_b64_tr_b16 v[144:145], v3 offset:12288
  v_mfma_f32_16x16x32_bf16 v[36:39], v[112:115], a[172:175], v[36:39]
  s_waitcnt lgkmcnt(13)
  ds_read_b64_tr_b16 v[146:147], v3 offset:14336
  buffer_load_dwordx4 v14, s[32:35], s44 offen offset:3072 lds
  v_mfma_f32_16x16x32_bf16 v[40:43], v[116:119], a[168:171], v[40:43]
  ds_read_b64_tr_b16 v[148:149], v4 offset:12288
  v_mfma_f32_16x16x32_bf16 v[44:47], v[116:119], a[172:175], v[44:47]
  s_waitcnt lgkmcnt(13)
  ds_read_b64_tr_b16 v[150:151], v4 offset:14336
  v_mfma_f32_16x16x32_bf16 v[48:51], v[120:123], a[168:171], v[48:51]
  s_add_u32 s47, s16, 24576
  ds_read_b64_tr_b16 v[152:153], v5 offset:12288
  buffer_load_dwordx4 a[224:227], v2, s[36:39], s47 offen offset:0
  v_mfma_f32_16x16x32_bf16 v[52:55], v[120:123], a[172:175], v[52:55]
  s_waitcnt lgkmcnt(13)
  ds_read_b64_tr_b16 v[154:155], v5 offset:14336
  v_mfma_f32_16x16x32_bf16 v[56:59], v[124:127], a[168:171], v[56:59]
  ds_read_b64_tr_b16 v[156:157], v6 offset:12288
  v_mfma_f32_16x16x32_bf16 v[60:63], v[124:127], a[172:175], v[60:63]
  s_waitcnt vmcnt(28) lgkmcnt(13)
  ds_read_b64_tr_b16 v[158:159], v6 offset:14336
  buffer_load_dwordx4 a[228:231], v2, s[56:59], s47 offen offset:0
  v_mfma_f32_16x16x32_bf16 v[32:35], v[128:131], a[176:179], v[32:35]
  s_waitcnt vmcnt(22)
  s_barrier
  ds_read_b64_tr_b16 v[96:97], v3 offset:16384
  v_mfma_f32_16x16x32_bf16 v[36:39], v[128:131], a[180:183], v[36:39]
  s_waitcnt lgkmcnt(13)
  ds_read_b64_tr_b16 v[98:99], v3 offset:18432
  v_mfma_f32_16x16x32_bf16 v[40:43], v[132:135], a[176:179], v[40:43]
  ds_read_b64_tr_b16 v[100:101], v4 offset:16384
  buffer_load_dwordx4 a[232:235], v2, s[36:39], s47 offen offset:1024
  v_mfma_f32_16x16x32_bf16 v[44:47], v[132:135], a[180:183], v[44:47]
  s_waitcnt lgkmcnt(13)
  ds_read_b64_tr_b16 v[102:103], v4 offset:18432
  v_mfma_f32_16x16x32_bf16 v[48:51], v[136:139], a[176:179], v[48:51]
  ds_read_b64_tr_b16 v[104:105], v5 offset:16384
  v_mfma_f32_16x16x32_bf16 v[52:55], v[136:139], a[180:183], v[52:55]
  s_waitcnt lgkmcnt(13)
  ds_read_b64_tr_b16 v[106:107], v5 offset:18432
  buffer_load_dwordx4 a[236:239], v2, s[56:59], s47 offen offset:1024
  v_mfma_f32_16x16x32_bf16 v[56:59], v[140:143], a[176:179], v[56:59]
  ds_read_b64_tr_b16 v[108:109], v6 offset:16384
  v_mfma_f32_16x16x32_bf16 v[60:63], v[140:143], a[180:183], v[60:63]
  s_waitcnt lgkmcnt(13)
  ds_read_b64_tr_b16 v[110:111], v6 offset:18432
  v_mfma_f32_16x16x32_bf16 v[32:35], v[144:147], a[184:187], v[32:35]
  ds_read_b64_tr_b16 v[112:113], v3 offset:20480
  buffer_load_dwordx4 a[240:243], v2, s[36:39], s47 offen offset:2048
  v_mfma_f32_16x16x32_bf16 v[36:39], v[144:147], a[188:191], v[36:39]
  s_waitcnt lgkmcnt(13)
  ds_read_b64_tr_b16 v[114:115], v3 offset:22528
  v_mfma_f32_16x16x32_bf16 v[40:43], v[148:151], a[184:187], v[40:43]
  ds_read_b64_tr_b16 v[116:117], v4 offset:20480
  v_mfma_f32_16x16x32_bf16 v[44:47], v[148:151], a[188:191], v[44:47]
  s_waitcnt lgkmcnt(13)
  ds_read_b64_tr_b16 v[118:119], v4 offset:22528
  buffer_load_dwordx4 a[244:247], v2, s[56:59], s47 offen offset:2048
  v_mfma_f32_16x16x32_bf16 v[48:51], v[152:155], a[184:187], v[48:51]
  ds_read_b64_tr_b16 v[120:121], v5 offset:20480
  v_mfma_f32_16x16x32_bf16 v[52:55], v[152:155], a[188:191], v[52:55]
  s_waitcnt lgkmcnt(13)
  ds_read_b64_tr_b16 v[122:123], v5 offset:22528
  v_mfma_f32_16x16x32_bf16 v[56:59], v[156:159], a[184:187], v[56:59]
  ds_read_b64_tr_b16 v[124:125], v6 offset:20480
  buffer_load_dwordx4 a[248:251], v2, s[36:39], s47 offen offset:3072
  v_mfma_f32_16x16x32_bf16 v[60:63], v[156:159], a[188:191], v[60:63]
  s_waitcnt lgkmcnt(13)
  ds_read_b64_tr_b16 v[126:127], v6 offset:22528
  v_mfma_f32_16x16x32_bf16 v[64:67], v[96:99], a[96:99], v[64:67]
  ds_read_b64_tr_b16 v[128:129], v3 offset:24576
  v_mfma_f32_16x16x32_bf16 v[68:71], v[96:99], a[100:103], v[68:71]
  s_waitcnt lgkmcnt(13)
  ds_read_b64_tr_b16 v[130:131], v3 offset:26624
  buffer_load_dwordx4 a[252:255], v2, s[56:59], s47 offen offset:3072
  v_mfma_f32_16x16x32_bf16 v[72:75], v[100:103], a[96:99], v[72:75]
  ds_read_b64_tr_b16 v[132:133], v4 offset:24576
  v_mfma_f32_16x16x32_bf16 v[76:79], v[100:103], a[100:103], v[76:79]
  s_waitcnt lgkmcnt(13)
  ds_read_b64_tr_b16 v[134:135], v4 offset:26624
  v_mfma_f32_16x16x32_bf16 v[80:83], v[104:107], a[96:99], v[80:83]
  s_add_u32 s44, s61, s14
  s_add_u32 m0, s45, 81920
  s_add_u32 s44, s44, 442368
  ds_read_b64_tr_b16 v[136:137], v5 offset:24576
  buffer_load_dwordx4 v11, s[32:35], s44 offen offset:0 lds
  v_mfma_f32_16x16x32_bf16 v[84:87], v[104:107], a[100:103], v[84:87]
  s_waitcnt lgkmcnt(13)
  ds_read_b64_tr_b16 v[138:139], v5 offset:26624
  v_mfma_f32_16x16x32_bf16 v[88:91], v[108:111], a[96:99], v[88:91]
  ds_read_b64_tr_b16 v[140:141], v6 offset:24576
  v_mfma_f32_16x16x32_bf16 v[92:95], v[108:111], a[100:103], v[92:95]
  s_waitcnt lgkmcnt(13)
  ds_read_b64_tr_b16 v[142:143], v6 offset:26624
  buffer_load_dwordx4 v12, s[32:35], s44 offen offset:1024 lds
  v_mfma_f32_16x16x32_bf16 v[64:67], v[112:115], a[104:107], v[64:67]
  ds_read_b64_tr_b16 v[144:145], v3 offset:28672
  v_mfma_f32_16x16x32_bf16 v[68:71], v[112:115], a[108:111], v[68:71]
  s_waitcnt lgkmcnt(13)
  ds_read_b64_tr_b16 v[146:147], v3 offset:30720
  v_mfma_f32_16x16x32_bf16 v[72:75], v[116:119], a[104:107], v[72:75]
  ds_read_b64_tr_b16 v[148:149], v4 offset:28672
  buffer_load_dwordx4 v13, s[32:35], s44 offen offset:2048 lds
  v_mfma_f32_16x16x32_bf16 v[76:79], v[116:119], a[108:111], v[76:79]
  s_waitcnt lgkmcnt(13)
  ds_read_b64_tr_b16 v[150:151], v4 offset:30720
  v_mfma_f32_16x16x32_bf16 v[80:83], v[120:123], a[104:107], v[80:83]
  ds_read_b64_tr_b16 v[152:153], v5 offset:28672
  v_mfma_f32_16x16x32_bf16 v[84:87], v[120:123], a[108:111], v[84:87]
  s_waitcnt lgkmcnt(13)
  ds_read_b64_tr_b16 v[154:155], v5 offset:30720
  buffer_load_dwordx4 v14, s[32:35], s44 offen offset:3072 lds
  v_mfma_f32_16x16x32_bf16 v[88:91], v[124:127], a[104:107], v[88:91]
  ds_read_b64_tr_b16 v[156:157], v6 offset:28672
  v_mfma_f32_16x16x32_bf16 v[92:95], v[124:127], a[108:111], v[92:95]
  s_waitcnt lgkmcnt(13)
  ds_read_b64_tr_b16 v[158:159], v6 offset:30720
  v_mfma_f32_16x16x32_bf16 v[64:67], v[128:131], a[112:115], v[64:67]
  s_waitcnt vmcnt(28)
  s_barrier
  ds_read_b64_tr_b16 v[96:97], v3 offset:32768
  v_mfma_f32_16x16x32_bf16 v[68:71], v[128:131], a[116:119], v[68:71]
  s_waitcnt lgkmcnt(13)
  ds_read_b64_tr_b16 v[98:99], v3 offset:34816
  v_mfma_f32_16x16x32_bf16 v[72:75], v[132:135], a[112:115], v[72:75]
  ds_read_b64_tr_b16 v[100:101], v4 offset:32768
  v_mfma_f32_16x16x32_bf16 v[76:79], v[132:135], a[116:119], v[76:79]
  s_waitcnt lgkmcnt(13)
  ds_read_b64_tr_b16 v[102:103], v4 offset:34816
  v_mfma_f32_16x16x32_bf16 v[80:83], v[136:139], a[112:115], v[80:83]
  ds_read_b64_tr_b16 v[104:105], v5 offset:32768
  v_mfma_f32_16x16x32_bf16 v[84:87], v[136:139], a[116:119], v[84:87]
  s_waitcnt lgkmcnt(13)
  ds_read_b64_tr_b16 v[106:107], v5 offset:34816
  v_mfma_f32_16x16x32_bf16 v[88:91], v[140:143], a[112:115], v[88:91]
  ds_read_b64_tr_b16 v[108:109], v6 offset:32768
  v_mfma_f32_16x16x32_bf16 v[92:95], v[140:143], a[116:119], v[92:95]
  s_waitcnt lgkmcnt(13)
  ds_read_b64_tr_b16 v[110:111], v6 offset:34816
  v_mfma_f32_16x16x32_bf16 v[64:67], v[144:147], a[120:123], v[64:67]
  ds_read_b64_tr_b16 v[112:113], v3 offset:36864
  v_mfma_f32_16x16x32_bf16 v[68:71], v[144:147], a[124:127], v[68:71]
  s_waitcnt lgkmcnt(13)
  ds_read_b64_tr_b16 v[114:115], v3 offset:38912
  v_mfma_f32_16x16x32_bf16 v[72:75], v[148:151], a[120:123], v[72:75]
  ds_read_b64_tr_b16 v[116:117], v4 offset:36864
  v_mfma_f32_16x16x32_bf16 v[76:79], v[148:151], a[124:127], v[76:79]
  s_waitcnt lgkmcnt(13)
  ds_read_b64_tr_b16 v[118:119], v4 offset:38912
  v_mfma_f32_16x16x32_bf16 v[80:83], v[152:155], a[120:123], v[80:83]
  ds_read_b64_tr_b16 v[120:121], v5 offset:36864
  v_mfma_f32_16x16x32_bf16 v[84:87], v[152:155], a[124:127], v[84:87]
  s_waitcnt lgkmcnt(13)
  ds_read_b64_tr_b16 v[122:123], v5 offset:38912
  v_mfma_f32_16x16x32_bf16 v[88:91], v[156:159], a[120:123], v[88:91]
  ds_read_b64_tr_b16 v[124:125], v6 offset:36864
  v_mfma_f32_16x16x32_bf16 v[92:95], v[156:159], a[124:127], v[92:95]
  s_waitcnt vmcnt(27) lgkmcnt(13)
  ds_read_b64_tr_b16 v[126:127], v6 offset:38912
  v_mfma_f32_16x16x32_bf16 v[32:35], v[96:99], a[192:195], v[32:35]
  s_waitcnt vmcnt(26)
  s_add_u32 s44, s60, s14
  s_add_u32 m0, s45, 98304
  s_add_u32 s44, s44, 884736
  ds_read_b64_tr_b16 v[128:129], v3 offset:40960
  buffer_load_dwordx4 v11, s[32:35], s44 offen offset:0 lds
  v_mfma_f32_16x16x32_bf16 v[36:39], v[96:99], a[196:199], v[36:39]
  s_waitcnt lgkmcnt(13)
  ds_read_b64_tr_b16 v[130:131], v3 offset:43008
  v_mfma_f32_16x16x32_bf16 v[40:43], v[100:103], a[192:195], v[40:43]
  ds_read_b64_tr_b16 v[132:133], v4 offset:40960
  v_mfma_f32_16x16x32_bf16 v[44:47], v[100:103], a[196:199], v[44:47]
  s_waitcnt lgkmcnt(13)
  ds_read_b64_tr_b16 v[134:135], v4 offset:43008
  buffer_load_dwordx4 v12, s[32:35], s44 offen offset:1024 lds
  v_mfma_f32_16x16x32_bf16 v[48:51], v[104:107], a[192:195], v[48:51]
  ds_read_b64_tr_b16 v[136:137], v5 offset:40960
  v_mfma_f32_16x16x32_bf16 v[52:55], v[104:107], a[196:199], v[52:55]
  s_waitcnt lgkmcnt(13)
  ds_read_b64_tr_b16 v[138:139], v5 offset:43008
  v_mfma_f32_16x16x32_bf16 v[56:59], v[108:111], a[192:195], v[56:59]
  ds_read_b64_tr_b16 v[140:141], v6 offset:40960
  buffer_load_dwordx4 v13, s[32:35], s44 offen offset:2048 lds
  v_mfma_f32_16x16x32_bf16 v[60:63], v[108:111], a[196:199], v[60:63]
  s_waitcnt vmcnt(28) lgkmcnt(13)
  ds_read_b64_tr_b16 v[142:143], v6 offset:43008
  v_mfma_f32_16x16x32_bf16 v[32:35], v[112:115], a[200:203], v[32:35]
  s_waitcnt vmcnt(27)
  ds_read_b64_tr_b16 v[144:145], v3 offset:45056
  v_mfma_f32_16x16x32_bf16 v[36:39], v[112:115], a[204:207], v[36:39]
  s_waitcnt lgkmcnt(13)
  ds_read_b64_tr_b16 v[146:147], v3 offset:47104
  buffer_load_dwordx4 v14, s[32:35], s44 offen offset:3072 lds
  v_mfma_f32_16x16x32_bf16 v[40:43], v[116:119], a[200:203], v[40:43]
  ds_read_b64_tr_b16 v[148:149], v4 offset:45056
  v_mfma_f32_16x16x32_bf16 v[44:47], v[116:119], a[204:207], v[44:47]
  s_waitcnt lgkmcnt(13)
  ds_read_b64_tr_b16 v[150:151], v4 offset:47104
  v_mfma_f32_16x16x32_bf16 v[48:51], v[120:123], a[200:203], v[48:51]
  s_add_u32 s47, s17, 24576
  ds_read_b64_tr_b16 v[152:153], v5 offset:45056
  buffer_load_dwordx4 v[160:163], v2, s[36:39], s47 offen offset:0
  v_mfma_f32_16x16x32_bf16 v[52:55], v[120:123], a[204:207], v[52:55]
  s_waitcnt lgkmcnt(13)
  ds_read_b64_tr_b16 v[154:155], v5 offset:47104
  v_mfma_f32_16x16x32_bf16 v[56:59], v[124:127], a[200:203], v[56:59]
  ds_read_b64_tr_b16 v[156:157], v6 offset:45056
  v_mfma_f32_16x16x32_bf16 v[60:63], v[124:127], a[204:207], v[60:63]
  s_waitcnt vmcnt(28) lgkmcnt(13)
  ds_read_b64_tr_b16 v[158:159], v6 offset:47104
  buffer_load_dwordx4 v[164:167], v2, s[56:59], s47 offen offset:0
  v_mfma_f32_16x16x32_bf16 v[32:35], v[128:131], a[208:211], v[32:35]
  s_waitcnt vmcnt(22)
  s_barrier
  ds_read_b64_tr_b16 v[96:97], v3 offset:49152
  v_mfma_f32_16x16x32_bf16 v[36:39], v[128:131], a[212:215], v[36:39]
  s_waitcnt lgkmcnt(13)
  ds_read_b64_tr_b16 v[98:99], v3 offset:51200
  v_mfma_f32_16x16x32_bf16 v[40:43], v[132:135], a[208:211], v[40:43]
  ds_read_b64_tr_b16 v[100:101], v4 offset:49152
  buffer_load_dwordx4 v[168:171], v2, s[36:39], s47 offen offset:1024
  v_mfma_f32_16x16x32_bf16 v[44:47], v[132:135], a[212:215], v[44:47]
  s_waitcnt lgkmcnt(13)
  ds_read_b64_tr_b16 v[102:103], v4 offset:51200
  v_mfma_f32_16x16x32_bf16 v[48:51], v[136:139], a[208:211], v[48:51]
  ds_read_b64_tr_b16 v[104:105], v5 offset:49152
  v_mfma_f32_16x16x32_bf16 v[52:55], v[136:139], a[212:215], v[52:55]
  s_waitcnt lgkmcnt(13)
  ds_read_b64_tr_b16 v[106:107], v5 offset:51200
  buffer_load_dwordx4 v[172:175], v2, s[56:59], s47 offen offset:1024
  v_mfma_f32_16x16x32_bf16 v[56:59], v[140:143], a[208:211], v[56:59]
  ds_read_b64_tr_b16 v[108:109], v6 offset:49152
  v_mfma_f32_16x16x32_bf16 v[60:63], v[140:143], a[212:215], v[60:63]
  s_waitcnt lgkmcnt(13)
  ds_read_b64_tr_b16 v[110:111], v6 offset:51200
  v_mfma_f32_16x16x32_bf16 v[32:35], v[144:147], a[216:219], v[32:35]
  ds_read_b64_tr_b16 v[112:113], v3 offset:53248
  buffer_load_dwordx4 v[176:179], v2, s[36:39], s47 offen offset:2048
  v_mfma_f32_16x16x32_bf16 v[36:39], v[144:147], a[220:223], v[36:39]
  s_waitcnt lgkmcnt(13)
  ds_read_b64_tr_b16 v[114:115], v3 offset:55296
  v_mfma_f32_16x16x32_bf16 v[40:43], v[148:151], a[216:219], v[40:43]
  ds_read_b64_tr_b16 v[116:117], v4 offset:53248
  v_mfma_f32_16x16x32_bf16 v[44:47], v[148:151], a[220:223], v[44:47]
  s_waitcnt lgkmcnt(13)
  ds_read_b64_tr_b16 v[118:119], v4 offset:55296
  buffer_load_dwordx4 v[180:183], v2, s[56:59], s47 offen offset:2048
  v_mfma_f32_16x16x32_bf16 v[48:51], v[152:155], a[216:219], v[48:51]
  ds_read_b64_tr_b16 v[120:121], v5 offset:53248
  v_mfma_f32_16x16x32_bf16 v[52:55], v[152:155], a[220:223], v[52:55]
  s_waitcnt lgkmcnt(13)
  ds_read_b64_tr_b16 v[122:123], v5 offset:55296
  v_mfma_f32_16x16x32_bf16 v[56:59], v[156:159], a[216:219], v[56:59]
  ds_read_b64_tr_b16 v[124:125], v6 offset:53248
  buffer_load_dwordx4 v[184:187], v2, s[36:39], s47 offen offset:3072
  v_mfma_f32_16x16x32_bf16 v[60:63], v[156:159], a[220:223], v[60:63]
  s_waitcnt lgkmcnt(13)
  ds_read_b64_tr_b16 v[126:127], v6 offset:55296
  v_mfma_f32_16x16x32_bf16 v[64:67], v[96:99], a[128:131], v[64:67]
  ds_read_b64_tr_b16 v[128:129], v3 offset:57344
  v_mfma_f32_16x16x32_bf16 v[68:71], v[96:99], a[132:135], v[68:71]
  s_waitcnt lgkmcnt(13)
  ds_read_b64_tr_b16 v[130:131], v3 offset:59392
  buffer_load_dwordx4 v[188:191], v2, s[56:59], s47 offen offset:3072
  v_mfma_f32_16x16x32_bf16 v[72:75], v[100:103], a[128:131], v[72:75]
  ds_read_b64_tr_b16 v[132:133], v4 offset:57344
  v_mfma_f32_16x16x32_bf16 v[76:79], v[100:103], a[132:135], v[76:79]
  s_waitcnt lgkmcnt(13)
  ds_read_b64_tr_b16 v[134:135], v4 offset:59392
  v_mfma_f32_16x16x32_bf16 v[80:83], v[104:107], a[128:131], v[80:83]
  s_add_u32 s44, s61, s12
  s_add_u32 m0, s45, 114688
  s_add_u32 s44, s44, 884736
  ds_read_b64_tr_b16 v[136:137], v5 offset:57344
  buffer_load_dwordx4 v11, s[32:35], s44 offen offset:0 lds
  v_mfma_f32_16x16x32_bf16 v[84:87], v[104:107], a[132:135], v[84:87]
  s_waitcnt lgkmcnt(13)
  ds_read_b64_tr_b16 v[138:139], v5 offset:59392
  v_mfma_f32_16x16x32_bf16 v[88:91], v[108:111], a[128:131], v[88:91]
  ds_read_b64_tr_b16 v[140:141], v6 offset:57344
  v_mfma_f32_16x16x32_bf16 v[92:95], v[108:111], a[132:135], v[92:95]
  s_waitcnt lgkmcnt(13)
  ds_read_b64_tr_b16 v[142:143], v6 offset:59392
  buffer_load_dwordx4 v12, s[32:35], s44 offen offset:1024 lds
  v_mfma_f32_16x16x32_bf16 v[64:67], v[112:115], a[136:139], v[64:67]
  ds_read_b64_tr_b16 v[144:145], v3 offset:61440
  v_mfma_f32_16x16x32_bf16 v[68:71], v[112:115], a[140:143], v[68:71]
  s_waitcnt lgkmcnt(13)
  ds_read_b64_tr_b16 v[146:147], v3 offset:63488
  v_mfma_f32_16x16x32_bf16 v[72:75], v[116:119], a[136:139], v[72:75]
  ds_read_b64_tr_b16 v[148:149], v4 offset:61440
  buffer_load_dwordx4 v13, s[32:35], s44 offen offset:2048 lds
  v_mfma_f32_16x16x32_bf16 v[76:79], v[116:119], a[140:143], v[76:79]
  s_waitcnt lgkmcnt(13)
  ds_read_b64_tr_b16 v[150:151], v4 offset:63488
  v_mfma_f32_16x16x32_bf16 v[80:83], v[120:123], a[136:139], v[80:83]
  ds_read_b64_tr_b16 v[152:153], v5 offset:61440
  v_mfma_f32_16x16x32_bf16 v[84:87], v[120:123], a[140:143], v[84:87]
  s_waitcnt lgkmcnt(13)
  ds_read_b64_tr_b16 v[154:155], v5 offset:63488
  buffer_load_dwordx4 v14, s[32:35], s44 offen offset:3072 lds
  v_mfma_f32_16x16x32_bf16 v[88:91], v[124:127], a[136:139], v[88:91]
  ds_read_b64_tr_b16 v[156:157], v6 offset:61440
  v_mfma_f32_16x16x32_bf16 v[92:95], v[124:127], a[140:143], v[92:95]
  s_waitcnt lgkmcnt(13)
  ds_read_b64_tr_b16 v[158:159], v6 offset:63488
  v_mfma_f32_16x16x32_bf16 v[64:67], v[128:131], a[144:147], v[64:67]
  s_waitcnt vmcnt(28)
  s_barrier
  ds_read_b64_tr_b16 v[96:97], v7 offset:0
  v_mfma_f32_16x16x32_bf16 v[68:71], v[128:131], a[148:151], v[68:71]
  s_waitcnt lgkmcnt(13)
  ds_read_b64_tr_b16 v[98:99], v7 offset:2048
  v_mfma_f32_16x16x32_bf16 v[72:75], v[132:135], a[144:147], v[72:75]
  ds_read_b64_tr_b16 v[100:101], v8 offset:0
  v_mfma_f32_16x16x32_bf16 v[76:79], v[132:135], a[148:151], v[76:79]
  s_waitcnt lgkmcnt(13)
  ds_read_b64_tr_b16 v[102:103], v8 offset:2048
  v_mfma_f32_16x16x32_bf16 v[80:83], v[136:139], a[144:147], v[80:83]
  ds_read_b64_tr_b16 v[104:105], v9 offset:0
  v_mfma_f32_16x16x32_bf16 v[84:87], v[136:139], a[148:151], v[84:87]
  s_waitcnt lgkmcnt(13)
  ds_read_b64_tr_b16 v[106:107], v9 offset:2048
  v_mfma_f32_16x16x32_bf16 v[88:91], v[140:143], a[144:147], v[88:91]
  ds_read_b64_tr_b16 v[108:109], v10 offset:0
  v_mfma_f32_16x16x32_bf16 v[92:95], v[140:143], a[148:151], v[92:95]
  s_waitcnt lgkmcnt(13)
  ds_read_b64_tr_b16 v[110:111], v10 offset:2048
  v_mfma_f32_16x16x32_bf16 v[64:67], v[144:147], a[152:155], v[64:67]
  ds_read_b64_tr_b16 v[112:113], v7 offset:4096
  v_mfma_f32_16x16x32_bf16 v[68:71], v[144:147], a[156:159], v[68:71]
  s_waitcnt lgkmcnt(13)
  ds_read_b64_tr_b16 v[114:115], v7 offset:6144
  v_mfma_f32_16x16x32_bf16 v[72:75], v[148:151], a[152:155], v[72:75]
  ds_read_b64_tr_b16 v[116:117], v8 offset:4096
  v_mfma_f32_16x16x32_bf16 v[76:79], v[148:151], a[156:159], v[76:79]
  s_waitcnt lgkmcnt(13)
  ds_read_b64_tr_b16 v[118:119], v8 offset:6144
  v_mfma_f32_16x16x32_bf16 v[80:83], v[152:155], a[152:155], v[80:83]
  ds_read_b64_tr_b16 v[120:121], v9 offset:4096
  v_mfma_f32_16x16x32_bf16 v[84:87], v[152:155], a[156:159], v[84:87]
  s_waitcnt lgkmcnt(13)
  ds_read_b64_tr_b16 v[122:123], v9 offset:6144
  v_mfma_f32_16x16x32_bf16 v[88:91], v[156:159], a[152:155], v[88:91]
  ds_read_b64_tr_b16 v[124:125], v10 offset:4096
  v_mfma_f32_16x16x32_bf16 v[92:95], v[156:159], a[156:159], v[92:95]
  s_waitcnt vmcnt(27) lgkmcnt(13)
  ds_read_b64_tr_b16 v[126:127], v10 offset:6144
  v_mfma_f32_16x16x32_bf16 v[32:35], v[96:99], a[224:227], v[32:35]
  s_waitcnt vmcnt(26)
  s_add_u32 m0, s45, 0
  s_add_u32 s44, s60, 1327104
  ds_read_b64_tr_b16 v[128:129], v7 offset:8192
  buffer_load_dwordx4 v11, s[32:35], s44 offen offset:0 lds
  v_mfma_f32_16x16x32_bf16 v[36:39], v[96:99], a[228:231], v[36:39]
  s_waitcnt lgkmcnt(13)
  ds_read_b64_tr_b16 v[130:131], v7 offset:10240
  v_mfma_f32_16x16x32_bf16 v[40:43], v[100:103], a[224:227], v[40:43]
  ds_read_b64_tr_b16 v[132:133], v8 offset:8192
  v_mfma_f32_16x16x32_bf16 v[44:47], v[100:103], a[228:231], v[44:47]
  s_waitcnt lgkmcnt(13)
  ds_read_b64_tr_b16 v[134:135], v8 offset:10240
  buffer_load_dwordx4 v12, s[32:35], s44 offen offset:1024 lds
  v_mfma_f32_16x16x32_bf16 v[48:51], v[104:107], a[224:227], v[48:51]
  ds_read_b64_tr_b16 v[136:137], v9 offset:8192
  v_mfma_f32_16x16x32_bf16 v[52:55], v[104:107], a[228:231], v[52:55]
  s_waitcnt lgkmcnt(13)
  ds_read_b64_tr_b16 v[138:139], v9 offset:10240
  v_mfma_f32_16x16x32_bf16 v[56:59], v[108:111], a[224:227], v[56:59]
  ds_read_b64_tr_b16 v[140:141], v10 offset:8192
  buffer_load_dwordx4 v13, s[32:35], s44 offen offset:2048 lds
  v_mfma_f32_16x16x32_bf16 v[60:63], v[108:111], a[228:231], v[60:63]
  s_waitcnt vmcnt(28) lgkmcnt(13)
  ds_read_b64_tr_b16 v[142:143], v10 offset:10240
  v_mfma_f32_16x16x32_bf16 v[32:35], v[112:115], a[232:235], v[32:35]
  s_waitcnt vmcnt(27)
  ds_read_b64_tr_b16 v[144:145], v7 offset:12288
  v_mfma_f32_16x16x32_bf16 v[36:39], v[112:115], a[236:239], v[36:39]
  s_waitcnt lgkmcnt(13)
  ds_read_b64_tr_b16 v[146:147], v7 offset:14336
  buffer_load_dwordx4 v14, s[32:35], s44 offen offset:3072 lds
  v_mfma_f32_16x16x32_bf16 v[40:43], v[116:119], a[232:235], v[40:43]
  ds_read_b64_tr_b16 v[148:149], v8 offset:12288
  v_mfma_f32_16x16x32_bf16 v[44:47], v[116:119], a[236:239], v[44:47]
  s_waitcnt lgkmcnt(13)
  ds_read_b64_tr_b16 v[150:151], v8 offset:14336
  v_mfma_f32_16x16x32_bf16 v[48:51], v[120:123], a[232:235], v[48:51]
  s_add_u32 s47, s48, 36864
  ds_read_b64_tr_b16 v[152:153], v9 offset:12288
  buffer_load_dwordx4 v[192:195], v2, s[36:39], s47 offen offset:0
  v_mfma_f32_16x16x32_bf16 v[52:55], v[120:123], a[236:239], v[52:55]
  s_waitcnt lgkmcnt(13)
  ds_read_b64_tr_b16 v[154:155], v9 offset:14336
  v_mfma_f32_16x16x32_bf16 v[56:59], v[124:127], a[232:235], v[56:59]
  ds_read_b64_tr_b16 v[156:157], v10 offset:12288
  v_mfma_f32_16x16x32_bf16 v[60:63], v[124:127], a[236:239], v[60:63]
  s_waitcnt vmcnt(28) lgkmcnt(13)
  ds_read_b64_tr_b16 v[158:159], v10 offset:14336
  buffer_load_dwordx4 v[196:199], v2, s[56:59], s47 offen offset:0
  v_mfma_f32_16x16x32_bf16 v[32:35], v[128:131], a[240:243], v[32:35]
  s_waitcnt vmcnt(22)
  s_barrier
  ds_read_b64_tr_b16 v[96:97], v7 offset:16384
  v_mfma_f32_16x16x32_bf16 v[36:39], v[128:131], a[244:247], v[36:39]
  s_waitcnt lgkmcnt(13)
  ds_read_b64_tr_b16 v[98:99], v7 offset:18432
  v_mfma_f32_16x16x32_bf16 v[40:43], v[132:135], a[240:243], v[40:43]
  ds_read_b64_tr_b16 v[100:101], v8 offset:16384
  buffer_load_dwordx4 v[200:203], v2, s[36:39], s47 offen offset:1024
  v_mfma_f32_16x16x32_bf16 v[44:47], v[132:135], a[244:247], v[44:47]
  s_waitcnt lgkmcnt(13)
  ds_read_b64_tr_b16 v[102:103], v8 offset:18432
  v_mfma_f32_16x16x32_bf16 v[48:51], v[136:139], a[240:243], v[48:51]
  ds_read_b64_tr_b16 v[104:105], v9 offset:16384
  v_mfma_f32_16x16x32_bf16 v[52:55], v[136:139], a[244:247], v[52:55]
  s_waitcnt lgkmcnt(13)
  ds_read_b64_tr_b16 v[106:107], v9 offset:18432
  buffer_load_dwordx4 v[204:207], v2, s[56:59], s47 offen offset:1024
  v_mfma_f32_16x16x32_bf16 v[56:59], v[140:143], a[240:243], v[56:59]
  ds_read_b64_tr_b16 v[108:109], v10 offset:16384
  v_mfma_f32_16x16x32_bf16 v[60:63], v[140:143], a[244:247], v[60:63]
  s_waitcnt lgkmcnt(13)
  ds_read_b64_tr_b16 v[110:111], v10 offset:18432
  v_mfma_f32_16x16x32_bf16 v[32:35], v[144:147], a[248:251], v[32:35]
  ds_read_b64_tr_b16 v[112:113], v7 offset:20480
  buffer_load_dwordx4 v[208:211], v2, s[36:39], s47 offen offset:2048
  v_mfma_f32_16x16x32_bf16 v[36:39], v[144:147], a[252:255], v[36:39]
  s_waitcnt lgkmcnt(13)
  ds_read_b64_tr_b16 v[114:115], v7 offset:22528
  v_mfma_f32_16x16x32_bf16 v[40:43], v[148:151], a[248:251], v[40:43]
  ds_read_b64_tr_b16 v[116:117], v8 offset:20480
  v_mfma_f32_16x16x32_bf16 v[44:47], v[148:151], a[252:255], v[44:47]
  s_waitcnt lgkmcnt(13)
  ds_read_b64_tr_b16 v[118:119], v8 offset:22528
  buffer_load_dwordx4 v[212:215], v2, s[56:59], s47 offen offset:2048
  v_mfma_f32_16x16x32_bf16 v[48:51], v[152:155], a[248:251], v[48:51]
  ds_read_b64_tr_b16 v[120:121], v9 offset:20480
  v_mfma_f32_16x16x32_bf16 v[52:55], v[152:155], a[252:255], v[52:55]
  s_waitcnt lgkmcnt(13)
  ds_read_b64_tr_b16 v[122:123], v9 offset:22528
  v_mfma_f32_16x16x32_bf16 v[56:59], v[156:159], a[248:251], v[56:59]
  ds_read_b64_tr_b16 v[124:125], v10 offset:20480
  buffer_load_dwordx4 v[216:219], v2, s[36:39], s47 offen offset:3072
  v_mfma_f32_16x16x32_bf16 v[60:63], v[156:159], a[252:255], v[60:63]
  s_waitcnt lgkmcnt(13)
  ds_read_b64_tr_b16 v[126:127], v10 offset:22528
  v_mfma_f32_16x16x32_bf16 v[64:67], v[96:99], a[160:163], v[64:67]
  ds_read_b64_tr_b16 v[128:129], v7 offset:24576
  v_mfma_f32_16x16x32_bf16 v[68:71], v[96:99], a[164:167], v[68:71]
  s_waitcnt lgkmcnt(13)
  ds_read_b64_tr_b16 v[130:131], v7 offset:26624
  buffer_load_dwordx4 v[220:223], v2, s[56:59], s47 offen offset:3072
  v_mfma_f32_16x16x32_bf16 v[72:75], v[100:103], a[160:163], v[72:75]
  ds_read_b64_tr_b16 v[132:133], v8 offset:24576
  v_mfma_f32_16x16x32_bf16 v[76:79], v[100:103], a[164:167], v[76:79]
  s_waitcnt lgkmcnt(13)
  ds_read_b64_tr_b16 v[134:135], v8 offset:26624
  v_mfma_f32_16x16x32_bf16 v[80:83], v[104:107], a[160:163], v[80:83]
  s_add_u32 s44, s61, s13
  s_add_u32 m0, s45, 16384
  s_add_u32 s44, s44, 884736
  ds_read_b64_tr_b16 v[136:137], v9 offset:24576
  buffer_load_dwordx4 v11, s[32:35], s44 offen offset:0 lds
  v_mfma_f32_16x16x32_bf16 v[84:87], v[104:107], a[164:167], v[84:87]
  s_waitcnt lgkmcnt(13)
  ds_read_b64_tr_b16 v[138:139], v9 offset:26624
  v_mfma_f32_16x16x32_bf16 v[88:91], v[108:111], a[160:163], v[88:91]
  ds_read_b64_tr_b16 v[140:141], v10 offset:24576
  v_mfma_f32_16x16x32_bf16 v[92:95], v[108:111], a[164:167], v[92:95]
  s_waitcnt lgkmcnt(13)
  ds_read_b64_tr_b16 v[142:143], v10 offset:26624
  buffer_load_dwordx4 v12, s[32:35], s44 offen offset:1024 lds
  v_mfma_f32_16x16x32_bf16 v[64:67], v[112:115], a[168:171], v[64:67]
  ds_read_b64_tr_b16 v[144:145], v7 offset:28672
  v_mfma_f32_16x16x32_bf16 v[68:71], v[112:115], a[172:175], v[68:71]
  s_waitcnt lgkmcnt(13)
  ds_read_b64_tr_b16 v[146:147], v7 offset:30720
  v_mfma_f32_16x16x32_bf16 v[72:75], v[116:119], a[168:171], v[72:75]
  ds_read_b64_tr_b16 v[148:149], v8 offset:28672
  buffer_load_dwordx4 v13, s[32:35], s44 offen offset:2048 lds
  v_mfma_f32_16x16x32_bf16 v[76:79], v[116:119], a[172:175], v[76:79]
  s_waitcnt lgkmcnt(13)
  ds_read_b64_tr_b16 v[150:151], v8 offset:30720
  v_mfma_f32_16x16x32_bf16 v[80:83], v[120:123], a[168:171], v[80:83]
  ds_read_b64_tr_b16 v[152:153], v9 offset:28672
  v_mfma_f32_16x16x32_bf16 v[84:87], v[120:123], a[172:175], v[84:87]
  s_waitcnt lgkmcnt(13)
  ds_read_b64_tr_b16 v[154:155], v9 offset:30720
  buffer_load_dwordx4 v14, s[32:35], s44 offen offset:3072 lds
  v_mfma_f32_16x16x32_bf16 v[88:91], v[124:127], a[168:171], v[88:91]
  ds_read_b64_tr_b16 v[156:157], v10 offset:28672
  v_mfma_f32_16x16x32_bf16 v[92:95], v[124:127], a[172:175], v[92:95]
  s_waitcnt lgkmcnt(13)
  ds_read_b64_tr_b16 v[158:159], v10 offset:30720
  v_mfma_f32_16x16x32_bf16 v[64:67], v[128:131], a[176:179], v[64:67]
  s_waitcnt vmcnt(28)
  s_barrier
  ds_read_b64_tr_b16 v[96:97], v7 offset:32768
  v_mfma_f32_16x16x32_bf16 v[68:71], v[128:131], a[180:183], v[68:71]
  s_waitcnt lgkmcnt(13)
  ds_read_b64_tr_b16 v[98:99], v7 offset:34816
  v_mfma_f32_16x16x32_bf16 v[72:75], v[132:135], a[176:179], v[72:75]
  ds_read_b64_tr_b16 v[100:101], v8 offset:32768
  v_mfma_f32_16x16x32_bf16 v[76:79], v[132:135], a[180:183], v[76:79]
  s_waitcnt lgkmcnt(13)
  ds_read_b64_tr_b16 v[102:103], v8 offset:34816
  v_mfma_f32_16x16x32_bf16 v[80:83], v[136:139], a[176:179], v[80:83]
  ds_read_b64_tr_b16 v[104:105], v9 offset:32768
  v_mfma_f32_16x16x32_bf16 v[84:87], v[136:139], a[180:183], v[84:87]
  s_waitcnt lgkmcnt(13)
  ds_read_b64_tr_b16 v[106:107], v9 offset:34816
  v_mfma_f32_16x16x32_bf16 v[88:91], v[140:143], a[176:179], v[88:91]
  ds_read_b64_tr_b16 v[108:109], v10 offset:32768
  v_mfma_f32_16x16x32_bf16 v[92:95], v[140:143], a[180:183], v[92:95]
  s_waitcnt lgkmcnt(13)
  ds_read_b64_tr_b16 v[110:111], v10 offset:34816
  v_mfma_f32_16x16x32_bf16 v[64:67], v[144:147], a[184:187], v[64:67]
  ds_read_b64_tr_b16 v[112:113], v7 offset:36864
  v_mfma_f32_16x16x32_bf16 v[68:71], v[144:147], a[188:191], v[68:71]
  s_waitcnt lgkmcnt(13)
  ds_read_b64_tr_b16 v[114:115], v7 offset:38912
  v_mfma_f32_16x16x32_bf16 v[72:75], v[148:151], a[184:187], v[72:75]
  ds_read_b64_tr_b16 v[116:117], v8 offset:36864
  v_mfma_f32_16x16x32_bf16 v[76:79], v[148:151], a[188:191], v[76:79]
  s_waitcnt lgkmcnt(13)
  ds_read_b64_tr_b16 v[118:119], v8 offset:38912
  v_mfma_f32_16x16x32_bf16 v[80:83], v[152:155], a[184:187], v[80:83]
  ds_read_b64_tr_b16 v[120:121], v9 offset:36864
  v_mfma_f32_16x16x32_bf16 v[84:87], v[152:155], a[188:191], v[84:87]
  s_waitcnt lgkmcnt(13)
  ds_read_b64_tr_b16 v[122:123], v9 offset:38912
  v_mfma_f32_16x16x32_bf16 v[88:91], v[156:159], a[184:187], v[88:91]
  ds_read_b64_tr_b16 v[124:125], v10 offset:36864
  v_mfma_f32_16x16x32_bf16 v[92:95], v[156:159], a[188:191], v[92:95]
  s_waitcnt vmcnt(27) lgkmcnt(13)
  ds_read_b64_tr_b16 v[126:127], v10 offset:38912
  v_mfma_f32_16x16x32_bf16 v[32:35], v[96:99], v[160:163], v[32:35]
  s_waitcnt vmcnt(26)
  s_add_u32 m0, s45, 32768
  s_add_u32 s44, s60, 1474560
  ds_read_b64_tr_b16 v[128:129], v7 offset:40960
  buffer_load_dwordx4 v11, s[32:35], s44 offen offset:0 lds
  v_mfma_f32_16x16x32_bf16 v[36:39], v[96:99], v[164:167], v[36:39]
  s_waitcnt lgkmcnt(13)
  ds_read_b64_tr_b16 v[130:131], v7 offset:43008
  v_mfma_f32_16x16x32_bf16 v[40:43], v[100:103], v[160:163], v[40:43]
  ds_read_b64_tr_b16 v[132:133], v8 offset:40960
  v_mfma_f32_16x16x32_bf16 v[44:47], v[100:103], v[164:167], v[44:47]
  s_waitcnt lgkmcnt(13)
  ds_read_b64_tr_b16 v[134:135], v8 offset:43008
  buffer_load_dwordx4 v12, s[32:35], s44 offen offset:1024 lds
  v_mfma_f32_16x16x32_bf16 v[48:51], v[104:107], v[160:163], v[48:51]
  ds_read_b64_tr_b16 v[136:137], v9 offset:40960
  v_mfma_f32_16x16x32_bf16 v[52:55], v[104:107], v[164:167], v[52:55]
  s_waitcnt lgkmcnt(13)
  ds_read_b64_tr_b16 v[138:139], v9 offset:43008
  v_mfma_f32_16x16x32_bf16 v[56:59], v[108:111], v[160:163], v[56:59]
  ds_read_b64_tr_b16 v[140:141], v10 offset:40960
  buffer_load_dwordx4 v13, s[32:35], s44 offen offset:2048 lds
  v_mfma_f32_16x16x32_bf16 v[60:63], v[108:111], v[164:167], v[60:63]
  s_waitcnt vmcnt(28) lgkmcnt(13)
  ds_read_b64_tr_b16 v[142:143], v10 offset:43008
  v_mfma_f32_16x16x32_bf16 v[32:35], v[112:115], v[168:171], v[32:35]
  s_waitcnt vmcnt(27)
  ds_read_b64_tr_b16 v[144:145], v7 offset:45056
  v_mfma_f32_16x16x32_bf16 v[36:39], v[112:115], v[172:175], v[36:39]
  s_waitcnt lgkmcnt(13)
  ds_read_b64_tr_b16 v[146:147], v7 offset:47104
  buffer_load_dwordx4 v14, s[32:35], s44 offen offset:3072 lds
  v_mfma_f32_16x16x32_bf16 v[40:43], v[116:119], v[168:171], v[40:43]
  ds_read_b64_tr_b16 v[148:149], v8 offset:45056
  v_mfma_f32_16x16x32_bf16 v[44:47], v[116:119], v[172:175], v[44:47]
  s_waitcnt lgkmcnt(13)
  ds_read_b64_tr_b16 v[150:151], v8 offset:47104
  v_mfma_f32_16x16x32_bf16 v[48:51], v[120:123], v[168:171], v[48:51]
  s_add_u32 s47, s48, 40960
  ds_read_b64_tr_b16 v[152:153], v9 offset:45056
  buffer_load_dwordx4 v[224:227], v2, s[36:39], s47 offen offset:0
  v_mfma_f32_16x16x32_bf16 v[52:55], v[120:123], v[172:175], v[52:55]
  s_waitcnt lgkmcnt(13)
  ds_read_b64_tr_b16 v[154:155], v9 offset:47104
  v_mfma_f32_16x16x32_bf16 v[56:59], v[124:127], v[168:171], v[56:59]
  ds_read_b64_tr_b16 v[156:157], v10 offset:45056
  v_mfma_f32_16x16x32_bf16 v[60:63], v[124:127], v[172:175], v[60:63]
  s_waitcnt vmcnt(28) lgkmcnt(13)
  ds_read_b64_tr_b16 v[158:159], v10 offset:47104
  buffer_load_dwordx4 v[228:231], v2, s[56:59], s47 offen offset:0
  v_mfma_f32_16x16x32_bf16 v[32:35], v[128:131], v[176:179], v[32:35]
  s_waitcnt vmcnt(22)
  s_barrier
  ds_read_b64_tr_b16 v[96:97], v7 offset:49152
  v_mfma_f32_16x16x32_bf16 v[36:39], v[128:131], v[180:183], v[36:39]
  s_waitcnt lgkmcnt(13)
  ds_read_b64_tr_b16 v[98:99], v7 offset:51200
  v_mfma_f32_16x16x32_bf16 v[40:43], v[132:135], v[176:179], v[40:43]
  ds_read_b64_tr_b16 v[100:101], v8 offset:49152
  buffer_load_dwordx4 v[232:235], v2, s[36:39], s47 offen offset:1024
  v_mfma_f32_16x16x32_bf16 v[44:47], v[132:135], v[180:183], v[44:47]
  s_waitcnt lgkmcnt(13)
  ds_read_b64_tr_b16 v[102:103], v8 offset:51200
  v_mfma_f32_16x16x32_bf16 v[48:51], v[136:139], v[176:179], v[48:51]
  ds_read_b64_tr_b16 v[104:105], v9 offset:49152
  v_mfma_f32_16x16x32_bf16 v[52:55], v[136:139], v[180:183], v[52:55]
  s_waitcnt lgkmcnt(13)
  ds_read_b64_tr_b16 v[106:107], v9 offset:51200
  buffer_load_dwordx4 v[236:239], v2, s[56:59], s47 offen offset:1024
  v_mfma_f32_16x16x32_bf16 v[56:59], v[140:143], v[176:179], v[56:59]
  ds_read_b64_tr_b16 v[108:109], v10 offset:49152
  v_mfma_f32_16x16x32_bf16 v[60:63], v[140:143], v[180:183], v[60:63]
  s_waitcnt lgkmcnt(13)
  ds_read_b64_tr_b16 v[110:111], v10 offset:51200
  v_mfma_f32_16x16x32_bf16 v[32:35], v[144:147], v[184:187], v[32:35]
  ds_read_b64_tr_b16 v[112:113], v7 offset:53248
  buffer_load_dwordx4 v[240:243], v2, s[36:39], s47 offen offset:2048
  v_mfma_f32_16x16x32_bf16 v[36:39], v[144:147], v[188:191], v[36:39]
  s_waitcnt lgkmcnt(13)
  ds_read_b64_tr_b16 v[114:115], v7 offset:55296
  v_mfma_f32_16x16x32_bf16 v[40:43], v[148:151], v[184:187], v[40:43]
  ds_read_b64_tr_b16 v[116:117], v8 offset:53248
  v_mfma_f32_16x16x32_bf16 v[44:47], v[148:151], v[188:191], v[44:47]
  s_waitcnt lgkmcnt(13)
  ds_read_b64_tr_b16 v[118:119], v8 offset:55296
  buffer_load_dwordx4 v[244:247], v2, s[56:59], s47 offen offset:2048
  v_mfma_f32_16x16x32_bf16 v[48:51], v[152:155], v[184:187], v[48:51]
  ds_read_b64_tr_b16 v[120:121], v9 offset:53248
  v_mfma_f32_16x16x32_bf16 v[52:55], v[152:155], v[188:191], v[52:55]
  s_waitcnt lgkmcnt(13)
  ds_read_b64_tr_b16 v[122:123], v9 offset:55296
  v_mfma_f32_16x16x32_bf16 v[56:59], v[156:159], v[184:187], v[56:59]
  ds_read_b64_tr_b16 v[124:125], v10 offset:53248
  buffer_load_dwordx4 v[248:251], v2, s[36:39], s47 offen offset:3072
  v_mfma_f32_16x16x32_bf16 v[60:63], v[156:159], v[188:191], v[60:63]
  s_waitcnt lgkmcnt(13)
  ds_read_b64_tr_b16 v[126:127], v10 offset:55296
  v_mfma_f32_16x16x32_bf16 v[64:67], v[96:99], a[192:195], v[64:67]
  ds_read_b64_tr_b16 v[128:129], v7 offset:57344
  v_mfma_f32_16x16x32_bf16 v[68:71], v[96:99], a[196:199], v[68:71]
  s_waitcnt lgkmcnt(13)
  ds_read_b64_tr_b16 v[130:131], v7 offset:59392
  buffer_load_dwordx4 v[252:255], v2, s[56:59], s47 offen offset:3072
  v_mfma_f32_16x16x32_bf16 v[72:75], v[100:103], a[192:195], v[72:75]
  ds_read_b64_tr_b16 v[132:133], v8 offset:57344
  v_mfma_f32_16x16x32_bf16 v[76:79], v[100:103], a[196:199], v[76:79]
  s_waitcnt lgkmcnt(13)
  ds_read_b64_tr_b16 v[134:135], v8 offset:59392
  v_mfma_f32_16x16x32_bf16 v[80:83], v[104:107], a[192:195], v[80:83]
  s_add_u32 s44, s61, s14
  s_add_u32 m0, s45, 49152
  s_add_u32 s44, s44, 884736
  ds_read_b64_tr_b16 v[136:137], v9 offset:57344
  buffer_load_dwordx4 v11, s[32:35], s44 offen offset:0 lds
  v_mfma_f32_16x16x32_bf16 v[84:87], v[104:107], a[196:199], v[84:87]
  s_waitcnt lgkmcnt(13)
  ds_read_b64_tr_b16 v[138:139], v9 offset:59392
  v_mfma_f32_16x16x32_bf16 v[88:91], v[108:111], a[192:195], v[88:91]
  ds_read_b64_tr_b16 v[140:141], v10 offset:57344
  v_mfma_f32_16x16x32_bf16 v[92:95], v[108:111], a[196:199], v[92:95]
  s_waitcnt lgkmcnt(13)
  ds_read_b64_tr_b16 v[142:143], v10 offset:59392
  buffer_load_dwordx4 v12, s[32:35], s44 offen offset:1024 lds
  v_mfma_f32_16x16x32_bf16 v[64:67], v[112:115], a[200:203], v[64:67]
  ds_read_b64_tr_b16 v[144:145], v7 offset:61440
  v_mfma_f32_16x16x32_bf16 v[68:71], v[112:115], a[204:207], v[68:71]
  s_waitcnt lgkmcnt(13)
  ds_read_b64_tr_b16 v[146:147], v7 offset:63488
  v_mfma_f32_16x16x32_bf16 v[72:75], v[116:119], a[200:203], v[72:75]
  ds_read_b64_tr_b16 v[148:149], v8 offset:61440
  buffer_load_dwordx4 v13, s[32:35], s44 offen offset:2048 lds
  v_mfma_f32_16x16x32_bf16 v[76:79], v[116:119], a[204:207], v[76:79]
  s_waitcnt lgkmcnt(13)
  ds_read_b64_tr_b16 v[150:151], v8 offset:63488
  v_mfma_f32_16x16x32_bf16 v[80:83], v[120:123], a[200:203], v[80:83]
  ds_read_b64_tr_b16 v[152:153], v9 offset:61440
  v_mfma_f32_16x16x32_bf16 v[84:87], v[120:123], a[204:207], v[84:87]
  s_waitcnt lgkmcnt(13)
  ds_read_b64_tr_b16 v[154:155], v9 offset:63488
  buffer_load_dwordx4 v14, s[32:35], s44 offen offset:3072 lds
  v_mfma_f32_16x16x32_bf16 v[88:91], v[124:127], a[200:203], v[88:91]
  ds_read_b64_tr_b16 v[156:157], v10 offset:61440
  v_mfma_f32_16x16x32_bf16 v[92:95], v[124:127], a[204:207], v[92:95]
  s_waitcnt lgkmcnt(13)
  ds_read_b64_tr_b16 v[158:159], v10 offset:63488
  v_mfma_f32_16x16x32_bf16 v[64:67], v[128:131], a[208:211], v[64:67]
  s_waitcnt vmcnt(28)
  s_barrier
  ds_read_b64_tr_b16 v[96:97], v3 offset:0
  v_mfma_f32_16x16x32_bf16 v[68:71], v[128:131], a[212:215], v[68:71]
  s_waitcnt lgkmcnt(13)
  ds_read_b64_tr_b16 v[98:99], v3 offset:2048
  v_mfma_f32_16x16x32_bf16 v[72:75], v[132:135], a[208:211], v[72:75]
  ds_read_b64_tr_b16 v[100:101], v4 offset:0
  v_mfma_f32_16x16x32_bf16 v[76:79], v[132:135], a[212:215], v[76:79]
  s_waitcnt lgkmcnt(13)
  ds_read_b64_tr_b16 v[102:103], v4 offset:2048
  v_mfma_f32_16x16x32_bf16 v[80:83], v[136:139], a[208:211], v[80:83]
  ds_read_b64_tr_b16 v[104:105], v5 offset:0
  v_mfma_f32_16x16x32_bf16 v[84:87], v[136:139], a[212:215], v[84:87]
  s_waitcnt lgkmcnt(13)
  ds_read_b64_tr_b16 v[106:107], v5 offset:2048
  v_mfma_f32_16x16x32_bf16 v[88:91], v[140:143], a[208:211], v[88:91]
  ds_read_b64_tr_b16 v[108:109], v6 offset:0
  v_mfma_f32_16x16x32_bf16 v[92:95], v[140:143], a[212:215], v[92:95]
  s_waitcnt lgkmcnt(13)
  ds_read_b64_tr_b16 v[110:111], v6 offset:2048
  v_mfma_f32_16x16x32_bf16 v[64:67], v[144:147], a[216:219], v[64:67]
  ds_read_b64_tr_b16 v[112:113], v3 offset:4096
  v_mfma_f32_16x16x32_bf16 v[68:71], v[144:147], a[220:223], v[68:71]
  s_waitcnt lgkmcnt(13)
  ds_read_b64_tr_b16 v[114:115], v3 offset:6144
  v_mfma_f32_16x16x32_bf16 v[72:75], v[148:151], a[216:219], v[72:75]
  ds_read_b64_tr_b16 v[116:117], v4 offset:4096
  v_mfma_f32_16x16x32_bf16 v[76:79], v[148:151], a[220:223], v[76:79]
  s_waitcnt lgkmcnt(13)
  ds_read_b64_tr_b16 v[118:119], v4 offset:6144
  v_mfma_f32_16x16x32_bf16 v[80:83], v[152:155], a[216:219], v[80:83]
  ds_read_b64_tr_b16 v[120:121], v5 offset:4096
  v_mfma_f32_16x16x32_bf16 v[84:87], v[152:155], a[220:223], v[84:87]
  s_waitcnt lgkmcnt(13)
  ds_read_b64_tr_b16 v[122:123], v5 offset:6144
  v_mfma_f32_16x16x32_bf16 v[88:91], v[156:159], a[216:219], v[88:91]
  ds_read_b64_tr_b16 v[124:125], v6 offset:4096
  v_mfma_f32_16x16x32_bf16 v[92:95], v[156:159], a[220:223], v[92:95]
  s_waitcnt vmcnt(27) lgkmcnt(13)
  ds_read_b64_tr_b16 v[126:127], v6 offset:6144
  v_mfma_f32_16x16x32_bf16 v[32:35], v[96:99], v[192:195], v[32:35]
  s_waitcnt vmcnt(26)
  s_add_u32 m0, s45, 65536
  s_add_u32 s44, s61, 1327104
  ds_read_b64_tr_b16 v[128:129], v3 offset:8192
  buffer_load_dwordx4 v11, s[32:35], s44 offen offset:0 lds
  v_mfma_f32_16x16x32_bf16 v[36:39], v[96:99], v[196:199], v[36:39]
  s_waitcnt lgkmcnt(13)
  ds_read_b64_tr_b16 v[130:131], v3 offset:10240
  v_mfma_f32_16x16x32_bf16 v[40:43], v[100:103], v[192:195], v[40:43]
  ds_read_b64_tr_b16 v[132:133], v4 offset:8192
  v_mfma_f32_16x16x32_bf16 v[44:47], v[100:103], v[196:199], v[44:47]
  s_waitcnt lgkmcnt(13)
  ds_read_b64_tr_b16 v[134:135], v4 offset:10240
  buffer_load_dwordx4 v12, s[32:35], s44 offen offset:1024 lds
  v_mfma_f32_16x16x32_bf16 v[48:51], v[104:107], v[192:195], v[48:51]
  ds_read_b64_tr_b16 v[136:137], v5 offset:8192
  v_mfma_f32_16x16x32_bf16 v[52:55], v[104:107], v[196:199], v[52:55]
  s_waitcnt lgkmcnt(13)
  ds_read_b64_tr_b16 v[138:139], v5 offset:10240
  v_mfma_f32_16x16x32_bf16 v[56:59], v[108:111], v[192:195], v[56:59]
  ds_read_b64_tr_b16 v[140:141], v6 offset:8192
  buffer_load_dwordx4 v13, s[32:35], s44 offen offset:2048 lds
  v_mfma_f32_16x16x32_bf16 v[60:63], v[108:111], v[196:199], v[60:63]
  s_waitcnt vmcnt(28) lgkmcnt(13)
  ds_read_b64_tr_b16 v[142:143], v6 offset:10240
  v_mfma_f32_16x16x32_bf16 v[32:35], v[112:115], v[200:203], v[32:35]
  s_waitcnt vmcnt(27)
  ds_read_b64_tr_b16 v[144:145], v3 offset:12288
  v_mfma_f32_16x16x32_bf16 v[36:39], v[112:115], v[204:207], v[36:39]
  s_waitcnt lgkmcnt(13)
  ds_read_b64_tr_b16 v[146:147], v3 offset:14336
  buffer_load_dwordx4 v14, s[32:35], s44 offen offset:3072 lds
  v_mfma_f32_16x16x32_bf16 v[40:43], v[116:119], v[200:203], v[40:43]
  ds_read_b64_tr_b16 v[148:149], v4 offset:12288
  v_mfma_f32_16x16x32_bf16 v[44:47], v[116:119], v[204:207], v[44:47]
  s_waitcnt lgkmcnt(13)
  ds_read_b64_tr_b16 v[150:151], v4 offset:14336
  v_mfma_f32_16x16x32_bf16 v[48:51], v[120:123], v[200:203], v[48:51]
  ds_read_b64_tr_b16 v[152:153], v5 offset:12288
  v_mfma_f32_16x16x32_bf16 v[52:55], v[120:123], v[204:207], v[52:55]
  s_waitcnt lgkmcnt(13)
  ds_read_b64_tr_b16 v[154:155], v5 offset:14336
  v_mfma_f32_16x16x32_bf16 v[56:59], v[124:127], v[200:203], v[56:59]
  ds_read_b64_tr_b16 v[156:157], v6 offset:12288
  v_mfma_f32_16x16x32_bf16 v[60:63], v[124:127], v[204:207], v[60:63]
  s_waitcnt vmcnt(27) lgkmcnt(13)
  ds_read_b64_tr_b16 v[158:159], v6 offset:14336
  v_mfma_f32_16x16x32_bf16 v[32:35], v[128:131], v[208:211], v[32:35]
  s_waitcnt vmcnt(20)
  s_barrier
  ds_read_b64_tr_b16 v[96:97], v3 offset:16384
  v_mfma_f32_16x16x32_bf16 v[36:39], v[128:131], v[212:215], v[36:39]
  s_waitcnt lgkmcnt(13)
  ds_read_b64_tr_b16 v[98:99], v3 offset:18432
  v_mfma_f32_16x16x32_bf16 v[40:43], v[132:135], v[208:211], v[40:43]
  ds_read_b64_tr_b16 v[100:101], v4 offset:16384
  v_mfma_f32_16x16x32_bf16 v[44:47], v[132:135], v[212:215], v[44:47]
  s_waitcnt lgkmcnt(13)
  ds_read_b64_tr_b16 v[102:103], v4 offset:18432
  v_mfma_f32_16x16x32_bf16 v[48:51], v[136:139], v[208:211], v[48:51]
  ds_read_b64_tr_b16 v[104:105], v5 offset:16384
  v_mfma_f32_16x16x32_bf16 v[52:55], v[136:139], v[212:215], v[52:55]
  s_waitcnt lgkmcnt(13)
  ds_read_b64_tr_b16 v[106:107], v5 offset:18432
  v_mfma_f32_16x16x32_bf16 v[56:59], v[140:143], v[208:211], v[56:59]
  ds_read_b64_tr_b16 v[108:109], v6 offset:16384
  v_mfma_f32_16x16x32_bf16 v[60:63], v[140:143], v[212:215], v[60:63]
  s_waitcnt lgkmcnt(13)
  ds_read_b64_tr_b16 v[110:111], v6 offset:18432
  v_mfma_f32_16x16x32_bf16 v[32:35], v[144:147], v[216:219], v[32:35]
  ds_read_b64_tr_b16 v[112:113], v3 offset:20480
  v_mfma_f32_16x16x32_bf16 v[36:39], v[144:147], v[220:223], v[36:39]
  s_waitcnt lgkmcnt(13)
  ds_read_b64_tr_b16 v[114:115], v3 offset:22528
  v_mfma_f32_16x16x32_bf16 v[40:43], v[148:151], v[216:219], v[40:43]
  ds_read_b64_tr_b16 v[116:117], v4 offset:20480
  v_mfma_f32_16x16x32_bf16 v[44:47], v[148:151], v[220:223], v[44:47]
  s_waitcnt lgkmcnt(13)
  ds_read_b64_tr_b16 v[118:119], v4 offset:22528
  v_mfma_f32_16x16x32_bf16 v[48:51], v[152:155], v[216:219], v[48:51]
  ds_read_b64_tr_b16 v[120:121], v5 offset:20480
  v_mfma_f32_16x16x32_bf16 v[52:55], v[152:155], v[220:223], v[52:55]
  s_waitcnt lgkmcnt(13)
  ds_read_b64_tr_b16 v[122:123], v5 offset:22528
  v_mfma_f32_16x16x32_bf16 v[56:59], v[156:159], v[216:219], v[56:59]
  ds_read_b64_tr_b16 v[124:125], v6 offset:20480
  v_mfma_f32_16x16x32_bf16 v[60:63], v[156:159], v[220:223], v[60:63]
  s_waitcnt lgkmcnt(13)
  ds_read_b64_tr_b16 v[126:127], v6 offset:22528
  v_mfma_f32_16x16x32_bf16 v[64:67], v[96:99], a[224:227], v[64:67]
  s_add_u32 m0, s45, 81920
  s_add_u32 s44, s61, 1474560
  ds_read_b64_tr_b16 v[128:129], v3 offset:24576
  buffer_load_dwordx4 v11, s[32:35], s44 offen offset:0 lds
  v_mfma_f32_16x16x32_bf16 v[68:71], v[96:99], a[228:231], v[68:71]
  s_waitcnt lgkmcnt(13)
  ds_read_b64_tr_b16 v[130:131], v3 offset:26624
  v_mfma_f32_16x16x32_bf16 v[72:75], v[100:103], a[224:227], v[72:75]
  ds_read_b64_tr_b16 v[132:133], v4 offset:24576
  v_mfma_f32_16x16x32_bf16 v[76:79], v[100:103], a[228:231], v[76:79]
  s_waitcnt lgkmcnt(13)
  ds_read_b64_tr_b16 v[134:135], v4 offset:26624
  buffer_load_dwordx4 v12, s[32:35], s44 offen offset:1024 lds
  v_mfma_f32_16x16x32_bf16 v[80:83], v[104:107], a[224:227], v[80:83]
  ds_read_b64_tr_b16 v[136:137], v5 offset:24576
  v_mfma_f32_16x16x32_bf16 v[84:87], v[104:107], a[228:231], v[84:87]
  s_waitcnt lgkmcnt(13)
  ds_read_b64_tr_b16 v[138:139], v5 offset:26624
  v_mfma_f32_16x16x32_bf16 v[88:91], v[108:111], a[224:227], v[88:91]
  ds_read_b64_tr_b16 v[140:141], v6 offset:24576
  buffer_load_dwordx4 v13, s[32:35], s44 offen offset:2048 lds
  v_mfma_f32_16x16x32_bf16 v[92:95], v[108:111], a[228:231], v[92:95]
  s_waitcnt lgkmcnt(13)
  ds_read_b64_tr_b16 v[142:143], v6 offset:26624
  v_mfma_f32_16x16x32_bf16 v[64:67], v[112:115], a[232:235], v[64:67]
  ds_read_b64_tr_b16 v[144:145], v3 offset:28672
  v_mfma_f32_16x16x32_bf16 v[68:71], v[112:115], a[236:239], v[68:71]
  s_waitcnt lgkmcnt(13)
  ds_read_b64_tr_b16 v[146:147], v3 offset:30720
  buffer_load_dwordx4 v14, s[32:35], s44 offen offset:3072 lds
  v_mfma_f32_16x16x32_bf16 v[72:75], v[116:119], a[232:235], v[72:75]
  ds_read_b64_tr_b16 v[148:149], v4 offset:28672
  v_mfma_f32_16x16x32_bf16 v[76:79], v[116:119], a[236:239], v[76:79]
  s_waitcnt lgkmcnt(13)
  ds_read_b64_tr_b16 v[150:151], v4 offset:30720
  v_mfma_f32_16x16x32_bf16 v[80:83], v[120:123], a[232:235], v[80:83]
  ds_read_b64_tr_b16 v[152:153], v5 offset:28672
  v_mfma_f32_16x16x32_bf16 v[84:87], v[120:123], a[236:239], v[84:87]
  s_waitcnt lgkmcnt(13)
  ds_read_b64_tr_b16 v[154:155], v5 offset:30720
  v_mfma_f32_16x16x32_bf16 v[88:91], v[124:127], a[232:235], v[88:91]
  ds_read_b64_tr_b16 v[156:157], v6 offset:28672
  v_mfma_f32_16x16x32_bf16 v[92:95], v[124:127], a[236:239], v[92:95]
  s_waitcnt lgkmcnt(13)
  ds_read_b64_tr_b16 v[158:159], v6 offset:30720
  v_mfma_f32_16x16x32_bf16 v[64:67], v[128:131], a[240:243], v[64:67]
  s_waitcnt vmcnt(20)
  s_barrier
  ds_read_b64_tr_b16 v[96:97], v3 offset:32768
  v_mfma_f32_16x16x32_bf16 v[68:71], v[128:131], a[244:247], v[68:71]
  s_waitcnt lgkmcnt(13)
  ds_read_b64_tr_b16 v[98:99], v3 offset:34816
  v_mfma_f32_16x16x32_bf16 v[72:75], v[132:135], a[240:243], v[72:75]
  ds_read_b64_tr_b16 v[100:101], v4 offset:32768
  v_mfma_f32_16x16x32_bf16 v[76:79], v[132:135], a[244:247], v[76:79]
  s_waitcnt lgkmcnt(13)
  ds_read_b64_tr_b16 v[102:103], v4 offset:34816
  v_mfma_f32_16x16x32_bf16 v[80:83], v[136:139], a[240:243], v[80:83]
  ds_read_b64_tr_b16 v[104:105], v5 offset:32768
  v_mfma_f32_16x16x32_bf16 v[84:87], v[136:139], a[244:247], v[84:87]
  s_waitcnt lgkmcnt(13)
  ds_read_b64_tr_b16 v[106:107], v5 offset:34816
  v_mfma_f32_16x16x32_bf16 v[88:91], v[140:143], a[240:243], v[88:91]
  ds_read_b64_tr_b16 v[108:109], v6 offset:32768
  v_mfma_f32_16x16x32_bf16 v[92:95], v[140:143], a[244:247], v[92:95]
  s_waitcnt lgkmcnt(13)
  ds_read_b64_tr_b16 v[110:111], v6 offset:34816
  v_mfma_f32_16x16x32_bf16 v[64:67], v[144:147], a[248:251], v[64:67]
  ds_read_b64_tr_b16 v[112:113], v3 offset:36864
  v_mfma_f32_16x16x32_bf16 v[68:71], v[144:147], a[252:255], v[68:71]
  s_waitcnt lgkmcnt(13)
  ds_read_b64_tr_b16 v[114:115], v3 offset:38912
  v_mfma_f32_16x16x32_bf16 v[72:75], v[148:151], a[248:251], v[72:75]
  ds_read_b64_tr_b16 v[116:117], v4 offset:36864
  v_mfma_f32_16x16x32_bf16 v[76:79], v[148:151], a[252:255], v[76:79]
  s_waitcnt lgkmcnt(13)
  ds_read_b64_tr_b16 v[118:119], v4 offset:38912
  v_mfma_f32_16x16x32_bf16 v[80:83], v[152:155], a[248:251], v[80:83]
  ds_read_b64_tr_b16 v[120:121], v5 offset:36864
  v_mfma_f32_16x16x32_bf16 v[84:87], v[152:155], a[252:255], v[84:87]
  s_waitcnt lgkmcnt(13)
  ds_read_b64_tr_b16 v[122:123], v5 offset:38912
  v_mfma_f32_16x16x32_bf16 v[88:91], v[156:159], a[248:251], v[88:91]
  ds_read_b64_tr_b16 v[124:125], v6 offset:36864
  v_mfma_f32_16x16x32_bf16 v[92:95], v[156:159], a[252:255], v[92:95]
  s_waitcnt vmcnt(19) lgkmcnt(13)
  ds_read_b64_tr_b16 v[126:127], v6 offset:38912
  v_mfma_f32_16x16x32_bf16 v[32:35], v[96:99], v[224:227], v[32:35]
  s_waitcnt vmcnt(18)
  s_add_u32 s44, s62, s12
  s_add_u32 m0, s45, 98304
  s_add_u32 s44, s44, 0
  ds_read_b64_tr_b16 v[128:129], v3 offset:40960
  buffer_load_dwordx4 v11, s[32:35], s44 offen offset:0 lds
  v_mfma_f32_16x16x32_bf16 v[36:39], v[96:99], v[228:231], v[36:39]
  s_waitcnt lgkmcnt(13)
  ds_read_b64_tr_b16 v[130:131], v3 offset:43008
  v_mfma_f32_16x16x32_bf16 v[40:43], v[100:103], v[224:227], v[40:43]
  ds_read_b64_tr_b16 v[132:133], v4 offset:40960
  v_mfma_f32_16x16x32_bf16 v[44:47], v[100:103], v[228:231], v[44:47]
  s_waitcnt lgkmcnt(13)
  ds_read_b64_tr_b16 v[134:135], v4 offset:43008
  buffer_load_dwordx4 v12, s[32:35], s44 offen offset:1024 lds
  v_mfma_f32_16x16x32_bf16 v[48:51], v[104:107], v[224:227], v[48:51]
  ds_read_b64_tr_b16 v[136:137], v5 offset:40960
  v_mfma_f32_16x16x32_bf16 v[52:55], v[104:107], v[228:231], v[52:55]
  s_waitcnt lgkmcnt(13)
  ds_read_b64_tr_b16 v[138:139], v5 offset:43008
  v_mfma_f32_16x16x32_bf16 v[56:59], v[108:111], v[224:227], v[56:59]
  ds_read_b64_tr_b16 v[140:141], v6 offset:40960
  buffer_load_dwordx4 v13, s[32:35], s44 offen offset:2048 lds
  v_mfma_f32_16x16x32_bf16 v[60:63], v[108:111], v[228:231], v[60:63]
  s_waitcnt vmcnt(20) lgkmcnt(13)
  ds_read_b64_tr_b16 v[142:143], v6 offset:43008
  v_mfma_f32_16x16x32_bf16 v[32:35], v[112:115], v[232:235], v[32:35]
  s_waitcnt vmcnt(19)
  ds_read_b64_tr_b16 v[144:145], v3 offset:45056
  v_mfma_f32_16x16x32_bf16 v[36:39], v[112:115], v[236:239], v[36:39]
  s_waitcnt lgkmcnt(13)
  ds_read_b64_tr_b16 v[146:147], v3 offset:47104
  buffer_load_dwordx4 v14, s[32:35], s44 offen offset:3072 lds
  v_mfma_f32_16x16x32_bf16 v[40:43], v[116:119], v[232:235], v[40:43]
  ds_read_b64_tr_b16 v[148:149], v4 offset:45056
  v_mfma_f32_16x16x32_bf16 v[44:47], v[116:119], v[236:239], v[44:47]
  s_waitcnt lgkmcnt(13)
  ds_read_b64_tr_b16 v[150:151], v4 offset:47104
  v_mfma_f32_16x16x32_bf16 v[48:51], v[120:123], v[232:235], v[48:51]
  ds_read_b64_tr_b16 v[152:153], v5 offset:45056
  v_mfma_f32_16x16x32_bf16 v[52:55], v[120:123], v[236:239], v[52:55]
  s_waitcnt lgkmcnt(13)
  ds_read_b64_tr_b16 v[154:155], v5 offset:47104
  v_mfma_f32_16x16x32_bf16 v[56:59], v[124:127], v[232:235], v[56:59]
  ds_read_b64_tr_b16 v[156:157], v6 offset:45056
  v_mfma_f32_16x16x32_bf16 v[60:63], v[124:127], v[236:239], v[60:63]
  s_waitcnt vmcnt(19) lgkmcnt(13)
  ds_read_b64_tr_b16 v[158:159], v6 offset:47104
  v_mfma_f32_16x16x32_bf16 v[32:35], v[128:131], v[240:243], v[32:35]
  s_waitcnt vmcnt(12)
  s_barrier
  ds_read_b64_tr_b16 v[96:97], v3 offset:49152
  v_mfma_f32_16x16x32_bf16 v[36:39], v[128:131], v[244:247], v[36:39]
  s_waitcnt lgkmcnt(13)
  ds_read_b64_tr_b16 v[98:99], v3 offset:51200
  v_mfma_f32_16x16x32_bf16 v[40:43], v[132:135], v[240:243], v[40:43]
  ds_read_b64_tr_b16 v[100:101], v4 offset:49152
  v_mfma_f32_16x16x32_bf16 v[44:47], v[132:135], v[244:247], v[44:47]
  s_waitcnt lgkmcnt(13)
  ds_read_b64_tr_b16 v[102:103], v4 offset:51200
  v_mfma_f32_16x16x32_bf16 v[48:51], v[136:139], v[240:243], v[48:51]
  ds_read_b64_tr_b16 v[104:105], v5 offset:49152
  v_mfma_f32_16x16x32_bf16 v[52:55], v[136:139], v[244:247], v[52:55]
  s_waitcnt lgkmcnt(13)
  ds_read_b64_tr_b16 v[106:107], v5 offset:51200
  v_mfma_f32_16x16x32_bf16 v[56:59], v[140:143], v[240:243], v[56:59]
  ds_read_b64_tr_b16 v[108:109], v6 offset:49152
  v_mfma_f32_16x16x32_bf16 v[60:63], v[140:143], v[244:247], v[60:63]
  s_waitcnt lgkmcnt(13)
  ds_read_b64_tr_b16 v[110:111], v6 offset:51200
  v_mfma_f32_16x16x32_bf16 v[32:35], v[144:147], v[248:251], v[32:35]
  ds_read_b64_tr_b16 v[112:113], v3 offset:53248
  v_mfma_f32_16x16x32_bf16 v[36:39], v[144:147], v[252:255], v[36:39]
  s_waitcnt lgkmcnt(13)
  ds_read_b64_tr_b16 v[114:115], v3 offset:55296
  v_mfma_f32_16x16x32_bf16 v[40:43], v[148:151], v[248:251], v[40:43]
  ds_read_b64_tr_b16 v[116:117], v4 offset:53248
  v_mfma_f32_16x16x32_bf16 v[44:47], v[148:151], v[252:255], v[44:47]
  s_waitcnt lgkmcnt(13)
  ds_read_b64_tr_b16 v[118:119], v4 offset:55296
  v_mfma_f32_16x16x32_bf16 v[48:51], v[152:155], v[248:251], v[48:51]
  ds_read_b64_tr_b16 v[120:121], v5 offset:53248
  v_mfma_f32_16x16x32_bf16 v[52:55], v[152:155], v[252:255], v[52:55]
  s_waitcnt lgkmcnt(13)
  ds_read_b64_tr_b16 v[122:123], v5 offset:55296
  v_mfma_f32_16x16x32_bf16 v[56:59], v[156:159], v[248:251], v[56:59]
  ds_read_b64_tr_b16 v[124:125], v6 offset:53248
  v_mfma_f32_16x16x32_bf16 v[60:63], v[156:159], v[252:255], v[60:63]
  s_waitcnt lgkmcnt(13)
  ds_read_b64_tr_b16 v[126:127], v6 offset:55296
  v_mfma_f32_16x16x32_bf16 v[64:67], v[96:99], v[160:163], v[64:67]
  s_add_u32 s44, s62, s13
  s_add_u32 m0, s45, 114688
  s_add_u32 s44, s44, 0
  ds_read_b64_tr_b16 v[128:129], v3 offset:57344
  buffer_load_dwordx4 v11, s[32:35], s44 offen offset:0 lds
  v_mfma_f32_16x16x32_bf16 v[68:71], v[96:99], v[164:167], v[68:71]
  s_waitcnt lgkmcnt(13)
  ds_read_b64_tr_b16 v[130:131], v3 offset:59392
  v_mfma_f32_16x16x32_bf16 v[72:75], v[100:103], v[160:163], v[72:75]
  ds_read_b64_tr_b16 v[132:133], v4 offset:57344
  v_mfma_f32_16x16x32_bf16 v[76:79], v[100:103], v[164:167], v[76:79]
  s_waitcnt lgkmcnt(13)
  ds_read_b64_tr_b16 v[134:135], v4 offset:59392
  buffer_load_dwordx4 v12, s[32:35], s44 offen offset:1024 lds
  v_mfma_f32_16x16x32_bf16 v[80:83], v[104:107], v[160:163], v[80:83]
  ds_read_b64_tr_b16 v[136:137], v5 offset:57344
  v_cvt_pk_bf16_f32 v32, v32, v33
  v_mfma_f32_16x16x32_bf16 v[84:87], v[104:107], v[164:167], v[84:87]
  s_waitcnt lgkmcnt(13)
  ds_read_b64_tr_b16 v[138:139], v5 offset:59392
  v_cvt_pk_bf16_f32 v33, v34, v35
  v_mfma_f32_16x16x32_bf16 v[88:91], v[108:111], v[160:163], v[88:91]
  ds_read_b64_tr_b16 v[140:141], v6 offset:57344
  buffer_load_dwordx4 v13, s[32:35], s44 offen offset:2048 lds
  v_mfma_f32_16x16x32_bf16 v[92:95], v[108:111], v[164:167], v[92:95]
  s_waitcnt lgkmcnt(13)
  ds_read_b64_tr_b16 v[142:143], v6 offset:59392
  v_cvt_pk_bf16_f32 v34, v36, v37
  v_mfma_f32_16x16x32_bf16 v[64:67], v[112:115], v[168:171], v[64:67]
  ds_read_b64_tr_b16 v[144:145], v3 offset:61440
  v_cvt_pk_bf16_f32 v35, v38, v39
  v_mfma_f32_16x16x32_bf16 v[68:71], v[112:115], v[172:175], v[68:71]
  s_waitcnt lgkmcnt(13)
  ds_read_b64_tr_b16 v[146:147], v3 offset:63488
  buffer_load_dwordx4 v14, s[32:35], s44 offen offset:3072 lds
  v_mfma_f32_16x16x32_bf16 v[72:75], v[116:119], v[168:171], v[72:75]
  ds_read_b64_tr_b16 v[148:149], v4 offset:61440
  buffer_store_dwordx4 v[32:35], v2, s[68:71], s63 offen offset:0 sc1
  v_mfma_f32_16x16x32_bf16 v[76:79], v[116:119], v[172:175], v[76:79]
  s_waitcnt lgkmcnt(13)
  ds_read_b64_tr_b16 v[150:151], v4 offset:63488
  v_cvt_pk_bf16_f32 v40, v40, v41
  v_mfma_f32_16x16x32_bf16 v[80:83], v[120:123], v[168:171], v[80:83]
  ds_read_b64_tr_b16 v[152:153], v5 offset:61440
  v_cvt_pk_bf16_f32 v41, v42, v43
  v_mfma_f32_16x16x32_bf16 v[84:87], v[120:123], v[172:175], v[84:87]
  s_waitcnt lgkmcnt(13)
  ds_read_b64_tr_b16 v[154:155], v5 offset:63488
  v_cvt_pk_bf16_f32 v42, v44, v45
  v_mfma_f32_16x16x32_bf16 v[88:91], v[124:127], v[168:171], v[88:91]
  ds_read_b64_tr_b16 v[156:157], v6 offset:61440
  v_cvt_pk_bf16_f32 v43, v46, v47
  v_mfma_f32_16x16x32_bf16 v[92:95], v[124:127], v[172:175], v[92:95]
  s_waitcnt lgkmcnt(13)
  ds_read_b64_tr_b16 v[158:159], v6 offset:63488
  buffer_store_dwordx4 v[40:43], v2, s[68:71], s63 offen offset:1024 sc1
  v_mfma_f32_16x16x32_bf16 v[64:67], v[128:131], v[176:179], v[64:67]
  s_waitcnt vmcnt(14)
  s_barrier
  ds_read_b64_tr_b16 v[96:97], v7 offset:0
  v_cvt_pk_bf16_f32 v48, v48, v49
  v_mfma_f32_16x16x32_bf16 v[68:71], v[128:131], v[180:183], v[68:71]
  s_waitcnt lgkmcnt(13)
  ds_read_b64_tr_b16 v[98:99], v7 offset:2048
  v_cvt_pk_bf16_f32 v49, v50, v51
  v_mfma_f32_16x16x32_bf16 v[72:75], v[132:135], v[176:179], v[72:75]
  ds_read_b64_tr_b16 v[100:101], v8 offset:0
  v_cvt_pk_bf16_f32 v50, v52, v53
  v_mfma_f32_16x16x32_bf16 v[76:79], v[132:135], v[180:183], v[76:79]
  s_waitcnt lgkmcnt(13)
  ds_read_b64_tr_b16 v[102:103], v8 offset:2048
  v_cvt_pk_bf16_f32 v51, v54, v55
  v_mfma_f32_16x16x32_bf16 v[80:83], v[136:139], v[176:179], v[80:83]
  ds_read_b64_tr_b16 v[104:105], v9 offset:0
  buffer_store_dwordx4 v[48:51], v2, s[68:71], s63 offen offset:2048 sc1
  v_mfma_f32_16x16x32_bf16 v[84:87], v[136:139], v[180:183], v[84:87]
  s_waitcnt lgkmcnt(13)
  ds_read_b64_tr_b16 v[106:107], v9 offset:2048
  v_cvt_pk_bf16_f32 v56, v56, v57
  v_mfma_f32_16x16x32_bf16 v[88:91], v[140:143], v[176:179], v[88:91]
  ds_read_b64_tr_b16 v[108:109], v10 offset:0
  v_cvt_pk_bf16_f32 v57, v58, v59
  v_mfma_f32_16x16x32_bf16 v[92:95], v[140:143], v[180:183], v[92:95]
  s_waitcnt lgkmcnt(13)
  ds_read_b64_tr_b16 v[110:111], v10 offset:2048
  v_cvt_pk_bf16_f32 v58, v60, v61
  v_mfma_f32_16x16x32_bf16 v[64:67], v[144:147], v[184:187], v[64:67]
  ds_read_b64_tr_b16 v[112:113], v7 offset:4096
  v_cvt_pk_bf16_f32 v59, v62, v63
  v_mfma_f32_16x16x32_bf16 v[68:71], v[144:147], v[188:191], v[68:71]
  s_waitcnt lgkmcnt(13)
  ds_read_b64_tr_b16 v[114:115], v7 offset:6144
  buffer_store_dwordx4 v[56:59], v2, s[68:71], s63 offen offset:3072 sc1
  v_mfma_f32_16x16x32_bf16 v[72:75], v[148:151], v[184:187], v[72:75]
  ds_read_b64_tr_b16 v[116:117], v8 offset:4096
  v_mfma_f32_16x16x32_bf16 v[76:79], v[148:151], v[188:191], v[76:79]
  s_waitcnt lgkmcnt(13)
  ds_read_b64_tr_b16 v[118:119], v8 offset:6144
  v_mfma_f32_16x16x32_bf16 v[80:83], v[152:155], v[184:187], v[80:83]
  ds_read_b64_tr_b16 v[120:121], v9 offset:4096
  v_mfma_f32_16x16x32_bf16 v[84:87], v[152:155], v[188:191], v[84:87]
  s_waitcnt lgkmcnt(13)
  ds_read_b64_tr_b16 v[122:123], v9 offset:6144
  v_mfma_f32_16x16x32_bf16 v[88:91], v[156:159], v[184:187], v[88:91]
  ds_read_b64_tr_b16 v[124:125], v10 offset:4096
  v_mfma_f32_16x16x32_bf16 v[92:95], v[156:159], v[188:191], v[92:95]
  s_waitcnt lgkmcnt(13)
  ds_read_b64_tr_b16 v[126:127], v10 offset:6144
  v_mfma_f32_16x16x32_bf16 v[64:67], v[96:99], v[192:195], v[64:67]
  s_add_u32 s44, s62, s14
  s_add_u32 m0, s45, 0
  s_add_u32 s44, s44, 0
  ds_read_b64_tr_b16 v[128:129], v7 offset:8192
  buffer_load_dwordx4 v11, s[32:35], s44 offen offset:0 lds
  v_mfma_f32_16x16x32_bf16 v[68:71], v[96:99], v[196:199], v[68:71]
  s_waitcnt lgkmcnt(13)
  ds_read_b64_tr_b16 v[130:131], v7 offset:10240
  v_mfma_f32_16x16x32_bf16 v[72:75], v[100:103], v[192:195], v[72:75]
  ds_read_b64_tr_b16 v[132:133], v8 offset:8192
  v_mfma_f32_16x16x32_bf16 v[76:79], v[100:103], v[196:199], v[76:79]
  s_waitcnt lgkmcnt(13)
  ds_read_b64_tr_b16 v[134:135], v8 offset:10240
  buffer_load_dwordx4 v12, s[32:35], s44 offen offset:1024 lds
  v_mfma_f32_16x16x32_bf16 v[80:83], v[104:107], v[192:195], v[80:83]
  ds_read_b64_tr_b16 v[136:137], v9 offset:8192
  v_mfma_f32_16x16x32_bf16 v[84:87], v[104:107], v[196:199], v[84:87]
  s_waitcnt lgkmcnt(13)
  ds_read_b64_tr_b16 v[138:139], v9 offset:10240
  v_mfma_f32_16x16x32_bf16 v[88:91], v[108:111], v[192:195], v[88:91]
  ds_read_b64_tr_b16 v[140:141], v10 offset:8192
  buffer_load_dwordx4 v13, s[32:35], s44 offen offset:2048 lds
  v_mfma_f32_16x16x32_bf16 v[92:95], v[108:111], v[196:199], v[92:95]
  s_waitcnt lgkmcnt(13)
  ds_read_b64_tr_b16 v[142:143], v10 offset:10240
  v_mfma_f32_16x16x32_bf16 v[64:67], v[112:115], v[200:203], v[64:67]
  ds_read_b64_tr_b16 v[144:145], v7 offset:12288
  v_mfma_f32_16x16x32_bf16 v[68:71], v[112:115], v[204:207], v[68:71]
  s_waitcnt lgkmcnt(13)
  ds_read_b64_tr_b16 v[146:147], v7 offset:14336
  buffer_load_dwordx4 v14, s[32:35], s44 offen offset:3072 lds
  v_mfma_f32_16x16x32_bf16 v[72:75], v[116:119], v[200:203], v[72:75]
  ds_read_b64_tr_b16 v[148:149], v8 offset:12288
  v_mfma_f32_16x16x32_bf16 v[76:79], v[116:119], v[204:207], v[76:79]
  s_waitcnt lgkmcnt(13)
  ds_read_b64_tr_b16 v[150:151], v8 offset:14336
  v_mfma_f32_16x16x32_bf16 v[80:83], v[120:123], v[200:203], v[80:83]
  ds_read_b64_tr_b16 v[152:153], v9 offset:12288
  v_mfma_f32_16x16x32_bf16 v[84:87], v[120:123], v[204:207], v[84:87]
  s_waitcnt lgkmcnt(13)
  ds_read_b64_tr_b16 v[154:155], v9 offset:14336
  v_mfma_f32_16x16x32_bf16 v[88:91], v[124:127], v[200:203], v[88:91]
  ds_read_b64_tr_b16 v[156:157], v10 offset:12288
  v_mfma_f32_16x16x32_bf16 v[92:95], v[124:127], v[204:207], v[92:95]
  s_waitcnt lgkmcnt(13)
  ds_read_b64_tr_b16 v[158:159], v10 offset:14336
  v_mfma_f32_16x16x32_bf16 v[64:67], v[128:131], v[208:211], v[64:67]
  s_waitcnt vmcnt(16)
  s_barrier
  ds_read_b64_tr_b16 v[96:97], v7 offset:16384
  v_mfma_f32_16x16x32_bf16 v[68:71], v[128:131], v[212:215], v[68:71]
  s_waitcnt lgkmcnt(13)
  ds_read_b64_tr_b16 v[98:99], v7 offset:18432
  v_mfma_f32_16x16x32_bf16 v[72:75], v[132:135], v[208:211], v[72:75]
  ds_read_b64_tr_b16 v[100:101], v8 offset:16384
  v_mfma_f32_16x16x32_bf16 v[76:79], v[132:135], v[212:215], v[76:79]
  s_waitcnt lgkmcnt(13)
  ds_read_b64_tr_b16 v[102:103], v8 offset:18432
  v_mfma_f32_16x16x32_bf16 v[80:83], v[136:139], v[208:211], v[80:83]
  ds_read_b64_tr_b16 v[104:105], v9 offset:16384
  v_mfma_f32_16x16x32_bf16 v[84:87], v[136:139], v[212:215], v[84:87]
  s_waitcnt lgkmcnt(13)
  ds_read_b64_tr_b16 v[106:107], v9 offset:18432
  v_mfma_f32_16x16x32_bf16 v[88:91], v[140:143], v[208:211], v[88:91]
  ds_read_b64_tr_b16 v[108:109], v10 offset:16384
  v_mfma_f32_16x16x32_bf16 v[92:95], v[140:143], v[212:215], v[92:95]
  s_waitcnt lgkmcnt(13)
  ds_read_b64_tr_b16 v[110:111], v10 offset:18432
  v_mfma_f32_16x16x32_bf16 v[64:67], v[144:147], v[216:219], v[64:67]
  ds_read_b64_tr_b16 v[112:113], v7 offset:20480
  v_mfma_f32_16x16x32_bf16 v[68:71], v[144:147], v[220:223], v[68:71]
  s_waitcnt lgkmcnt(13)
  ds_read_b64_tr_b16 v[114:115], v7 offset:22528
  v_mfma_f32_16x16x32_bf16 v[72:75], v[148:151], v[216:219], v[72:75]
  ds_read_b64_tr_b16 v[116:117], v8 offset:20480
  v_mfma_f32_16x16x32_bf16 v[76:79], v[148:151], v[220:223], v[76:79]
  s_waitcnt lgkmcnt(13)
  ds_read_b64_tr_b16 v[118:119], v8 offset:22528
  v_mfma_f32_16x16x32_bf16 v[80:83], v[152:155], v[216:219], v[80:83]
  ds_read_b64_tr_b16 v[120:121], v9 offset:20480
  v_mfma_f32_16x16x32_bf16 v[84:87], v[152:155], v[220:223], v[84:87]
  s_waitcnt lgkmcnt(13)
  ds_read_b64_tr_b16 v[122:123], v9 offset:22528
  v_mfma_f32_16x16x32_bf16 v[88:91], v[156:159], v[216:219], v[88:91]
  ds_read_b64_tr_b16 v[124:125], v10 offset:20480
  v_mfma_f32_16x16x32_bf16 v[92:95], v[156:159], v[220:223], v[92:95]
  s_waitcnt lgkmcnt(13)
  ds_read_b64_tr_b16 v[126:127], v10 offset:22528
  v_mfma_f32_16x16x32_bf16 v[64:67], v[96:99], v[224:227], v[64:67]
  s_add_u32 s44, s62, s12
  s_add_u32 m0, s45, 16384
  s_add_u32 s44, s44, 442368
  ds_read_b64_tr_b16 v[128:129], v7 offset:24576
  buffer_load_dwordx4 v11, s[32:35], s44 offen offset:0 lds
  v_mfma_f32_16x16x32_bf16 v[68:71], v[96:99], v[228:231], v[68:71]
  s_waitcnt lgkmcnt(13)
  ds_read_b64_tr_b16 v[130:131], v7 offset:26624
  v_mfma_f32_16x16x32_bf16 v[72:75], v[100:103], v[224:227], v[72:75]
  ds_read_b64_tr_b16 v[132:133], v8 offset:24576
  v_mfma_f32_16x16x32_bf16 v[76:79], v[100:103], v[228:231], v[76:79]
  s_waitcnt lgkmcnt(13)
  ds_read_b64_tr_b16 v[134:135], v8 offset:26624
  buffer_load_dwordx4 v12, s[32:35], s44 offen offset:1024 lds
  v_mfma_f32_16x16x32_bf16 v[80:83], v[104:107], v[224:227], v[80:83]
  ds_read_b64_tr_b16 v[136:137], v9 offset:24576
  v_mfma_f32_16x16x32_bf16 v[84:87], v[104:107], v[228:231], v[84:87]
  s_waitcnt lgkmcnt(13)
  ds_read_b64_tr_b16 v[138:139], v9 offset:26624
  v_mfma_f32_16x16x32_bf16 v[88:91], v[108:111], v[224:227], v[88:91]
  ds_read_b64_tr_b16 v[140:141], v10 offset:24576
  buffer_load_dwordx4 v13, s[32:35], s44 offen offset:2048 lds
  v_mfma_f32_16x16x32_bf16 v[92:95], v[108:111], v[228:231], v[92:95]
  s_waitcnt lgkmcnt(13)
  ds_read_b64_tr_b16 v[142:143], v10 offset:26624
  v_mfma_f32_16x16x32_bf16 v[64:67], v[112:115], v[232:235], v[64:67]
  ds_read_b64_tr_b16 v[144:145], v7 offset:28672
  v_mfma_f32_16x16x32_bf16 v[68:71], v[112:115], v[236:239], v[68:71]
  s_waitcnt lgkmcnt(13)
  ds_read_b64_tr_b16 v[146:147], v7 offset:30720
  buffer_load_dwordx4 v14, s[32:35], s44 offen offset:3072 lds
  v_mfma_f32_16x16x32_bf16 v[72:75], v[116:119], v[232:235], v[72:75]
  ds_read_b64_tr_b16 v[148:149], v8 offset:28672
  v_mfma_f32_16x16x32_bf16 v[76:79], v[116:119], v[236:239], v[76:79]
  s_waitcnt lgkmcnt(13)
  ds_read_b64_tr_b16 v[150:151], v8 offset:30720
  v_mfma_f32_16x16x32_bf16 v[80:83], v[120:123], v[232:235], v[80:83]
  ds_read_b64_tr_b16 v[152:153], v9 offset:28672
  v_mfma_f32_16x16x32_bf16 v[84:87], v[120:123], v[236:239], v[84:87]
  s_waitcnt lgkmcnt(13)
  ds_read_b64_tr_b16 v[154:155], v9 offset:30720
  v_mfma_f32_16x16x32_bf16 v[88:91], v[124:127], v[232:235], v[88:91]
  ds_read_b64_tr_b16 v[156:157], v10 offset:28672
  v_mfma_f32_16x16x32_bf16 v[92:95], v[124:127], v[236:239], v[92:95]
  s_waitcnt lgkmcnt(13)
  ds_read_b64_tr_b16 v[158:159], v10 offset:30720
  v_mfma_f32_16x16x32_bf16 v[64:67], v[128:131], v[240:243], v[64:67]
  s_waitcnt vmcnt(16)
  s_barrier
  ds_read_b64_tr_b16 v[96:97], v7 offset:32768
  v_mfma_f32_16x16x32_bf16 v[68:71], v[128:131], v[244:247], v[68:71]
  s_waitcnt lgkmcnt(13)
  ds_read_b64_tr_b16 v[98:99], v7 offset:34816
  v_mfma_f32_16x16x32_bf16 v[72:75], v[132:135], v[240:243], v[72:75]
  ds_read_b64_tr_b16 v[100:101], v8 offset:32768
  v_mfma_f32_16x16x32_bf16 v[76:79], v[132:135], v[244:247], v[76:79]
  s_waitcnt lgkmcnt(13)
  ds_read_b64_tr_b16 v[102:103], v8 offset:34816
  v_mfma_f32_16x16x32_bf16 v[80:83], v[136:139], v[240:243], v[80:83]
  ds_read_b64_tr_b16 v[104:105], v9 offset:32768
  v_mfma_f32_16x16x32_bf16 v[84:87], v[136:139], v[244:247], v[84:87]
  s_waitcnt lgkmcnt(13)
  ds_read_b64_tr_b16 v[106:107], v9 offset:34816
  v_mfma_f32_16x16x32_bf16 v[88:91], v[140:143], v[240:243], v[88:91]
  ds_read_b64_tr_b16 v[108:109], v10 offset:32768
  v_mfma_f32_16x16x32_bf16 v[92:95], v[140:143], v[244:247], v[92:95]
  s_waitcnt lgkmcnt(13)
  ds_read_b64_tr_b16 v[110:111], v10 offset:34816
  v_mfma_f32_16x16x32_bf16 v[64:67], v[144:147], v[248:251], v[64:67]
  ds_read_b64_tr_b16 v[112:113], v7 offset:36864
  v_mfma_f32_16x16x32_bf16 v[68:71], v[144:147], v[252:255], v[68:71]
  s_waitcnt lgkmcnt(13)
  ds_read_b64_tr_b16 v[114:115], v7 offset:38912
  v_mfma_f32_16x16x32_bf16 v[72:75], v[148:151], v[248:251], v[72:75]
  ds_read_b64_tr_b16 v[116:117], v8 offset:36864
  v_mfma_f32_16x16x32_bf16 v[76:79], v[148:151], v[252:255], v[76:79]
  s_waitcnt lgkmcnt(13)
  ds_read_b64_tr_b16 v[118:119], v8 offset:38912
  v_mfma_f32_16x16x32_bf16 v[80:83], v[152:155], v[248:251], v[80:83]
  ds_read_b64_tr_b16 v[120:121], v9 offset:36864
  v_mfma_f32_16x16x32_bf16 v[84:87], v[152:155], v[252:255], v[84:87]
  s_waitcnt lgkmcnt(13)
  ds_read_b64_tr_b16 v[122:123], v9 offset:38912
  v_mfma_f32_16x16x32_bf16 v[88:91], v[156:159], v[248:251], v[88:91]
  ds_read_b64_tr_b16 v[124:125], v10 offset:36864
  v_mfma_f32_16x16x32_bf16 v[92:95], v[156:159], v[252:255], v[92:95]
  s_waitcnt lgkmcnt(13)
  ds_read_b64_tr_b16 v[126:127], v10 offset:38912
  v_mfma_f32_16x16x32_bf16 v[32:35], v[96:99], a[0:3], 0
  s_add_u32 s44, s62, s13
  s_add_u32 m0, s45, 32768
  s_add_u32 s44, s44, 442368
  ds_read_b64_tr_b16 v[128:129], v7 offset:40960
  buffer_load_dwordx4 v11, s[32:35], s44 offen offset:0 lds
  v_mfma_f32_16x16x32_bf16 v[36:39], v[96:99], a[4:7], 0
  s_waitcnt lgkmcnt(13)
  ds_read_b64_tr_b16 v[130:131], v7 offset:43008
  v_mfma_f32_16x16x32_bf16 v[40:43], v[100:103], a[0:3], 0
  ds_read_b64_tr_b16 v[132:133], v8 offset:40960
  v_mfma_f32_16x16x32_bf16 v[44:47], v[100:103], a[4:7], 0
  s_waitcnt lgkmcnt(13)
  ds_read_b64_tr_b16 v[134:135], v8 offset:43008
  buffer_load_dwordx4 v12, s[32:35], s44 offen offset:1024 lds
  v_mfma_f32_16x16x32_bf16 v[48:51], v[104:107], a[0:3], 0
  ds_read_b64_tr_b16 v[136:137], v9 offset:40960
  v_cvt_pk_bf16_f32 v64, v64, v65
  v_mfma_f32_16x16x32_bf16 v[52:55], v[104:107], a[4:7], 0
  s_waitcnt lgkmcnt(13)
  ds_read_b64_tr_b16 v[138:139], v9 offset:43008
  v_cvt_pk_bf16_f32 v65, v66, v67
  v_mfma_f32_16x16x32_bf16 v[56:59], v[108:111], a[0:3], 0
  ds_read_b64_tr_b16 v[140:141], v10 offset:40960
  buffer_load_dwordx4 v13, s[32:35], s44 offen offset:2048 lds
  v_mfma_f32_16x16x32_bf16 v[60:63], v[108:111], a[4:7], 0
  s_waitcnt lgkmcnt(13)
  ds_read_b64_tr_b16 v[142:143], v10 offset:43008
  v_cvt_pk_bf16_f32 v66, v68, v69
  v_mfma_f32_16x16x32_bf16 v[32:35], v[112:115], a[8:11], v[32:35]
  ds_read_b64_tr_b16 v[144:145], v7 offset:45056
  v_cvt_pk_bf16_f32 v67, v70, v71
  v_mfma_f32_16x16x32_bf16 v[36:39], v[112:115], a[12:15], v[36:39]
  s_waitcnt lgkmcnt(13)
  ds_read_b64_tr_b16 v[146:147], v7 offset:47104
  buffer_load_dwordx4 v14, s[32:35], s44 offen offset:3072 lds
  v_mfma_f32_16x16x32_bf16 v[40:43], v[116:119], a[8:11], v[40:43]
  ds_read_b64_tr_b16 v[148:149], v8 offset:45056
  buffer_store_dwordx4 v[64:67], v2, s[68:71], s64 offen offset:0 sc1
  v_mfma_f32_16x16x32_bf16 v[44:47], v[116:119], a[12:15], v[44:47]
  s_waitcnt lgkmcnt(13)
  ds_read_b64_tr_b16 v[150:151], v8 offset:47104
  v_cvt_pk_bf16_f32 v72, v72, v73
  v_mfma_f32_16x16x32_bf16 v[48:51], v[120:123], a[8:11], v[48:51]
  ds_read_b64_tr_b16 v[152:153], v9 offset:45056
  v_cvt_pk_bf16_f32 v73, v74, v75
  v_mfma_f32_16x16x32_bf16 v[52:55], v[120:123], a[12:15], v[52:55]
  s_waitcnt lgkmcnt(13)
  ds_read_b64_tr_b16 v[154:155], v9 offset:47104
  v_cvt_pk_bf16_f32 v74, v76, v77
  v_mfma_f32_16x16x32_bf16 v[56:59], v[124:127], a[8:11], v[56:59]
  ds_read_b64_tr_b16 v[156:157], v10 offset:45056
  v_cvt_pk_bf16_f32 v75, v78, v79
  v_mfma_f32_16x16x32_bf16 v[60:63], v[124:127], a[12:15], v[60:63]
  s_waitcnt lgkmcnt(13)
  ds_read_b64_tr_b16 v[158:159], v10 offset:47104
  buffer_store_dwordx4 v[72:75], v2, s[68:71], s64 offen offset:1024 sc1
  v_mfma_f32_16x16x32_bf16 v[32:35], v[128:131], a[16:19], v[32:35]
  s_waitcnt vmcnt(18)
  s_barrier
  ds_read_b64_tr_b16 v[96:97], v7 offset:49152
  v_cvt_pk_bf16_f32 v80, v80, v81
  v_mfma_f32_16x16x32_bf16 v[36:39], v[128:131], a[20:23], v[36:39]
  s_waitcnt lgkmcnt(13)
  ds_read_b64_tr_b16 v[98:99], v7 offset:51200
  v_cvt_pk_bf16_f32 v81, v82, v83
  v_mfma_f32_16x16x32_bf16 v[40:43], v[132:135], a[16:19], v[40:43]
  ds_read_b64_tr_b16 v[100:101], v8 offset:49152
  v_cvt_pk_bf16_f32 v82, v84, v85
  v_mfma_f32_16x16x32_bf16 v[44:47], v[132:135], a[20:23], v[44:47]
  s_waitcnt lgkmcnt(13)
  ds_read_b64_tr_b16 v[102:103], v8 offset:51200
  v_cvt_pk_bf16_f32 v83, v86, v87
  v_mfma_f32_16x16x32_bf16 v[48:51], v[136:139], a[16:19], v[48:51]
  ds_read_b64_tr_b16 v[104:105], v9 offset:49152
  buffer_store_dwordx4 v[80:83], v2, s[68:71], s64 offen offset:2048 sc1
  v_mfma_f32_16x16x32_bf16 v[52:55], v[136:139], a[20:23], v[52:55]
  s_waitcnt lgkmcnt(13)
  ds_read_b64_tr_b16 v[106:107], v9 offset:51200
  v_cvt_pk_bf16_f32 v88, v88, v89
  v_mfma_f32_16x16x32_bf16 v[56:59], v[140:143], a[16:19], v[56:59]
  ds_read_b64_tr_b16 v[108:109], v10 offset:49152
  v_cvt_pk_bf16_f32 v89, v90, v91
  v_mfma_f32_16x16x32_bf16 v[60:63], v[140:143], a[20:23], v[60:63]
  s_waitcnt lgkmcnt(13)
  ds_read_b64_tr_b16 v[110:111], v10 offset:51200
  v_cvt_pk_bf16_f32 v90, v92, v93
  v_mfma_f32_16x16x32_bf16 v[32:35], v[144:147], a[24:27], v[32:35]
  ds_read_b64_tr_b16 v[112:113], v7 offset:53248
  v_cvt_pk_bf16_f32 v91, v94, v95
  v_mfma_f32_16x16x32_bf16 v[36:39], v[144:147], a[28:31], v[36:39]
  s_waitcnt lgkmcnt(13)
  ds_read_b64_tr_b16 v[114:115], v7 offset:55296
  buffer_store_dwordx4 v[88:91], v2, s[68:71], s64 offen offset:3072 sc1
  v_mfma_f32_16x16x32_bf16 v[40:43], v[148:151], a[24:27], v[40:43]
  ds_read_b64_tr_b16 v[116:117], v8 offset:53248
  v_mfma_f32_16x16x32_bf16 v[44:47], v[148:151], a[28:31], v[44:47]
  s_waitcnt lgkmcnt(13)
  ds_read_b64_tr_b16 v[118:119], v8 offset:55296
  v_mfma_f32_16x16x32_bf16 v[48:51], v[152:155], a[24:27], v[48:51]
  ds_read_b64_tr_b16 v[120:121], v9 offset:53248
  v_mfma_f32_16x16x32_bf16 v[52:55], v[152:155], a[28:31], v[52:55]
  s_waitcnt lgkmcnt(13)
  ds_read_b64_tr_b16 v[122:123], v9 offset:55296
  v_mfma_f32_16x16x32_bf16 v[56:59], v[156:159], a[24:27], v[56:59]
  ds_read_b64_tr_b16 v[124:125], v10 offset:53248
  v_mfma_f32_16x16x32_bf16 v[60:63], v[156:159], a[28:31], v[60:63]
  s_waitcnt lgkmcnt(13)
  ds_read_b64_tr_b16 v[126:127], v10 offset:55296
  v_mfma_f32_16x16x32_bf16 v[32:35], v[96:99], a[32:35], v[32:35]
  s_add_u32 s44, s62, s14
  s_add_u32 m0, s45, 49152
  s_add_u32 s44, s44, 442368
  ds_read_b64_tr_b16 v[128:129], v7 offset:57344
  buffer_load_dwordx4 v11, s[32:35], s44 offen offset:0 lds
  v_mfma_f32_16x16x32_bf16 v[36:39], v[96:99], a[36:39], v[36:39]
  s_waitcnt lgkmcnt(13)
  ds_read_b64_tr_b16 v[130:131], v7 offset:59392
  v_mfma_f32_16x16x32_bf16 v[40:43], v[100:103], a[32:35], v[40:43]
  ds_read_b64_tr_b16 v[132:133], v8 offset:57344
  v_mfma_f32_16x16x32_bf16 v[44:47], v[100:103], a[36:39], v[44:47]
  s_waitcnt lgkmcnt(13)
  ds_read_b64_tr_b16 v[134:135], v8 offset:59392
  buffer_load_dwordx4 v12, s[32:35], s44 offen offset:1024 lds
  v_mfma_f32_16x16x32_bf16 v[48:51], v[104:107], a[32:35], v[48:51]
  ds_read_b64_tr_b16 v[136:137], v9 offset:57344
  v_mfma_f32_16x16x32_bf16 v[52:55], v[104:107], a[36:39], v[52:55]
  s_waitcnt lgkmcnt(13)
  ds_read_b64_tr_b16 v[138:139], v9 offset:59392
  v_mfma_f32_16x16x32_bf16 v[56:59], v[108:111], a[32:35], v[56:59]
  ds_read_b64_tr_b16 v[140:141], v10 offset:57344
  buffer_load_dwordx4 v13, s[32:35], s44 offen offset:2048 lds
  v_mfma_f32_16x16x32_bf16 v[60:63], v[108:111], a[36:39], v[60:63]
  s_waitcnt lgkmcnt(13)
  ds_read_b64_tr_b16 v[142:143], v10 offset:59392
  v_mfma_f32_16x16x32_bf16 v[32:35], v[112:115], a[40:43], v[32:35]
  ds_read_b64_tr_b16 v[144:145], v7 offset:61440
  v_mfma_f32_16x16x32_bf16 v[36:39], v[112:115], a[44:47], v[36:39]
  s_waitcnt lgkmcnt(13)
  ds_read_b64_tr_b16 v[146:147], v7 offset:63488
  buffer_load_dwordx4 v14, s[32:35], s44 offen offset:3072 lds
  v_mfma_f32_16x16x32_bf16 v[40:43], v[116:119], a[40:43], v[40:43]
  ds_read_b64_tr_b16 v[148:149], v8 offset:61440
  v_mfma_f32_16x16x32_bf16 v[44:47], v[116:119], a[44:47], v[44:47]
  s_waitcnt lgkmcnt(13)
  ds_read_b64_tr_b16 v[150:151], v8 offset:63488
  v_mfma_f32_16x16x32_bf16 v[48:51], v[120:123], a[40:43], v[48:51]
  ds_read_b64_tr_b16 v[152:153], v9 offset:61440
  v_mfma_f32_16x16x32_bf16 v[52:55], v[120:123], a[44:47], v[52:55]
  s_waitcnt lgkmcnt(13)
  ds_read_b64_tr_b16 v[154:155], v9 offset:63488
  v_mfma_f32_16x16x32_bf16 v[56:59], v[124:127], a[40:43], v[56:59]
  ds_read_b64_tr_b16 v[156:157], v10 offset:61440
  v_mfma_f32_16x16x32_bf16 v[60:63], v[124:127], a[44:47], v[60:63]
  s_waitcnt lgkmcnt(13)
  ds_read_b64_tr_b16 v[158:159], v10 offset:63488
  v_mfma_f32_16x16x32_bf16 v[32:35], v[128:131], a[48:51], v[32:35]
  s_waitcnt vmcnt(16)
  s_barrier
  ds_read_b64_tr_b16 v[96:97], v3 offset:0
  v_mfma_f32_16x16x32_bf16 v[36:39], v[128:131], a[52:55], v[36:39]
  s_waitcnt lgkmcnt(13)
  ds_read_b64_tr_b16 v[98:99], v3 offset:2048
  v_mfma_f32_16x16x32_bf16 v[40:43], v[132:135], a[48:51], v[40:43]
  ds_read_b64_tr_b16 v[100:101], v4 offset:0
  v_mfma_f32_16x16x32_bf16 v[44:47], v[132:135], a[52:55], v[44:47]
  s_waitcnt lgkmcnt(13)
  ds_read_b64_tr_b16 v[102:103], v4 offset:2048
  v_mfma_f32_16x16x32_bf16 v[48:51], v[136:139], a[48:51], v[48:51]
  ds_read_b64_tr_b16 v[104:105], v5 offset:0
  v_mfma_f32_16x16x32_bf16 v[52:55], v[136:139], a[52:55], v[52:55]
  s_waitcnt lgkmcnt(13)
  ds_read_b64_tr_b16 v[106:107], v5 offset:2048
  v_mfma_f32_16x16x32_bf16 v[56:59], v[140:143], a[48:51], v[56:59]
  ds_read_b64_tr_b16 v[108:109], v6 offset:0
  v_mfma_f32_16x16x32_bf16 v[60:63], v[140:143], a[52:55], v[60:63]
  s_waitcnt lgkmcnt(13)
  ds_read_b64_tr_b16 v[110:111], v6 offset:2048
  v_mfma_f32_16x16x32_bf16 v[32:35], v[144:147], a[56:59], v[32:35]
  ds_read_b64_tr_b16 v[112:113], v3 offset:4096
  v_mfma_f32_16x16x32_bf16 v[36:39], v[144:147], a[60:63], v[36:39]
  s_waitcnt lgkmcnt(13)
  ds_read_b64_tr_b16 v[114:115], v3 offset:6144
  v_mfma_f32_16x16x32_bf16 v[40:43], v[148:151], a[56:59], v[40:43]
  ds_read_b64_tr_b16 v[116:117], v4 offset:4096
  v_mfma_f32_16x16x32_bf16 v[44:47], v[148:151], a[60:63], v[44:47]
  s_waitcnt lgkmcnt(13)
  ds_read_b64_tr_b16 v[118:119], v4 offset:6144
  v_mfma_f32_16x16x32_bf16 v[48:51], v[152:155], a[56:59], v[48:51]
  ds_read_b64_tr_b16 v[120:121], v5 offset:4096
  v_mfma_f32_16x16x32_bf16 v[52:55], v[152:155], a[60:63], v[52:55]
  s_waitcnt lgkmcnt(13)
  ds_read_b64_tr_b16 v[122:123], v5 offset:6144
  v_mfma_f32_16x16x32_bf16 v[56:59], v[156:159], a[56:59], v[56:59]
  ds_read_b64_tr_b16 v[124:125], v6 offset:4096
  v_mfma_f32_16x16x32_bf16 v[60:63], v[156:159], a[60:63], v[60:63]
  s_waitcnt lgkmcnt(13)
  ds_read_b64_tr_b16 v[126:127], v6 offset:6144
  v_mfma_f32_16x16x32_bf16 v[32:35], v[96:99], a[64:67], v[32:35]
  s_add_u32 s44, s62, s12
  s_add_u32 m0, s45, 65536
  s_add_u32 s44, s44, 884736
  ds_read_b64_tr_b16 v[128:129], v3 offset:8192
  buffer_load_dwordx4 v11, s[32:35], s44 offen offset:0 lds
  v_mfma_f32_16x16x32_bf16 v[36:39], v[96:99], a[68:71], v[36:39]
  s_waitcnt lgkmcnt(13)
  ds_read_b64_tr_b16 v[130:131], v3 offset:10240
  v_mfma_f32_16x16x32_bf16 v[40:43], v[100:103], a[64:67], v[40:43]
  ds_read_b64_tr_b16 v[132:133], v4 offset:8192
  v_mfma_f32_16x16x32_bf16 v[44:47], v[100:103], a[68:71], v[44:47]
  s_waitcnt lgkmcnt(13)
  ds_read_b64_tr_b16 v[134:135], v4 offset:10240
  buffer_load_dwordx4 v12, s[32:35], s44 offen offset:1024 lds
  v_mfma_f32_16x16x32_bf16 v[48:51], v[104:107], a[64:67], v[48:51]
  ds_read_b64_tr_b16 v[136:137], v5 offset:8192
  v_mfma_f32_16x16x32_bf16 v[52:55], v[104:107], a[68:71], v[52:55]
  s_waitcnt lgkmcnt(13)
  ds_read_b64_tr_b16 v[138:139], v5 offset:10240
  v_mfma_f32_16x16x32_bf16 v[56:59], v[108:111], a[64:67], v[56:59]
  ds_read_b64_tr_b16 v[140:141], v6 offset:8192
  buffer_load_dwordx4 v13, s[32:35], s44 offen offset:2048 lds
  v_mfma_f32_16x16x32_bf16 v[60:63], v[108:111], a[68:71], v[60:63]
  s_waitcnt lgkmcnt(13)
  ds_read_b64_tr_b16 v[142:143], v6 offset:10240
  v_mfma_f32_16x16x32_bf16 v[32:35], v[112:115], a[72:75], v[32:35]
  ds_read_b64_tr_b16 v[144:145], v3 offset:12288
  v_mfma_f32_16x16x32_bf16 v[36:39], v[112:115], a[76:79], v[36:39]
  s_waitcnt lgkmcnt(13)
  ds_read_b64_tr_b16 v[146:147], v3 offset:14336
  buffer_load_dwordx4 v14, s[32:35], s44 offen offset:3072 lds
  v_mfma_f32_16x16x32_bf16 v[40:43], v[116:119], a[72:75], v[40:43]
  ds_read_b64_tr_b16 v[148:149], v4 offset:12288
  v_mfma_f32_16x16x32_bf16 v[44:47], v[116:119], a[76:79], v[44:47]
  s_waitcnt lgkmcnt(13)
  ds_read_b64_tr_b16 v[150:151], v4 offset:14336
  v_mfma_f32_16x16x32_bf16 v[48:51], v[120:123], a[72:75], v[48:51]
  ds_read_b64_tr_b16 v[152:153], v5 offset:12288
  v_mfma_f32_16x16x32_bf16 v[52:55], v[120:123], a[76:79], v[52:55]
  s_waitcnt lgkmcnt(13)
  ds_read_b64_tr_b16 v[154:155], v5 offset:14336
  v_mfma_f32_16x16x32_bf16 v[56:59], v[124:127], a[72:75], v[56:59]
  ds_read_b64_tr_b16 v[156:157], v6 offset:12288
  v_mfma_f32_16x16x32_bf16 v[60:63], v[124:127], a[76:79], v[60:63]
  s_waitcnt lgkmcnt(13)
  ds_read_b64_tr_b16 v[158:159], v6 offset:14336
  v_mfma_f32_16x16x32_bf16 v[32:35], v[128:131], a[80:83], v[32:35]
  s_waitcnt vmcnt(16)
  s_barrier
  ds_read_b64_tr_b16 v[96:97], v3 offset:16384
  v_mfma_f32_16x16x32_bf16 v[36:39], v[128:131], a[84:87], v[36:39]
  s_waitcnt lgkmcnt(13)
  ds_read_b64_tr_b16 v[98:99], v3 offset:18432
  v_mfma_f32_16x16x32_bf16 v[40:43], v[132:135], a[80:83], v[40:43]
  ds_read_b64_tr_b16 v[100:101], v4 offset:16384
  v_mfma_f32_16x16x32_bf16 v[44:47], v[132:135], a[84:87], v[44:47]
  s_waitcnt lgkmcnt(13)
  ds_read_b64_tr_b16 v[102:103], v4 offset:18432
  v_mfma_f32_16x16x32_bf16 v[48:51], v[136:139], a[80:83], v[48:51]
  ds_read_b64_tr_b16 v[104:105], v5 offset:16384
  v_mfma_f32_16x16x32_bf16 v[52:55], v[136:139], a[84:87], v[52:55]
  s_waitcnt lgkmcnt(13)
  ds_read_b64_tr_b16 v[106:107], v5 offset:18432
  v_mfma_f32_16x16x32_bf16 v[56:59], v[140:143], a[80:83], v[56:59]
  ds_read_b64_tr_b16 v[108:109], v6 offset:16384
  v_mfma_f32_16x16x32_bf16 v[60:63], v[140:143], a[84:87], v[60:63]
  s_waitcnt lgkmcnt(13)
  ds_read_b64_tr_b16 v[110:111], v6 offset:18432
  v_mfma_f32_16x16x32_bf16 v[32:35], v[144:147], a[88:91], v[32:35]
  ds_read_b64_tr_b16 v[112:113], v3 offset:20480
  v_mfma_f32_16x16x32_bf16 v[36:39], v[144:147], a[92:95], v[36:39]
  s_waitcnt lgkmcnt(13)
  ds_read_b64_tr_b16 v[114:115], v3 offset:22528
  v_mfma_f32_16x16x32_bf16 v[40:43], v[148:151], a[88:91], v[40:43]
  ds_read_b64_tr_b16 v[116:117], v4 offset:20480
  v_mfma_f32_16x16x32_bf16 v[44:47], v[148:151], a[92:95], v[44:47]
  s_waitcnt lgkmcnt(13)
  ds_read_b64_tr_b16 v[118:119], v4 offset:22528
  v_mfma_f32_16x16x32_bf16 v[48:51], v[152:155], a[88:91], v[48:51]
  ds_read_b64_tr_b16 v[120:121], v5 offset:20480
  v_mfma_f32_16x16x32_bf16 v[52:55], v[152:155], a[92:95], v[52:55]
  s_waitcnt lgkmcnt(13)
  ds_read_b64_tr_b16 v[122:123], v5 offset:22528
  v_mfma_f32_16x16x32_bf16 v[56:59], v[156:159], a[88:91], v[56:59]
  ds_read_b64_tr_b16 v[124:125], v6 offset:20480
  v_mfma_f32_16x16x32_bf16 v[60:63], v[156:159], a[92:95], v[60:63]
  s_waitcnt lgkmcnt(13)
  ds_read_b64_tr_b16 v[126:127], v6 offset:22528
  v_mfma_f32_16x16x32_bf16 v[32:35], v[96:99], a[96:99], v[32:35]
  s_add_u32 s44, s62, s13
  s_add_u32 m0, s45, 81920
  s_add_u32 s44, s44, 884736
  ds_read_b64_tr_b16 v[128:129], v3 offset:24576
  buffer_load_dwordx4 v11, s[32:35], s44 offen offset:0 lds
  v_mfma_f32_16x16x32_bf16 v[36:39], v[96:99], a[100:103], v[36:39]
  s_waitcnt lgkmcnt(13)
  ds_read_b64_tr_b16 v[130:131], v3 offset:26624
  v_mfma_f32_16x16x32_bf16 v[40:43], v[100:103], a[96:99], v[40:43]
  ds_read_b64_tr_b16 v[132:133], v4 offset:24576
  v_mfma_f32_16x16x32_bf16 v[44:47], v[100:103], a[100:103], v[44:47]
  s_waitcnt lgkmcnt(13)
  ds_read_b64_tr_b16 v[134:135], v4 offset:26624
  buffer_load_dwordx4 v12, s[32:35], s44 offen offset:1024 lds
  v_mfma_f32_16x16x32_bf16 v[48:51], v[104:107], a[96:99], v[48:51]
  ds_read_b64_tr_b16 v[136:137], v5 offset:24576
  v_mfma_f32_16x16x32_bf16 v[52:55], v[104:107], a[100:103], v[52:55]
  s_waitcnt lgkmcnt(13)
  ds_read_b64_tr_b16 v[138:139], v5 offset:26624
  v_mfma_f32_16x16x32_bf16 v[56:59], v[108:111], a[96:99], v[56:59]
  ds_read_b64_tr_b16 v[140:141], v6 offset:24576
  buffer_load_dwordx4 v13, s[32:35], s44 offen offset:2048 lds
  v_mfma_f32_16x16x32_bf16 v[60:63], v[108:111], a[100:103], v[60:63]
  s_waitcnt lgkmcnt(13)
  ds_read_b64_tr_b16 v[142:143], v6 offset:26624
  v_mfma_f32_16x16x32_bf16 v[32:35], v[112:115], a[104:107], v[32:35]
  ds_read_b64_tr_b16 v[144:145], v3 offset:28672
  v_mfma_f32_16x16x32_bf16 v[36:39], v[112:115], a[108:111], v[36:39]
  s_waitcnt lgkmcnt(13)
  ds_read_b64_tr_b16 v[146:147], v3 offset:30720
  buffer_load_dwordx4 v14, s[32:35], s44 offen offset:3072 lds
  v_mfma_f32_16x16x32_bf16 v[40:43], v[116:119], a[104:107], v[40:43]
  ds_read_b64_tr_b16 v[148:149], v4 offset:28672
  v_mfma_f32_16x16x32_bf16 v[44:47], v[116:119], a[108:111], v[44:47]
  s_waitcnt lgkmcnt(13)
  ds_read_b64_tr_b16 v[150:151], v4 offset:30720
  v_mfma_f32_16x16x32_bf16 v[48:51], v[120:123], a[104:107], v[48:51]
  ds_read_b64_tr_b16 v[152:153], v5 offset:28672
  v_mfma_f32_16x16x32_bf16 v[52:55], v[120:123], a[108:111], v[52:55]
  s_waitcnt lgkmcnt(13)
  ds_read_b64_tr_b16 v[154:155], v5 offset:30720
  v_mfma_f32_16x16x32_bf16 v[56:59], v[124:127], a[104:107], v[56:59]
  ds_read_b64_tr_b16 v[156:157], v6 offset:28672
  v_mfma_f32_16x16x32_bf16 v[60:63], v[124:127], a[108:111], v[60:63]
  s_waitcnt lgkmcnt(13)
  ds_read_b64_tr_b16 v[158:159], v6 offset:30720
  v_mfma_f32_16x16x32_bf16 v[32:35], v[128:131], a[112:115], v[32:35]
  s_waitcnt vmcnt(16)
  s_barrier
  ds_read_b64_tr_b16 v[96:97], v3 offset:32768
  v_mfma_f32_16x16x32_bf16 v[36:39], v[128:131], a[116:119], v[36:39]
  s_waitcnt lgkmcnt(13)
  ds_read_b64_tr_b16 v[98:99], v3 offset:34816
  v_mfma_f32_16x16x32_bf16 v[40:43], v[132:135], a[112:115], v[40:43]
  ds_read_b64_tr_b16 v[100:101], v4 offset:32768
  v_mfma_f32_16x16x32_bf16 v[44:47], v[132:135], a[116:119], v[44:47]
  s_waitcnt lgkmcnt(13)
  ds_read_b64_tr_b16 v[102:103], v4 offset:34816
  v_mfma_f32_16x16x32_bf16 v[48:51], v[136:139], a[112:115], v[48:51]
  ds_read_b64_tr_b16 v[104:105], v5 offset:32768
  v_mfma_f32_16x16x32_bf16 v[52:55], v[136:139], a[116:119], v[52:55]
  s_waitcnt lgkmcnt(13)
  ds_read_b64_tr_b16 v[106:107], v5 offset:34816
  v_mfma_f32_16x16x32_bf16 v[56:59], v[140:143], a[112:115], v[56:59]
  ds_read_b64_tr_b16 v[108:109], v6 offset:32768
  v_mfma_f32_16x16x32_bf16 v[60:63], v[140:143], a[116:119], v[60:63]
  s_waitcnt lgkmcnt(13)
  ds_read_b64_tr_b16 v[110:111], v6 offset:34816
  v_mfma_f32_16x16x32_bf16 v[32:35], v[144:147], a[120:123], v[32:35]
  ds_read_b64_tr_b16 v[112:113], v3 offset:36864
  v_mfma_f32_16x16x32_bf16 v[36:39], v[144:147], a[124:127], v[36:39]
  s_waitcnt lgkmcnt(13)
  ds_read_b64_tr_b16 v[114:115], v3 offset:38912
  v_mfma_f32_16x16x32_bf16 v[40:43], v[148:151], a[120:123], v[40:43]
  ds_read_b64_tr_b16 v[116:117], v4 offset:36864
  v_mfma_f32_16x16x32_bf16 v[44:47], v[148:151], a[124:127], v[44:47]
  s_waitcnt lgkmcnt(13)
  ds_read_b64_tr_b16 v[118:119], v4 offset:38912
  v_mfma_f32_16x16x32_bf16 v[48:51], v[152:155], a[120:123], v[48:51]
  ds_read_b64_tr_b16 v[120:121], v5 offset:36864
  v_mfma_f32_16x16x32_bf16 v[52:55], v[152:155], a[124:127], v[52:55]
  s_waitcnt lgkmcnt(13)
  ds_read_b64_tr_b16 v[122:123], v5 offset:38912
  v_mfma_f32_16x16x32_bf16 v[56:59], v[156:159], a[120:123], v[56:59]
  ds_read_b64_tr_b16 v[124:125], v6 offset:36864
  v_mfma_f32_16x16x32_bf16 v[60:63], v[156:159], a[124:127], v[60:63]
  s_waitcnt lgkmcnt(13)
  ds_read_b64_tr_b16 v[126:127], v6 offset:38912
  v_mfma_f32_16x16x32_bf16 v[32:35], v[96:99], a[128:131], v[32:35]
  s_add_u32 s44, s62, s14
  s_add_u32 m0, s45, 98304
  s_add_u32 s44, s44, 884736
  ds_read_b64_tr_b16 v[128:129], v3 offset:40960
  buffer_load_dwordx4 v11, s[32:35], s44 offen offset:0 lds
  v_mfma_f32_16x16x32_bf16 v[36:39], v[96:99], a[132:135], v[36:39]
  s_waitcnt lgkmcnt(13)
  ds_read_b64_tr_b16 v[130:131], v3 offset:43008
  v_mfma_f32_16x16x32_bf16 v[40:43], v[100:103], a[128:131], v[40:43]
  ds_read_b64_tr_b16 v[132:133], v4 offset:40960
  v_mfma_f32_16x16x32_bf16 v[44:47], v[100:103], a[132:135], v[44:47]
  s_waitcnt lgkmcnt(13)
  ds_read_b64_tr_b16 v[134:135], v4 offset:43008
  buffer_load_dwordx4 v12, s[32:35], s44 offen offset:1024 lds
  v_mfma_f32_16x16x32_bf16 v[48:51], v[104:107], a[128:131], v[48:51]
  ds_read_b64_tr_b16 v[136:137], v5 offset:40960
  v_mfma_f32_16x16x32_bf16 v[52:55], v[104:107], a[132:135], v[52:55]
  s_waitcnt lgkmcnt(13)
  ds_read_b64_tr_b16 v[138:139], v5 offset:43008
  v_mfma_f32_16x16x32_bf16 v[56:59], v[108:111], a[128:131], v[56:59]
  ds_read_b64_tr_b16 v[140:141], v6 offset:40960
  buffer_load_dwordx4 v13, s[32:35], s44 offen offset:2048 lds
  v_mfma_f32_16x16x32_bf16 v[60:63], v[108:111], a[132:135], v[60:63]
  s_waitcnt lgkmcnt(13)
  ds_read_b64_tr_b16 v[142:143], v6 offset:43008
  v_mfma_f32_16x16x32_bf16 v[32:35], v[112:115], a[136:139], v[32:35]
  ds_read_b64_tr_b16 v[144:145], v3 offset:45056
  v_mfma_f32_16x16x32_bf16 v[36:39], v[112:115], a[140:143], v[36:39]
  s_waitcnt lgkmcnt(13)
  ds_read_b64_tr_b16 v[146:147], v3 offset:47104
  buffer_load_dwordx4 v14, s[32:35], s44 offen offset:3072 lds
  v_mfma_f32_16x16x32_bf16 v[40:43], v[116:119], a[136:139], v[40:43]
  ds_read_b64_tr_b16 v[148:149], v4 offset:45056
  v_mfma_f32_16x16x32_bf16 v[44:47], v[116:119], a[140:143], v[44:47]
  s_waitcnt lgkmcnt(13)
  ds_read_b64_tr_b16 v[150:151], v4 offset:47104
  v_mfma_f32_16x16x32_bf16 v[48:51], v[120:123], a[136:139], v[48:51]
  ds_read_b64_tr_b16 v[152:153], v5 offset:45056
  v_mfma_f32_16x16x32_bf16 v[52:55], v[120:123], a[140:143], v[52:55]
  s_waitcnt lgkmcnt(13)
  ds_read_b64_tr_b16 v[154:155], v5 offset:47104
  v_mfma_f32_16x16x32_bf16 v[56:59], v[124:127], a[136:139], v[56:59]
  ds_read_b64_tr_b16 v[156:157], v6 offset:45056
  v_mfma_f32_16x16x32_bf16 v[60:63], v[124:127], a[140:143], v[60:63]
  s_waitcnt lgkmcnt(13)
  ds_read_b64_tr_b16 v[158:159], v6 offset:47104
  v_mfma_f32_16x16x32_bf16 v[32:35], v[128:131], a[144:147], v[32:35]
  s_waitcnt vmcnt(12)
  s_barrier
  ds_read_b64_tr_b16 v[96:97], v3 offset:49152
  v_mfma_f32_16x16x32_bf16 v[36:39], v[128:131], a[148:151], v[36:39]
  s_waitcnt lgkmcnt(13)
  ds_read_b64_tr_b16 v[98:99], v3 offset:51200
  v_mfma_f32_16x16x32_bf16 v[40:43], v[132:135], a[144:147], v[40:43]
  ds_read_b64_tr_b16 v[100:101], v4 offset:49152
  v_mfma_f32_16x16x32_bf16 v[44:47], v[132:135], a[148:151], v[44:47]
  s_waitcnt lgkmcnt(13)
  ds_read_b64_tr_b16 v[102:103], v4 offset:51200
  v_mfma_f32_16x16x32_bf16 v[48:51], v[136:139], a[144:147], v[48:51]
  ds_read_b64_tr_b16 v[104:105], v5 offset:49152
  v_mfma_f32_16x16x32_bf16 v[52:55], v[136:139], a[148:151], v[52:55]
  s_waitcnt lgkmcnt(13)
  ds_read_b64_tr_b16 v[106:107], v5 offset:51200
  v_mfma_f32_16x16x32_bf16 v[56:59], v[140:143], a[144:147], v[56:59]
  ds_read_b64_tr_b16 v[108:109], v6 offset:49152
  v_mfma_f32_16x16x32_bf16 v[60:63], v[140:143], a[148:151], v[60:63]
  s_waitcnt lgkmcnt(13)
  ds_read_b64_tr_b16 v[110:111], v6 offset:51200
  v_mfma_f32_16x16x32_bf16 v[32:35], v[144:147], a[152:155], v[32:35]
  ds_read_b64_tr_b16 v[112:113], v3 offset:53248
  v_mfma_f32_16x16x32_bf16 v[36:39], v[144:147], a[156:159], v[36:39]
  s_waitcnt lgkmcnt(13)
  ds_read_b64_tr_b16 v[114:115], v3 offset:55296
  v_mfma_f32_16x16x32_bf16 v[40:43], v[148:151], a[152:155], v[40:43]
  ds_read_b64_tr_b16 v[116:117], v4 offset:53248
  v_mfma_f32_16x16x32_bf16 v[44:47], v[148:151], a[156:159], v[44:47]
  s_waitcnt lgkmcnt(13)
  ds_read_b64_tr_b16 v[118:119], v4 offset:55296
  v_mfma_f32_16x16x32_bf16 v[48:51], v[152:155], a[152:155], v[48:51]
  ds_read_b64_tr_b16 v[120:121], v5 offset:53248
  v_mfma_f32_16x16x32_bf16 v[52:55], v[152:155], a[156:159], v[52:55]
  s_waitcnt lgkmcnt(13)
  ds_read_b64_tr_b16 v[122:123], v5 offset:55296
  v_mfma_f32_16x16x32_bf16 v[56:59], v[156:159], a[152:155], v[56:59]
  ds_read_b64_tr_b16 v[124:125], v6 offset:53248
  v_mfma_f32_16x16x32_bf16 v[60:63], v[156:159], a[156:159], v[60:63]
  s_waitcnt lgkmcnt(13)
  ds_read_b64_tr_b16 v[126:127], v6 offset:55296
  v_mfma_f32_16x16x32_bf16 v[32:35], v[96:99], a[160:163], v[32:35]
  s_add_u32 m0, s45, 114688
  s_add_u32 s44, s62, 1327104
  ds_read_b64_tr_b16 v[128:129], v3 offset:57344
  buffer_load_dwordx4 v11, s[32:35], s44 offen offset:0 lds
  v_mfma_f32_16x16x32_bf16 v[36:39], v[96:99], a[164:167], v[36:39]
  s_waitcnt lgkmcnt(13)
  ds_read_b64_tr_b16 v[130:131], v3 offset:59392
  v_mfma_f32_16x16x32_bf16 v[40:43], v[100:103], a[160:163], v[40:43]
  ds_read_b64_tr_b16 v[132:133], v4 offset:57344
  v_mfma_f32_16x16x32_bf16 v[44:47], v[100:103], a[164:167], v[44:47]
  s_waitcnt lgkmcnt(13)
  ds_read_b64_tr_b16 v[134:135], v4 offset:59392
  buffer_load_dwordx4 v12, s[32:35], s44 offen offset:1024 lds
  v_mfma_f32_16x16x32_bf16 v[48:51], v[104:107], a[160:163], v[48:51]
  ds_read_b64_tr_b16 v[136:137], v5 offset:57344
  v_mfma_f32_16x16x32_bf16 v[52:55], v[104:107], a[164:167], v[52:55]
  s_waitcnt lgkmcnt(13)
  ds_read_b64_tr_b16 v[138:139], v5 offset:59392
  v_mfma_f32_16x16x32_bf16 v[56:59], v[108:111], a[160:163], v[56:59]
  ds_read_b64_tr_b16 v[140:141], v6 offset:57344
  buffer_load_dwordx4 v13, s[32:35], s44 offen offset:2048 lds
  v_mfma_f32_16x16x32_bf16 v[60:63], v[108:111], a[164:167], v[60:63]
  s_waitcnt lgkmcnt(13)
  ds_read_b64_tr_b16 v[142:143], v6 offset:59392
  v_mfma_f32_16x16x32_bf16 v[32:35], v[112:115], a[168:171], v[32:35]
  ds_read_b64_tr_b16 v[144:145], v3 offset:61440
  v_mfma_f32_16x16x32_bf16 v[36:39], v[112:115], a[172:175], v[36:39]
  s_waitcnt lgkmcnt(13)
  ds_read_b64_tr_b16 v[146:147], v3 offset:63488
  buffer_load_dwordx4 v14, s[32:35], s44 offen offset:3072 lds
  v_mfma_f32_16x16x32_bf16 v[40:43], v[116:119], a[168:171], v[40:43]
  ds_read_b64_tr_b16 v[148:149], v4 offset:61440
  v_mfma_f32_16x16x32_bf16 v[44:47], v[116:119], a[172:175], v[44:47]
  s_waitcnt lgkmcnt(13)
  ds_read_b64_tr_b16 v[150:151], v4 offset:63488
  v_mfma_f32_16x16x32_bf16 v[48:51], v[120:123], a[168:171], v[48:51]
  ds_read_b64_tr_b16 v[152:153], v5 offset:61440
  v_mfma_f32_16x16x32_bf16 v[52:55], v[120:123], a[172:175], v[52:55]
  s_waitcnt lgkmcnt(13)
  ds_read_b64_tr_b16 v[154:155], v5 offset:63488
  v_mfma_f32_16x16x32_bf16 v[56:59], v[124:127], a[168:171], v[56:59]
  ds_read_b64_tr_b16 v[156:157], v6 offset:61440
  v_mfma_f32_16x16x32_bf16 v[60:63], v[124:127], a[172:175], v[60:63]
  s_waitcnt lgkmcnt(13)
  ds_read_b64_tr_b16 v[158:159], v6 offset:63488
  v_mfma_f32_16x16x32_bf16 v[32:35], v[128:131], a[176:179], v[32:35]
  s_waitcnt vmcnt(12)
  s_barrier
  ds_read_b64_tr_b16 v[96:97], v7 offset:0
  v_mfma_f32_16x16x32_bf16 v[36:39], v[128:131], a[180:183], v[36:39]
  s_cmp_lg_u32 s28, 0
  s_cbranch_scc1 oproj_kernel_nf
  s_mov_b64 exec, 1
  buffer_store_dword v23, v22, s[72:75], 0 offen sc1
  s_mov_b64 exec, -1
oproj_kernel_nf:
  ds_read_b64_tr_b16 v[98:99], v7 offset:2048
  s_waitcnt lgkmcnt(14)
  v_mfma_f32_16x16x32_bf16 v[40:43], v[132:135], a[176:179], v[40:43]
  ds_read_b64_tr_b16 v[100:101], v8 offset:0
  v_mfma_f32_16x16x32_bf16 v[44:47], v[132:135], a[180:183], v[44:47]
  s_waitcnt lgkmcnt(13)
  ds_read_b64_tr_b16 v[102:103], v8 offset:2048
  v_mfma_f32_16x16x32_bf16 v[48:51], v[136:139], a[176:179], v[48:51]
  ds_read_b64_tr_b16 v[104:105], v9 offset:0
  v_mfma_f32_16x16x32_bf16 v[52:55], v[136:139], a[180:183], v[52:55]
  s_waitcnt lgkmcnt(13)
  ds_read_b64_tr_b16 v[106:107], v9 offset:2048
  v_mfma_f32_16x16x32_bf16 v[56:59], v[140:143], a[176:179], v[56:59]
  ds_read_b64_tr_b16 v[108:109], v10 offset:0
  v_mfma_f32_16x16x32_bf16 v[60:63], v[140:143], a[180:183], v[60:63]
  s_waitcnt lgkmcnt(13)
  ds_read_b64_tr_b16 v[110:111], v10 offset:2048
  v_mfma_f32_16x16x32_bf16 v[32:35], v[144:147], a[184:187], v[32:35]
  ds_read_b64_tr_b16 v[112:113], v7 offset:4096
  v_mfma_f32_16x16x32_bf16 v[36:39], v[144:147], a[188:191], v[36:39]
  s_waitcnt lgkmcnt(13)
  ds_read_b64_tr_b16 v[114:115], v7 offset:6144
  v_mfma_f32_16x16x32_bf16 v[40:43], v[148:151], a[184:187], v[40:43]
  ds_read_b64_tr_b16 v[116:117], v8 offset:4096
  v_mfma_f32_16x16x32_bf16 v[44:47], v[148:151], a[188:191], v[44:47]
  s_waitcnt lgkmcnt(13)
  ds_read_b64_tr_b16 v[118:119], v8 offset:6144
  v_mfma_f32_16x16x32_bf16 v[48:51], v[152:155], a[184:187], v[48:51]
  ds_read_b64_tr_b16 v[120:121], v9 offset:4096
  v_mfma_f32_16x16x32_bf16 v[52:55], v[152:155], a[188:191], v[52:55]
  s_waitcnt lgkmcnt(13)
  ds_read_b64_tr_b16 v[122:123], v9 offset:6144
  v_mfma_f32_16x16x32_bf16 v[56:59], v[156:159], a[184:187], v[56:59]
  ds_read_b64_tr_b16 v[124:125], v10 offset:4096
  v_mfma_f32_16x16x32_bf16 v[60:63], v[156:159], a[188:191], v[60:63]
  s_waitcnt lgkmcnt(13)
  ds_read_b64_tr_b16 v[126:127], v10 offset:6144
  v_mfma_f32_16x16x32_bf16 v[32:35], v[96:99], a[192:195], v[32:35]
  s_add_u32 m0, s45, 0
  s_add_u32 s44, s62, 1474560
  ds_read_b64_tr_b16 v[128:129], v7 offset:8192
  buffer_load_dwordx4 v11, s[32:35], s44 offen offset:0 lds
  v_mfma_f32_16x16x32_bf16 v[36:39], v[96:99], a[196:199], v[36:39]
  s_waitcnt lgkmcnt(13)
  ds_read_b64_tr_b16 v[130:131], v7 offset:10240
  v_mfma_f32_16x16x32_bf16 v[40:43], v[100:103], a[192:195], v[40:43]
  ds_read_b64_tr_b16 v[132:133], v8 offset:8192
  v_mfma_f32_16x16x32_bf16 v[44:47], v[100:103], a[196:199], v[44:47]
  s_waitcnt lgkmcnt(13)
  ds_read_b64_tr_b16 v[134:135], v8 offset:10240
  buffer_load_dwordx4 v12, s[32:35], s44 offen offset:1024 lds
  v_mfma_f32_16x16x32_bf16 v[48:51], v[104:107], a[192:195], v[48:51]
  ds_read_b64_tr_b16 v[136:137], v9 offset:8192
  v_mfma_f32_16x16x32_bf16 v[52:55], v[104:107], a[196:199], v[52:55]
  s_waitcnt lgkmcnt(13)
  ds_read_b64_tr_b16 v[138:139], v9 offset:10240
  v_mfma_f32_16x16x32_bf16 v[56:59], v[108:111], a[192:195], v[56:59]
  ds_read_b64_tr_b16 v[140:141], v10 offset:8192
  buffer_load_dwordx4 v13, s[32:35], s44 offen offset:2048 lds
  v_mfma_f32_16x16x32_bf16 v[60:63], v[108:111], a[196:199], v[60:63]
  s_waitcnt lgkmcnt(13)
  ds_read_b64_tr_b16 v[142:143], v10 offset:10240
  v_mfma_f32_16x16x32_bf16 v[32:35], v[112:115], a[200:203], v[32:35]
  ds_read_b64_tr_b16 v[144:145], v7 offset:12288
  v_mfma_f32_16x16x32_bf16 v[36:39], v[112:115], a[204:207], v[36:39]
  s_waitcnt lgkmcnt(13)
  ds_read_b64_tr_b16 v[146:147], v7 offset:14336
  buffer_load_dwordx4 v14, s[32:35], s44 offen offset:3072 lds
  v_mfma_f32_16x16x32_bf16 v[40:43], v[116:119], a[200:203], v[40:43]
  ds_read_b64_tr_b16 v[148:149], v8 offset:12288
  v_mfma_f32_16x16x32_bf16 v[44:47], v[116:119], a[204:207], v[44:47]
  s_waitcnt lgkmcnt(13)
  ds_read_b64_tr_b16 v[150:151], v8 offset:14336
  v_mfma_f32_16x16x32_bf16 v[48:51], v[120:123], a[200:203], v[48:51]
  ds_read_b64_tr_b16 v[152:153], v9 offset:12288
  v_mfma_f32_16x16x32_bf16 v[52:55], v[120:123], a[204:207], v[52:55]
  s_waitcnt lgkmcnt(13)
  ds_read_b64_tr_b16 v[154:155], v9 offset:14336
  v_mfma_f32_16x16x32_bf16 v[56:59], v[124:127], a[200:203], v[56:59]
  ds_read_b64_tr_b16 v[156:157], v10 offset:12288
  v_mfma_f32_16x16x32_bf16 v[60:63], v[124:127], a[204:207], v[60:63]
  s_waitcnt lgkmcnt(13)
  ds_read_b64_tr_b16 v[158:159], v10 offset:14336
  v_mfma_f32_16x16x32_bf16 v[32:35], v[128:131], a[208:211], v[32:35]
  s_waitcnt vmcnt(12)
  s_barrier
  ds_read_b64_tr_b16 v[96:97], v7 offset:16384
  v_mfma_f32_16x16x32_bf16 v[36:39], v[128:131], a[212:215], v[36:39]
  s_waitcnt lgkmcnt(13)
  ds_read_b64_tr_b16 v[98:99], v7 offset:18432
  v_mfma_f32_16x16x32_bf16 v[40:43], v[132:135], a[208:211], v[40:43]
  ds_read_b64_tr_b16 v[100:101], v8 offset:16384
  v_mfma_f32_16x16x32_bf16 v[44:47], v[132:135], a[212:215], v[44:47]
  s_waitcnt lgkmcnt(13)
  ds_read_b64_tr_b16 v[102:103], v8 offset:18432
  v_mfma_f32_16x16x32_bf16 v[48:51], v[136:139], a[208:211], v[48:51]
  ds_read_b64_tr_b16 v[104:105], v9 offset:16384
  v_mfma_f32_16x16x32_bf16 v[52:55], v[136:139], a[212:215], v[52:55]
  s_waitcnt lgkmcnt(13)
  ds_read_b64_tr_b16 v[106:107], v9 offset:18432
  v_mfma_f32_16x16x32_bf16 v[56:59], v[140:143], a[208:211], v[56:59]
  ds_read_b64_tr_b16 v[108:109], v10 offset:16384
  v_mfma_f32_16x16x32_bf16 v[60:63], v[140:143], a[212:215], v[60:63]
  s_waitcnt lgkmcnt(13)
  ds_read_b64_tr_b16 v[110:111], v10 offset:18432
  v_mfma_f32_16x16x32_bf16 v[32:35], v[144:147], a[216:219], v[32:35]
  ds_read_b64_tr_b16 v[112:113], v7 offset:20480
  v_mfma_f32_16x16x32_bf16 v[36:39], v[144:147], a[220:223], v[36:39]
  s_waitcnt lgkmcnt(13)
  ds_read_b64_tr_b16 v[114:115], v7 offset:22528
  v_mfma_f32_16x16x32_bf16 v[40:43], v[148:151], a[216:219], v[40:43]
  ds_read_b64_tr_b16 v[116:117], v8 offset:20480
  v_mfma_f32_16x16x32_bf16 v[44:47], v[148:151], a[220:223], v[44:47]
  s_waitcnt lgkmcnt(13)
  ds_read_b64_tr_b16 v[118:119], v8 offset:22528
  v_mfma_f32_16x16x32_bf16 v[48:51], v[152:155], a[216:219], v[48:51]
  ds_read_b64_tr_b16 v[120:121], v9 offset:20480
  v_mfma_f32_16x16x32_bf16 v[52:55], v[152:155], a[220:223], v[52:55]
  s_waitcnt lgkmcnt(13)
  ds_read_b64_tr_b16 v[122:123], v9 offset:22528
  v_mfma_f32_16x16x32_bf16 v[56:59], v[156:159], a[216:219], v[56:59]
  ds_read_b64_tr_b16 v[124:125], v10 offset:20480
  v_mfma_f32_16x16x32_bf16 v[60:63], v[156:159], a[220:223], v[60:63]
  s_waitcnt lgkmcnt(13)
  ds_read_b64_tr_b16 v[126:127], v10 offset:22528
  v_mfma_f32_16x16x32_bf16 v[32:35], v[96:99], a[224:227], v[32:35]
  ds_read_b64_tr_b16 v[128:129], v7 offset:24576
  v_mfma_f32_16x16x32_bf16 v[36:39], v[96:99], a[228:231], v[36:39]
  s_waitcnt lgkmcnt(13)
  ds_read_b64_tr_b16 v[130:131], v7 offset:26624
  v_mfma_f32_16x16x32_bf16 v[40:43], v[100:103], a[224:227], v[40:43]
  ds_read_b64_tr_b16 v[132:133], v8 offset:24576
  v_mfma_f32_16x16x32_bf16 v[44:47], v[100:103], a[228:231], v[44:47]
  s_waitcnt lgkmcnt(13)
  ds_read_b64_tr_b16 v[134:135], v8 offset:26624
  v_mfma_f32_16x16x32_bf16 v[48:51], v[104:107], a[224:227], v[48:51]
  ds_read_b64_tr_b16 v[136:137], v9 offset:24576
  v_mfma_f32_16x16x32_bf16 v[52:55], v[104:107], a[228:231], v[52:55]
  s_waitcnt lgkmcnt(13)
  ds_read_b64_tr_b16 v[138:139], v9 offset:26624
  v_mfma_f32_16x16x32_bf16 v[56:59], v[108:111], a[224:227], v[56:59]
  ds_read_b64_tr_b16 v[140:141], v10 offset:24576
  v_mfma_f32_16x16x32_bf16 v[60:63], v[108:111], a[228:231], v[60:63]
  s_waitcnt lgkmcnt(13)
  ds_read_b64_tr_b16 v[142:143], v10 offset:26624
  v_mfma_f32_16x16x32_bf16 v[32:35], v[112:115], a[232:235], v[32:35]
  ds_read_b64_tr_b16 v[144:145], v7 offset:28672
  v_mfma_f32_16x16x32_bf16 v[36:39], v[112:115], a[236:239], v[36:39]
  s_waitcnt lgkmcnt(13)
  ds_read_b64_tr_b16 v[146:147], v7 offset:30720
  v_mfma_f32_16x16x32_bf16 v[40:43], v[116:119], a[232:235], v[40:43]
  ds_read_b64_tr_b16 v[148:149], v8 offset:28672
  v_mfma_f32_16x16x32_bf16 v[44:47], v[116:119], a[236:239], v[44:47]
  s_waitcnt lgkmcnt(13)
  ds_read_b64_tr_b16 v[150:151], v8 offset:30720
  v_mfma_f32_16x16x32_bf16 v[48:51], v[120:123], a[232:235], v[48:51]
  ds_read_b64_tr_b16 v[152:153], v9 offset:28672
  v_mfma_f32_16x16x32_bf16 v[52:55], v[120:123], a[236:239], v[52:55]
  s_waitcnt lgkmcnt(13)
  ds_read_b64_tr_b16 v[154:155], v9 offset:30720
  v_mfma_f32_16x16x32_bf16 v[56:59], v[124:127], a[232:235], v[56:59]
  ds_read_b64_tr_b16 v[156:157], v10 offset:28672
  v_mfma_f32_16x16x32_bf16 v[60:63], v[124:127], a[236:239], v[60:63]
  s_waitcnt lgkmcnt(13)
  ds_read_b64_tr_b16 v[158:159], v10 offset:30720
  v_mfma_f32_16x16x32_bf16 v[32:35], v[128:131], a[240:243], v[32:35]
  s_waitcnt vmcnt(8)
  s_barrier
  ds_read_b64_tr_b16 v[96:97], v7 offset:32768
  v_mfma_f32_16x16x32_bf16 v[36:39], v[128:131], a[244:247], v[36:39]
  s_waitcnt lgkmcnt(13)
  ds_read_b64_tr_b16 v[98:99], v7 offset:34816
  v_mfma_f32_16x16x32_bf16 v[40:43], v[132:135], a[240:243], v[40:43]
  ds_read_b64_tr_b16 v[100:101], v8 offset:32768
  v_mfma_f32_16x16x32_bf16 v[44:47], v[132:135], a[244:247], v[44:47]
  s_waitcnt lgkmcnt(13)
  ds_read_b64_tr_b16 v[102:103], v8 offset:34816
  v_mfma_f32_16x16x32_bf16 v[48:51], v[136:139], a[240:243], v[48:51]
  ds_read_b64_tr_b16 v[104:105], v9 offset:32768
  v_mfma_f32_16x16x32_bf16 v[52:55], v[136:139], a[244:247], v[52:55]
  s_waitcnt lgkmcnt(13)
  ds_read_b64_tr_b16 v[106:107], v9 offset:34816
  v_mfma_f32_16x16x32_bf16 v[56:59], v[140:143], a[240:243], v[56:59]
  ds_read_b64_tr_b16 v[108:109], v10 offset:32768
  v_mfma_f32_16x16x32_bf16 v[60:63], v[140:143], a[244:247], v[60:63]
  s_waitcnt lgkmcnt(13)
  ds_read_b64_tr_b16 v[110:111], v10 offset:34816
  v_mfma_f32_16x16x32_bf16 v[32:35], v[144:147], a[248:251], v[32:35]
  ds_read_b64_tr_b16 v[112:113], v7 offset:36864
  v_mfma_f32_16x16x32_bf16 v[36:39], v[144:147], a[252:255], v[36:39]
  s_waitcnt lgkmcnt(13)
  ds_read_b64_tr_b16 v[114:115], v7 offset:38912
  v_mfma_f32_16x16x32_bf16 v[40:43], v[148:151], a[248:251], v[40:43]
  ds_read_b64_tr_b16 v[116:117], v8 offset:36864
  v_mfma_f32_16x16x32_bf16 v[44:47], v[148:151], a[252:255], v[44:47]
  s_waitcnt lgkmcnt(13)
  ds_read_b64_tr_b16 v[118:119], v8 offset:38912
  v_mfma_f32_16x16x32_bf16 v[48:51], v[152:155], a[248:251], v[48:51]
  ds_read_b64_tr_b16 v[120:121], v9 offset:36864
  v_mfma_f32_16x16x32_bf16 v[52:55], v[152:155], a[252:255], v[52:55]
  s_waitcnt lgkmcnt(13)
  ds_read_b64_tr_b16 v[122:123], v9 offset:38912
  v_mfma_f32_16x16x32_bf16 v[56:59], v[156:159], a[248:251], v[56:59]
  ds_read_b64_tr_b16 v[124:125], v10 offset:36864
  v_mfma_f32_16x16x32_bf16 v[60:63], v[156:159], a[252:255], v[60:63]
  s_waitcnt lgkmcnt(13)
  ds_read_b64_tr_b16 v[126:127], v10 offset:38912
  v_mfma_f32_16x16x32_bf16 v[32:35], v[96:99], v[160:163], v[32:35]
  ds_read_b64_tr_b16 v[128:129], v7 offset:40960
  v_mfma_f32_16x16x32_bf16 v[36:39], v[96:99], v[164:167], v[36:39]
  s_waitcnt lgkmcnt(13)
  ds_read_b64_tr_b16 v[130:131], v7 offset:43008
  v_mfma_f32_16x16x32_bf16 v[40:43], v[100:103], v[160:163], v[40:43]
  ds_read_b64_tr_b16 v[132:133], v8 offset:40960
  buffer_load_dword v24, v20, s[72:75], 0 offen sc1
  v_mfma_f32_16x16x32_bf16 v[44:47], v[100:103], v[164:167], v[44:47]
  s_waitcnt lgkmcnt(13)
  ds_read_b64_tr_b16 v[134:135], v8 offset:43008
  v_mfma_f32_16x16x32_bf16 v[48:51], v[104:107], v[160:163], v[48:51]
  ds_read_b64_tr_b16 v[136:137], v9 offset:40960
  v_mfma_f32_16x16x32_bf16 v[52:55], v[104:107], v[164:167], v[52:55]
  s_waitcnt lgkmcnt(13)
  ds_read_b64_tr_b16 v[138:139], v9 offset:43008
  v_mfma_f32_16x16x32_bf16 v[56:59], v[108:111], v[160:163], v[56:59]
  ds_read_b64_tr_b16 v[140:141], v10 offset:40960
  v_mfma_f32_16x16x32_bf16 v[60:63], v[108:111], v[164:167], v[60:63]
  s_waitcnt lgkmcnt(13)
  ds_read_b64_tr_b16 v[142:143], v10 offset:43008
  v_mfma_f32_16x16x32_bf16 v[32:35], v[112:115], v[168:171], v[32:35]
  ds_read_b64_tr_b16 v[144:145], v7 offset:45056
  v_mfma_f32_16x16x32_bf16 v[36:39], v[112:115], v[172:175], v[36:39]
  s_waitcnt lgkmcnt(13)
  ds_read_b64_tr_b16 v[146:147], v7 offset:47104
  v_mfma_f32_16x16x32_bf16 v[40:43], v[116:119], v[168:171], v[40:43]
  ds_read_b64_tr_b16 v[148:149], v8 offset:45056
  v_mfma_f32_16x16x32_bf16 v[44:47], v[116:119], v[172:175], v[44:47]
  s_waitcnt lgkmcnt(13)
  ds_read_b64_tr_b16 v[150:151], v8 offset:47104
  v_mfma_f32_16x16x32_bf16 v[48:51], v[120:123], v[168:171], v[48:51]
  ds_read_b64_tr_b16 v[152:153], v9 offset:45056
  v_mfma_f32_16x16x32_bf16 v[52:55], v[120:123], v[172:175], v[52:55]
  s_waitcnt lgkmcnt(13)
  ds_read_b64_tr_b16 v[154:155], v9 offset:47104
  v_mfma_f32_16x16x32_bf16 v[56:59], v[124:127], v[168:171], v[56:59]
  ds_read_b64_tr_b16 v[156:157], v10 offset:45056
  v_mfma_f32_16x16x32_bf16 v[60:63], v[124:127], v[172:175], v[60:63]
  s_waitcnt lgkmcnt(13)
  ds_read_b64_tr_b16 v[158:159], v10 offset:47104
  v_mfma_f32_16x16x32_bf16 v[32:35], v[128:131], v[176:179], v[32:35]
  s_waitcnt vmcnt(5)
  s_barrier
  ds_read_b64_tr_b16 v[96:97], v7 offset:49152
  v_mfma_f32_16x16x32_bf16 v[36:39], v[128:131], v[180:183], v[36:39]
  s_waitcnt lgkmcnt(13)
  ds_read_b64_tr_b16 v[98:99], v7 offset:51200
  v_mfma_f32_16x16x32_bf16 v[40:43], v[132:135], v[176:179], v[40:43]
  ds_read_b64_tr_b16 v[100:101], v8 offset:49152
  v_mfma_f32_16x16x32_bf16 v[44:47], v[132:135], v[180:183], v[44:47]
  s_waitcnt lgkmcnt(13)
  ds_read_b64_tr_b16 v[102:103], v8 offset:51200
  v_mfma_f32_16x16x32_bf16 v[48:51], v[136:139], v[176:179], v[48:51]
  ds_read_b64_tr_b16 v[104:105], v9 offset:49152
  v_mfma_f32_16x16x32_bf16 v[52:55], v[136:139], v[180:183], v[52:55]
  s_waitcnt lgkmcnt(13)
  ds_read_b64_tr_b16 v[106:107], v9 offset:51200
  v_mfma_f32_16x16x32_bf16 v[56:59], v[140:143], v[176:179], v[56:59]
  ds_read_b64_tr_b16 v[108:109], v10 offset:49152
  v_mfma_f32_16x16x32_bf16 v[60:63], v[140:143], v[180:183], v[60:63]
  s_waitcnt lgkmcnt(13)
  ds_read_b64_tr_b16 v[110:111], v10 offset:51200
  v_mfma_f32_16x16x32_bf16 v[32:35], v[144:147], v[184:187], v[32:35]
  ds_read_b64_tr_b16 v[112:113], v7 offset:53248
  v_mfma_f32_16x16x32_bf16 v[36:39], v[144:147], v[188:191], v[36:39]
  s_waitcnt lgkmcnt(13)
  ds_read_b64_tr_b16 v[114:115], v7 offset:55296
  v_mfma_f32_16x16x32_bf16 v[40:43], v[148:151], v[184:187], v[40:43]
  ds_read_b64_tr_b16 v[116:117], v8 offset:53248
  v_mfma_f32_16x16x32_bf16 v[44:47], v[148:151], v[188:191], v[44:47]
  s_waitcnt lgkmcnt(13)
  ds_read_b64_tr_b16 v[118:119], v8 offset:55296
  v_mfma_f32_16x16x32_bf16 v[48:51], v[152:155], v[184:187], v[48:51]
  ds_read_b64_tr_b16 v[120:121], v9 offset:53248
  v_mfma_f32_16x16x32_bf16 v[52:55], v[152:155], v[188:191], v[52:55]
  s_waitcnt lgkmcnt(13)
  ds_read_b64_tr_b16 v[122:123], v9 offset:55296
  v_mfma_f32_16x16x32_bf16 v[56:59], v[156:159], v[184:187], v[56:59]
  ds_read_b64_tr_b16 v[124:125], v10 offset:53248
  v_mfma_f32_16x16x32_bf16 v[60:63], v[156:159], v[188:191], v[60:63]
  s_waitcnt lgkmcnt(13)
  ds_read_b64_tr_b16 v[126:127], v10 offset:55296
  v_mfma_f32_16x16x32_bf16 v[32:35], v[96:99], v[192:195], v[32:35]
  ds_read_b64_tr_b16 v[128:129], v7 offset:57344
  v_mfma_f32_16x16x32_bf16 v[36:39], v[96:99], v[196:199], v[36:39]
  s_waitcnt lgkmcnt(13)
  ds_read_b64_tr_b16 v[130:131], v7 offset:59392
  v_mfma_f32_16x16x32_bf16 v[40:43], v[100:103], v[192:195], v[40:43]
  ds_read_b64_tr_b16 v[132:133], v8 offset:57344
  s_waitcnt vmcnt(0)
  v_cmp_ne_u32 vcc, v23, v24
  s_cbranch_vccnz oproj_kernel_poll
oproj_kernel_pb:
  v_mfma_f32_16x16x32_bf16 v[44:47], v[100:103], v[196:199], v[44:47]
  s_waitcnt lgkmcnt(13)
  ds_read_b64_tr_b16 v[134:135], v8 offset:59392
  buffer_load_dwordx4 a[0:3], v2, s[68:71], s65 offen offset:0 sc1
  v_mfma_f32_16x16x32_bf16 v[48:51], v[104:107], v[192:195], v[48:51]
  ds_read_b64_tr_b16 v[136:137], v9 offset:57344
  v_mfma_f32_16x16x32_bf16 v[52:55], v[104:107], v[196:199], v[52:55]
  s_waitcnt lgkmcnt(13)
  ds_read_b64_tr_b16 v[138:139], v9 offset:59392
  v_mfma_f32_16x16x32_bf16 v[56:59], v[108:111], v[192:195], v[56:59]
  ds_read_b64_tr_b16 v[140:141], v10 offset:57344
  buffer_load_dwordx4 a[4:7], v2, s[68:71], s65 offen offset:1024 sc1
  v_mfma_f32_16x16x32_bf16 v[60:63], v[108:111], v[196:199], v[60:63]
  s_waitcnt lgkmcnt(13)
  ds_read_b64_tr_b16 v[142:143], v10 offset:59392
  v_mfma_f32_16x16x32_bf16 v[32:35], v[112:115], v[200:203], v[32:35]
  ds_read_b64_tr_b16 v[144:145], v7 offset:61440
  v_mfma_f32_16x16x32_bf16 v[36:39], v[112:115], v[204:207], v[36:39]
  s_waitcnt lgkmcnt(13)
  ds_read_b64_tr_b16 v[146:147], v7 offset:63488
  buffer_load_dwordx4 a[8:11], v2, s[68:71], s65 offen offset:2048 sc1
  v_mfma_f32_16x16x32_bf16 v[40:43], v[116:119], v[200:203], v[40:43]
  ds_read_b64_tr_b16 v[148:149], v8 offset:61440
  v_mfma_f32_16x16x32_bf16 v[44:47], v[116:119], v[204:207], v[44:47]
  s_waitcnt lgkmcnt(13)
  ds_read_b64_tr_b16 v[150:151], v8 offset:63488
  v_mfma_f32_16x16x32_bf16 v[48:51], v[120:123], v[200:203], v[48:51]
  ds_read_b64_tr_b16 v[152:153], v9 offset:61440
  buffer_load_dwordx4 a[12:15], v2, s[68:71], s65 offen offset:3072 sc1
  v_mfma_f32_16x16x32_bf16 v[52:55], v[120:123], v[204:207], v[52:55]
  s_waitcnt lgkmcnt(13)
  s_add_u32 s65, s65, 16384
  ds_read_b64_tr_b16 v[154:155], v9 offset:63488
  v_mfma_f32_16x16x32_bf16 v[56:59], v[124:127], v[200:203], v[56:59]
  ds_read_b64_tr_b16 v[156:157], v10 offset:61440
  v_mfma_f32_16x16x32_bf16 v[60:63], v[124:127], v[204:207], v[60:63]
  s_waitcnt lgkmcnt(13)
  ds_read_b64_tr_b16 v[158:159], v10 offset:63488
  buffer_load_dwordx4 a[16:19], v2, s[68:71], s65 offen offset:0 sc1
  v_mfma_f32_16x16x32_bf16 v[32:35], v[128:131], v[208:211], v[32:35]
  s_barrier
  ds_read_b64_tr_b16 v[96:97], v3 offset:0
  v_mfma_f32_16x16x32_bf16 v[36:39], v[128:131], v[212:215], v[36:39]
  s_waitcnt lgkmcnt(13)
  ds_read_b64_tr_b16 v[98:99], v3 offset:2048
  v_mfma_f32_16x16x32_bf16 v[40:43], v[132:135], v[208:211], v[40:43]
  ds_read_b64_tr_b16 v[100:101], v4 offset:0
  buffer_load_dwordx4 a[20:23], v2, s[68:71], s65 offen offset:1024 sc1
  v_mfma_f32_16x16x32_bf16 v[44:47], v[132:135], v[212:215], v[44:47]
  s_waitcnt lgkmcnt(13)
  ds_read_b64_tr_b16 v[102:103], v4 offset:2048
  v_mfma_f32_16x16x32_bf16 v[48:51], v[136:139], v[208:211], v[48:51]
  ds_read_b64_tr_b16 v[104:105], v5 offset:0
  v_mfma_f32_16x16x32_bf16 v[52:55], v[136:139], v[212:215], v[52:55]
  s_waitcnt lgkmcnt(13)
  ds_read_b64_tr_b16 v[106:107], v5 offset:2048
  buffer_load_dwordx4 a[24:27], v2, s[68:71], s65 offen offset:2048 sc1
  v_mfma_f32_16x16x32_bf16 v[56:59], v[140:143], v[208:211], v[56:59]
  ds_read_b64_tr_b16 v[108:109], v6 offset:0
  v_mfma_f32_16x16x32_bf16 v[60:63], v[140:143], v[212:215], v[60:63]
  s_waitcnt lgkmcnt(13)
  ds_read_b64_tr_b16 v[110:111], v6 offset:2048
  v_mfma_f32_16x16x32_bf16 v[32:35], v[144:147], v[216:219], v[32:35]
  ds_read_b64_tr_b16 v[112:113], v3 offset:4096
  buffer_load_dwordx4 a[28:31], v2, s[68:71], s65 offen offset:3072 sc1
  v_mfma_f32_16x16x32_bf16 v[36:39], v[144:147], v[220:223], v[36:39]
  s_waitcnt lgkmcnt(13)
  ds_read_b64_tr_b16 v[114:115], v3 offset:6144
  v_mfma_f32_16x16x32_bf16 v[40:43], v[148:151], v[216:219], v[40:43]
  ds_read_b64_tr_b16 v[116:117], v4 offset:4096
  v_mfma_f32_16x16x32_bf16 v[44:47], v[148:151], v[220:223], v[44:47]
  s_waitcnt lgkmcnt(13)
  ds_read_b64_tr_b16 v[118:119], v4 offset:6144
  v_mfma_f32_16x16x32_bf16 v[48:51], v[152:155], v[216:219], v[48:51]
  ds_read_b64_tr_b16 v[120:121], v5 offset:4096
  v_mfma_f32_16x16x32_bf16 v[52:55], v[152:155], v[220:223], v[52:55]
  s_waitcnt lgkmcnt(13)
  ds_read_b64_tr_b16 v[122:123], v5 offset:6144
  v_mfma_f32_16x16x32_bf16 v[56:59], v[156:159], v[216:219], v[56:59]
  ds_read_b64_tr_b16 v[124:125], v6 offset:4096
  v_mfma_f32_16x16x32_bf16 v[60:63], v[156:159], v[220:223], v[60:63]
  s_waitcnt lgkmcnt(13)
  ds_read_b64_tr_b16 v[126:127], v6 offset:6144
  v_mfma_f32_16x16x32_bf16 v[32:35], v[96:99], v[224:227], v[32:35]
  ds_read_b64_tr_b16 v[128:129], v3 offset:8192
  v_mfma_f32_16x16x32_bf16 v[36:39], v[96:99], v[228:231], v[36:39]
  s_waitcnt lgkmcnt(13)
  ds_read_b64_tr_b16 v[130:131], v3 offset:10240
  v_mfma_f32_16x16x32_bf16 v[40:43], v[100:103], v[224:227], v[40:43]
  ds_read_b64_tr_b16 v[132:133], v4 offset:8192
  v_mfma_f32_16x16x32_bf16 v[44:47], v[100:103], v[228:231], v[44:47]
  s_waitcnt lgkmcnt(13)
  ds_read_b64_tr_b16 v[134:135], v4 offset:10240
  v_mfma_f32_16x16x32_bf16 v[48:51], v[104:107], v[224:227], v[48:51]
  ds_read_b64_tr_b16 v[136:137], v5 offset:8192
  v_mfma_f32_16x16x32_bf16 v[52:55], v[104:107], v[228:231], v[52:55]
  s_waitcnt lgkmcnt(13)
  ds_read_b64_tr_b16 v[138:139], v5 offset:10240
  v_mfma_f32_16x16x32_bf16 v[56:59], v[108:111], v[224:227], v[56:59]
  ds_read_b64_tr_b16 v[140:141], v6 offset:8192
  v_mfma_f32_16x16x32_bf16 v[60:63], v[108:111], v[228:231], v[60:63]
  s_waitcnt lgkmcnt(13)
  ds_read_b64_tr_b16 v[142:143], v6 offset:10240
  v_mfma_f32_16x16x32_bf16 v[32:35], v[112:115], v[232:235], v[32:35]
  ds_read_b64_tr_b16 v[144:145], v3 offset:12288
  v_mfma_f32_16x16x32_bf16 v[36:39], v[112:115], v[236:239], v[36:39]
  s_waitcnt lgkmcnt(13)
  ds_read_b64_tr_b16 v[146:147], v3 offset:14336
  v_mfma_f32_16x16x32_bf16 v[40:43], v[116:119], v[232:235], v[40:43]
  ds_read_b64_tr_b16 v[148:149], v4 offset:12288
  v_mfma_f32_16x16x32_bf16 v[44:47], v[116:119], v[236:239], v[44:47]
  s_waitcnt lgkmcnt(13)
  ds_read_b64_tr_b16 v[150:151], v4 offset:14336
  v_mfma_f32_16x16x32_bf16 v[48:51], v[120:123], v[232:235], v[48:51]
  ds_read_b64_tr_b16 v[152:153], v5 offset:12288
  v_mfma_f32_16x16x32_bf16 v[52:55], v[120:123], v[236:239], v[52:55]
  s_waitcnt lgkmcnt(13)
  ds_read_b64_tr_b16 v[154:155], v5 offset:14336
  v_mfma_f32_16x16x32_bf16 v[56:59], v[124:127], v[232:235], v[56:59]
  ds_read_b64_tr_b16 v[156:157], v6 offset:12288
  v_mfma_f32_16x16x32_bf16 v[60:63], v[124:127], v[236:239], v[60:63]
  s_waitcnt lgkmcnt(13)
  ds_read_b64_tr_b16 v[158:159], v6 offset:14336
  v_mfma_f32_16x16x32_bf16 v[32:35], v[128:131], v[240:243], v[32:35]
  v_mfma_f32_16x16x32_bf16 v[36:39], v[128:131], v[244:247], v[36:39]
  s_waitcnt lgkmcnt(12)
  v_mfma_f32_16x16x32_bf16 v[40:43], v[132:135], v[240:243], v[40:43]
  v_mfma_f32_16x16x32_bf16 v[44:47], v[132:135], v[244:247], v[44:47]
  s_waitcnt lgkmcnt(10)
  v_mfma_f32_16x16x32_bf16 v[48:51], v[136:139], v[240:243], v[48:51]
  v_mfma_f32_16x16x32_bf16 v[52:55], v[136:139], v[244:247], v[52:55]
  s_waitcnt lgkmcnt(8)
  v_mfma_f32_16x16x32_bf16 v[56:59], v[140:143], v[240:243], v[56:59]
  v_mfma_f32_16x16x32_bf16 v[60:63], v[140:143], v[244:247], v[60:63]
  s_waitcnt lgkmcnt(6)
  v_mfma_f32_16x16x32_bf16 v[32:35], v[144:147], v[248:251], v[32:35]
  v_mfma_f32_16x16x32_bf16 v[36:39], v[144:147], v[252:255], v[36:39]
  s_waitcnt lgkmcnt(4)
  v_mfma_f32_16x16x32_bf16 v[40:43], v[148:151], v[248:251], v[40:43]
  v_mfma_f32_16x16x32_bf16 v[44:47], v[148:151], v[252:255], v[44:47]
  s_waitcnt lgkmcnt(2)
  v_mfma_f32_16x16x32_bf16 v[48:51], v[152:155], v[248:251], v[48:51]
  v_mfma_f32_16x16x32_bf16 v[52:55], v[152:155], v[252:255], v[52:55]
  s_waitcnt lgkmcnt(0)
  v_mfma_f32_16x16x32_bf16 v[56:59], v[156:159], v[248:251], v[56:59]
  v_mfma_f32_16x16x32_bf16 v[60:63], v[156:159], v[252:255], v[60:63]
  s_mov_b32 s50, 36864
  s_mov_b32 s51, 0xffff0000
  s_nop 7
  s_waitcnt vmcnt(7)
  v_accvgpr_read_b32 v96, a0
  v_accvgpr_read_b32 v100, a1
  s_waitcnt vmcnt(3)
  v_accvgpr_read_b32 v104, a16
  v_accvgpr_read_b32 v108, a17
  v_lshlrev_b32 v97, 16, v96
  v_and_b32 v98, s51, v96
  v_lshlrev_b32 v101, 16, v100
  v_and_b32 v102, s51, v100
  v_lshlrev_b32 v105, 16, v104
  v_and_b32 v106, s51, v104
  v_lshlrev_b32 v109, 16, v108
  v_and_b32 v110, s51, v108
  v_add_f32 v32, v32, v97
  v_add_f32 v33, v33, v98
  v_add_f32 v34, v34, v101
  v_add_f32 v35, v35, v102
  v_add_f32 v32, v32, v105
  v_add_f32 v33, v33, v106
  v_add_f32 v34, v34, v109
  v_add_f32 v35, v35, v110
  v_cvt_pk_bf16_f32 v64, v32, v33
  v_cvt_pk_bf16_f32 v65, v34, v35
  buffer_store_dwordx2 v[64:65], v15, s[40:43], 0 offen offset:0
  v_accvgpr_read_b32 v112, a2
  v_accvgpr_read_b32 v116, a3
  v_accvgpr_read_b32 v120, a18
  v_accvgpr_read_b32 v124, a19
  v_lshlrev_b32 v113, 16, v112
  v_and_b32 v114, s51, v112
  v_lshlrev_b32 v117, 16, v116
  v_and_b32 v118, s51, v116
  v_lshlrev_b32 v121, 16, v120
  v_and_b32 v122, s51, v120
  v_lshlrev_b32 v125, 16, v124
  v_and_b32 v126, s51, v124
  v_add_f32 v36, v36, v113
  v_add_f32 v37, v37, v114
  v_add_f32 v38, v38, v117
  v_add_f32 v39, v39, v118
  v_add_f32 v36, v36, v121
  v_add_f32 v37, v37, v122
  v_add_f32 v38, v38, v125
  v_add_f32 v39, v39, v126
  v_cvt_pk_bf16_f32 v66, v36, v37
  v_cvt_pk_bf16_f32 v67, v38, v39
  buffer_store_dwordx2 v[66:67], v15, s[40:43], s50 offen offset:0
  v_accvgpr_read_b32 v128, a4
  v_accvgpr_read_b32 v132, a5
  s_waitcnt vmcnt(4)
  v_accvgpr_read_b32 v136, a20
  v_accvgpr_read_b32 v140, a21
  v_lshlrev_b32 v129, 16, v128
  v_and_b32 v130, s51, v128
  v_lshlrev_b32 v133, 16, v132
  v_and_b32 v134, s51, v132
  v_lshlrev_b32 v137, 16, v136
  v_and_b32 v138, s51, v136
  v_lshlrev_b32 v141, 16, v140
  v_and_b32 v142, s51, v140
  v_add_f32 v40, v40, v129
  v_add_f32 v41, v41, v130
  v_add_f32 v42, v42, v133
  v_add_f32 v43, v43, v134
  v_add_f32 v40, v40, v137
  v_add_f32 v41, v41, v138
  v_add_f32 v42, v42, v141
  v_add_f32 v43, v43, v142
  v_cvt_pk_bf16_f32 v68, v40, v41
  v_cvt_pk_bf16_f32 v69, v42, v43
  buffer_store_dwordx2 v[68:69], v15, s[40:43], 0 offen offset:32
  v_accvgpr_read_b32 v144, a6
  v_accvgpr_read_b32 v148, a7
  v_accvgpr_read_b32 v152, a22
  v_accvgpr_read_b32 v156, a23
  v_lshlrev_b32 v145, 16, v144
  v_and_b32 v146, s51, v144
  v_lshlrev_b32 v149, 16, v148
  v_and_b32 v150, s51, v148
  v_lshlrev_b32 v153, 16, v152
  v_and_b32 v154, s51, v152
  v_lshlrev_b32 v157, 16, v156
  v_and_b32 v158, s51, v156
  v_add_f32 v44, v44, v145
  v_add_f32 v45, v45, v146
  v_add_f32 v46, v46, v149
  v_add_f32 v47, v47, v150
  v_add_f32 v44, v44, v153
  v_add_f32 v45, v45, v154
  v_add_f32 v46, v46, v157
  v_add_f32 v47, v47, v158
  v_cvt_pk_bf16_f32 v70, v44, v45
  v_cvt_pk_bf16_f32 v71, v46, v47
  buffer_store_dwordx2 v[70:71], v15, s[40:43], s50 offen offset:32
  v_accvgpr_read_b32 v160, a8
  v_accvgpr_read_b32 v164, a9
  s_waitcnt vmcnt(5)
  v_accvgpr_read_b32 v168, a24
  v_accvgpr_read_b32 v172, a25
  v_lshlrev_b32 v161, 16, v160
  v_and_b32 v162, s51, v160
  v_lshlrev_b32 v165, 16, v164
  v_and_b32 v166, s51, v164
  v_lshlrev_b32 v169, 16, v168
  v_and_b32 v170, s51, v168
  v_lshlrev_b32 v173, 16, v172
  v_and_b32 v174, s51, v172
  v_add_f32 v48, v48, v161
  v_add_f32 v49, v49, v162
  v_add_f32 v50, v50, v165
  v_add_f32 v51, v51, v166
  v_add_f32 v48, v48, v169
  v_add_f32 v49, v49, v170
  v_add_f32 v50, v50, v173
  v_add_f32 v51, v51, v174
  v_cvt_pk_bf16_f32 v72, v48, v49
  v_cvt_pk_bf16_f32 v73, v50, v51
  buffer_store_dwordx2 v[72:73], v15, s[40:43], 0 offen offset:64
  v_accvgpr_read_b32 v176, a10
  v_accvgpr_read_b32 v180, a11
  v_accvgpr_read_b32 v184, a26
  v_accvgpr_read_b32 v188, a27
  v_lshlrev_b32 v177, 16, v176
  v_and_b32 v178, s51, v176
  v_lshlrev_b32 v181, 16, v180
  v_and_b32 v182, s51, v180
  v_lshlrev_b32 v185, 16, v184
  v_and_b32 v186, s51, v184
  v_lshlrev_b32 v189, 16, v188
  v_and_b32 v190, s51, v188
  v_add_f32 v52, v52, v177
  v_add_f32 v53, v53, v178
  v_add_f32 v54, v54, v181
  v_add_f32 v55, v55, v182
  v_add_f32 v52, v52, v185
  v_add_f32 v53, v53, v186
  v_add_f32 v54, v54, v189
  v_add_f32 v55, v55, v190
  v_cvt_pk_bf16_f32 v74, v52, v53
  v_cvt_pk_bf16_f32 v75, v54, v55
  buffer_store_dwordx2 v[74:75], v15, s[40:43], s50 offen offset:64
  v_accvgpr_read_b32 v192, a12
  v_accvgpr_read_b32 v196, a13
  s_waitcnt vmcnt(6)
  v_accvgpr_read_b32 v200, a28
  v_accvgpr_read_b32 v204, a29
  v_lshlrev_b32 v193, 16, v192
  v_and_b32 v194, s51, v192
  v_lshlrev_b32 v197, 16, v196
  v_and_b32 v198, s51, v196
  v_lshlrev_b32 v201, 16, v200
  v_and_b32 v202, s51, v200
  v_lshlrev_b32 v205, 16, v204
  v_and_b32 v206, s51, v204
  v_add_f32 v56, v56, v193
  v_add_f32 v57, v57, v194
  v_add_f32 v58, v58, v197
  v_add_f32 v59, v59, v198
  v_add_f32 v56, v56, v201
  v_add_f32 v57, v57, v202
  v_add_f32 v58, v58, v205
  v_add_f32 v59, v59, v206
  v_cvt_pk_bf16_f32 v76, v56, v57
  v_cvt_pk_bf16_f32 v77, v58, v59
  buffer_store_dwordx2 v[76:77], v15, s[40:43], 0 offen offset:96
  v_accvgpr_read_b32 v208, a14
  v_accvgpr_read_b32 v212, a15
  v_accvgpr_read_b32 v216, a30
  v_accvgpr_read_b32 v220, a31
  v_lshlrev_b32 v209, 16, v208
  v_and_b32 v210, s51, v208
  v_lshlrev_b32 v213, 16, v212
  v_and_b32 v214, s51, v212
  v_lshlrev_b32 v217, 16, v216
  v_and_b32 v218, s51, v216
  v_lshlrev_b32 v221, 16, v220
  v_and_b32 v222, s51, v220
  v_add_f32 v60, v60, v209
  v_add_f32 v61, v61, v210
  v_add_f32 v62, v62, v213
  v_add_f32 v63, v63, v214
  v_add_f32 v60, v60, v217
  v_add_f32 v61, v61, v218
  v_add_f32 v62, v62, v221
  v_add_f32 v63, v63, v222
  v_cvt_pk_bf16_f32 v78, v60, v61
  v_cvt_pk_bf16_f32 v79, v62, v63
  buffer_store_dwordx2 v[78:79], v15, s[40:43], s50 offen offset:96
oproj_kernel_done:
  s_endpgm
oproj_kernel_poll:
  s_mov_b32 s78, 0
oproj_kernel_pl:
  buffer_load_dword v24, v20, s[72:75], 0 offen sc1
  s_waitcnt vmcnt(0)
  v_cmp_ne_u32 vcc, v23, v24
  s_add_u32 s78, s78, 1
  s_cmp_lt_u32 s78, 0x40000
  s_cbranch_scc0 oproj_kernel_pb
  s_cbranch_vccnz oproj_kernel_pl
  s_branch oproj_kernel_pb
code_end:
.section .rodata,"a"
.p2align 6
.amdhsa_kernel attn_kernel
  .amdhsa_next_free_vgpr 512
  .amdhsa_next_free_sgpr 102
  .amdhsa_accum_offset 256
  .amdhsa_group_segment_fixed_size 0
  .amdhsa_kernarg_size 104
  .amdhsa_user_sgpr_count 2
  .amdhsa_user_sgpr_kernarg_segment_ptr 1
  .amdhsa_system_sgpr_workgroup_id_x 1
.end_amdhsa_kernel
.p2align 6
.amdhsa_kernel oproj_kernel
  .amdhsa_next_free_vgpr 512
  .amdhsa_next_free_sgpr 102
  .amdhsa_accum_offset 256
  .amdhsa_group_segment_fixed_size 0
  .amdhsa_kernarg_size 104
  .amdhsa_user_sgpr_count 2
  .amdhsa_user_sgpr_kernarg_segment_ptr 1
  .amdhsa_system_sgpr_workgroup_id_x 1
.end_amdhsa_kernel
```
